```python
import torch

def _softmax(x, axis=-1):
    return torch.softmax(x, dim=axis)

def _gelu(x):
    return torch.nn.functional.gelu(x, approximate='tanh')

def _silu(x):
    return torch.nn.functional.silu(x)

def _sigmoid(x):
    return torch.sigmoid(x)

def _layernorm(x, axis=-1, eps=1e-05):
    m = x.mean(dim=axis, keepdim=True)
    v = x.var(dim=axis, keepdim=True, unbiased=False)
    return (x - m) / torch.sqrt(v + eps)

def _scatter_add(tgt, idx, src, axis=0):
    return tgt.clone().index_add_(axis, idx, src)

def _segment_sum(src, seg, n):
    out = torch.zeros((n,) + src.shape[1:], dtype=src.dtype)
    return out.index_add_(0, seg, src)

def _pad(x, pw):
    flat = tuple((v for pair in reversed(pw) for v in pair))
    return torch.nn.functional.pad(x, flat)
kernel_name = 'adaLN_cond__sliding_block_cached__glu_gated_geglu__prompt'

def setup_inputs():

    _w = lambda a: (lambda t: t.to(torch.bfloat16) if t.is_floating_point() else t)(torch.as_tensor(a))

    def _A_setup():
        B, Sq, D = (1, 2048, 512)
        Hq, Hkv, Sk, Dh = (32, 32, 2048, 128)
        assert Hq % Hkv == 0, (Hq, Hkv)
        return {'x': _w((lambda *s: torch.randn(*s, dtype=torch.bfloat16) * 0.05)(B, Sq, D)), 'k_cache': _w((lambda *s: torch.randn(*s, dtype=torch.bfloat16) * 1.6)(B, Hkv, Sk, Dh)), 'v_cache': _w((lambda *s: torch.randn(*s, dtype=torch.bfloat16) * 0.8)(B, Hkv, Sk, Dh)), 'wq': _w((lambda *s: torch.randn(*s, dtype=torch.bfloat16) * 1.6)(D, Hq * Dh) * D ** (-0.5)), 'wo': _w((lambda *s: torch.randn(*s, dtype=torch.bfloat16) * 0.8)(Hq * Dh, D) * (Hq * Dh) ** (-0.5))}
    _A_in = _A_setup()

    def _B_setup():
        B, S, Dm, Df = (1, 2048, 512, 1376)
        return {'x': _w((lambda *s: torch.randn(*s, dtype=torch.bfloat16) * 0.05)(B, S, Dm)), 'w_gate': _w((lambda *s: torch.randn(*s, dtype=torch.bfloat16) * 0.8)(Dm, Df) * Dm ** (-0.5)), 'w_up': _w((lambda *s: torch.randn(*s, dtype=torch.bfloat16) * 0.8)(Dm, Df) * Dm ** (-0.5)), 'w_down': _w((lambda *s: torch.randn(*s, dtype=torch.bfloat16) * 0.8)(Df, Dm) * Df ** (-0.5))}
    _B_in = _B_setup()
    return {'A_x': _A_in['x'], 'A_k_cache': _A_in['k_cache'], 'A_v_cache': _A_in['v_cache'], 'A_wq': _A_in['wq'], 'A_wo': _A_in['wo'], 'B_x': _B_in['x'], 'B_w_gate': _B_in['w_gate'], 'B_w_up': _B_in['w_up'], 'B_w_down': _B_in['w_down'], 'c': _w((lambda *s: torch.randn(*s, dtype=torch.bfloat16) * 0.1)(1, 512) * 8.0), 'w_mod': _w((lambda *s: torch.randn(*s, dtype=torch.bfloat16) * 0.1)(512, 6 * 512) * 512 ** (-0.5) * 8.0)}

def reference(A_x, A_k_cache, A_v_cache, A_wq, A_wo, B_x, B_w_gate, B_w_up, B_w_down, c, w_mod):

    def _A_ref(x, k_cache, v_cache, wq, wo):
        B, Sq, D = x.shape
        Hq, Dh = (32, 128)
        Hkv, Sk = (k_cache.shape[1], k_cache.shape[2])
        W = min(4096, max(256, Sk // 4))
        rep = Hq // Hkv
        q = (lambda x, *d: x.permute(*d))((x @ wq).reshape(B, Sq, Hq, Dh), 0, 2, 1, 3)
        k = (lambda x, n, axis: torch.repeat_interleave(x, n, dim=axis))(k_cache[:, :, Sk - W:, :], rep, axis=1)
        v = (lambda x, n, axis: torch.repeat_interleave(x, n, dim=axis))(v_cache[:, :, Sk - W:, :], rep, axis=1)
        scores = torch.einsum('bhqd,bhkd->bhqk', q, k) * Dh ** (-0.5)
        p = _softmax(scores, axis=-1)
        o = torch.einsum('bhqk,bhkd->bhqd', p, v)
        return (lambda x, *d: x.permute(*d))(o, 0, 2, 1, 3).reshape(B, Sq, Hq * Dh) @ wo

    def _B_ref(x, w_gate, w_up, w_down):
        g = torch.einsum('bsd,df->bsf', x, w_gate)
        u = torch.einsum('bsd,df->bsf', x, w_up)
        h = _gelu(g) * u
        return torch.einsum('bsf,fd->bsd', h, w_down)
    x = A_x
    mod = (_silu(c) @ w_mod).reshape(c.shape[0], 6, 1, -1)
    sa, ca, ga, sb, cb, gb = (mod[:, 0].clone(), mod[:, 1].clone(), mod[:, 2].clone(), mod[:, 3].clone(), mod[:, 4].clone(), mod[:, 5].clone())
    h = _layernorm(x, axis=-1) * (1 + ca) + sa
    x = x + ga * _A_ref(h, A_k_cache, A_v_cache, A_wq, A_wo)
    h = _layernorm(x, axis=-1) * (1 + cb) + sb
    x = x + gb * _B_ref(h, B_w_gate, B_w_up, B_w_down)
    return x
```

```asm
; @launch kernel=ada_attn_kernel grid=(256,1,1) block=(256,1,1) lds=155648
; @launch kernel=ada_tail_kernel grid=(256,1,1) block=(256,1,1) lds=69632
.amdgcn_target "amdgcn-amd-amdhsa--gfx950"
.text
.globl ada_attn_kernel
.p2align 8
.type ada_attn_kernel,@function
ada_attn_kernel:
    s_cmp_ge_u32 s2, 256
    s_cbranch_scc1 L_k2_end
    s_load_dwordx2 s[32:33], s[0:1], 0
    s_load_dwordx2 s[82:83], s[0:1], 72
    s_load_dwordx2 s[84:85], s[0:1], 80
    s_load_dwordx2 s[40:41], s[0:1], 96
    s_memrealtime s[42:43]
    s_load_dwordx2 s[48:49], s[0:1], 8
    s_load_dwordx2 s[50:51], s[0:1], 16
    s_load_dwordx2 s[52:53], s[0:1], 24
    s_load_dwordx2 s[54:55], s[0:1], 104
    s_load_dwordx2 s[56:57], s[0:1], 32
    s_load_dwordx2 s[58:59], s[0:1], 64
    s_load_dwordx2 s[60:61], s[0:1], 48
    s_load_dwordx2 s[62:63], s[0:1], 56
    s_cmp_ge_u32 s2, 32
    s_cbranch_scc1 L_cpf_skip
    s_getpc_b64 s[20:21]
L_cpf_here:
    s_mov_b32 s22, L_text_end-L_cpf_here
    s_mov_b32 s23, 0x00020000
    v_lshlrev_b32 v250, 7, v0
    s_mov_b32 s24, 0
    buffer_load_dword v248, v250, s[20:23], s24 offen
    s_mov_b32 s24, 32768
    buffer_load_dword v249, v250, s[20:23], s24 offen
L_cpf_skip:
    v_lshrrev_b32 v2, 6, v0
    v_and_b32 v1, 63, v0
    v_readfirstlane_b32 s28, v2
    s_and_b32 s29, s2, 7
    s_lshr_b32 s30, s2, 3
    s_lshl_b32 s29, s29, 2
    s_and_b32 s46, s30, 3
    s_add_u32 s29, s29, s46
    s_lshr_b32 s30, s30, 2
    v_lshrrev_b32 v24, 3, v1
    v_bfe_u32 v25, v1, 2, 1
    v_bfe_u32 v26, v1, 4, 1
    v_xor_b32 v25, v25, v26
    v_and_b32 v26, 3, v1
    v_lshlrev_b32 v26, 4, v26
    v_lshl_add_u32 v26, v25, 6, v26
    v_lshl_add_u32 v19, v24, 13, v26
    v_lshl_add_u32 v5, v24, 8, v26
    v_lshlrev_b32 v18, 4, v1
    v_lshrrev_b32 v236, 2, v0
    v_and_b32 v237, 3, v0
    v_mul_u32_u24 v240, 49152, v236
    v_lshl_add_u32 v240, v237, 4, v240
    v_lshlrev_b32 v241, 4, v236
    v_lshlrev_b32 v243, 7, v236
    v_lshl_add_u32 v243, v237, 5, v243
    v_add_u32 v243, 147456, v243
    v_lshrrev_b32 v236, 3, v0
    v_and_b32 v237, 7, v0
    v_lshlrev_b32 v242, 9, v236
    v_lshl_add_u32 v242, v237, 4, v242
    v_lshrrev_b32 v236, 3, v1
    v_lshlrev_b32 v244, 10, v236
    v_and_b32 v237, 7, v1
    v_lshl_add_u32 v244, v237, 2, v244
    s_lshl_b32 s46, s28, 5
    s_add_u32 s46, s46, 147456
    v_add_u32 v244, s46, v244
    s_and_b32 s31, s2, 31
    s_waitcnt lgkmcnt(0)
    s_mov_b32 s8, s32
    s_mov_b32 s9, s33
    s_mov_b32 s10, 0x200000
    s_mov_b32 s11, 0x00020000
    s_mov_b32 s12, s84
    s_mov_b32 s13, s85
    s_mov_b32 s14, 0x300000
    s_mov_b32 s15, 0x00020000
    s_mov_b32 s20, s82
    s_mov_b32 s21, s83
    s_mov_b32 s22, 0x400
    s_mov_b32 s23, 0x00020000
    s_lshl_b32 s36, s30, 5
    s_add_u32 s36, s36, s31
    s_and_b32 s35, s31, 7
    s_lshl_b32 s35, s35, 1
    s_bfe_u32 s46, s31, 0x10003
    s_add_u32 s35, s35, s46
    s_lshr_b32 s46, s31, 4
    s_lshl_b32 s46, s46, 4
    s_add_u32 s35, s35, s46
    buffer_load_dwordx4 v[100:103], v241, s[20:23], 0 offen
    s_lshl_b32 s46, s36, 13
    s_lshl_b32 s47, s28, 11
    s_add_u32 s46, s46, s47
    v_lshlrev_b32 v236, 4, v1
    buffer_load_dwordx4 v[64:67], v236, s[8:11], s46 offen
    buffer_load_dwordx4 v[68:71], v236, s[8:11], s46 offen offset:1024
    s_lshl_b32 s46, s35, 6
    buffer_load_dwordx4 v[112:115], v240, s[12:15], s46 offen
    s_add_u32 s46, s46, 6144
    buffer_load_dwordx4 v[116:119], v240, s[12:15], s46 offen
    s_add_u32 s46, s46, 6144
    buffer_load_dwordx4 v[120:123], v240, s[12:15], s46 offen
    s_add_u32 s46, s46, 6144
    buffer_load_dwordx4 v[124:127], v240, s[12:15], s46 offen
    s_add_u32 s46, s46, 6144
    buffer_load_dwordx4 v[128:131], v240, s[12:15], s46 offen
    s_add_u32 s46, s46, 6144
    buffer_load_dwordx4 v[132:135], v240, s[12:15], s46 offen
    s_add_u32 s46, s46, 6144
    buffer_load_dwordx4 v[136:139], v240, s[12:15], s46 offen
    s_add_u32 s46, s46, 6144
    buffer_load_dwordx4 v[140:143], v240, s[12:15], s46 offen
    s_or_b32 s43, s43, 0x80000000
    s_lshl_b32 s46, s30, 5
    v_mov_b32 v251, s46
    v_mov_b32 v252, s42
    v_mov_b32 v253, s43
    v_mov_b32 v254, 0
    v_mov_b32 v255, 0
    s_cmp_lg_u32 s28, 0
    s_cbranch_scc1 L_mg_dummy
    s_mov_b32 s20, s40
    s_mov_b32 s21, s41
    s_mov_b32 s22, 0x100
    s_mov_b32 s23, 0x00020000
    s_mov_b64 exec, 1
    buffer_atomic_cmpswap_x2 v[252:255], v251, s[20:23], 0 offen sc0 sc1
    s_mov_b64 exec, -1
    s_branch L_mg_tagged
L_mg_dummy:
    buffer_load_dword v252, v241, s[20:23], 0 offen
L_mg_tagged:
    s_add_u32 s20, s54, 0x10000
    s_addc_u32 s21, s55, 0
    s_mov_b32 s22, 0x10080
    s_mov_b32 s23, 0x00020000
    s_lshl_b32 s46, s30, 12
    s_add_u32 s46, s46, 32768
    s_add_u32 s24, s54, s46
    s_addc_u32 s25, s55, 0
    s_mov_b32 s26, 0x1000
    s_mov_b32 s27, 0x00020000
    s_lshl_b32 s46, s29, 8
    s_add_u32 s4, s52, s46
    s_addc_u32 s5, s53, 0
    s_mov_b32 s6, 0x400000
    s_mov_b32 s7, 0x00020000
    s_sub_u32 s6, s6, s46
    s_lshl_b32 s44, s28, 13
    s_lshl_b32 s45, s28, 18
    s_add_u32 s16, s54, 0x100000
    s_addc_u32 s17, s55, 0
    s_mov_b32 s18, 0x210000
    s_mov_b32 s19, 0x00020000
    s_lshl_b32 s46, s30, 3
    s_lshl_b32 s47, s28, 1
    s_add_u32 s46, s46, s47
    s_lshl_b32 s34, s46, 18
    s_lshl_b32 s47, s29, 13
    s_add_u32 s34, s34, s47
    s_lshl_b32 s47, s46, 15
    v_lshlrev_b32 v16, 4, v1
    v_add_u32 v16, s47, v16
    v_add_u32 v17, 32768, v16
    v_mov_b32 v24, 0
    v_mov_b32 v25, 137504
    ds_write_b32 v25, v24
    s_waitcnt vmcnt(11)
    v_lshlrev_b32 v104, 16, v100
    v_and_b32 v105, 0xffff0000, v100
    v_lshlrev_b32 v106, 16, v101
    v_and_b32 v107, 0xffff0000, v101
    v_lshlrev_b32 v108, 16, v102
    v_and_b32 v109, 0xffff0000, v102
    v_lshlrev_b32 v110, 16, v103
    v_and_b32 v111, 0xffff0000, v103
    v_mul_f32 v144, 0xbfb8aa3b, v104
    v_mul_f32 v145, 0xbfb8aa3b, v105
    v_mul_f32 v146, 0xbfb8aa3b, v106
    v_mul_f32 v147, 0xbfb8aa3b, v107
    v_mul_f32 v148, 0xbfb8aa3b, v108
    v_mul_f32 v149, 0xbfb8aa3b, v109
    v_mul_f32 v150, 0xbfb8aa3b, v110
    v_mul_f32 v151, 0xbfb8aa3b, v111
    v_exp_f32 v144, v144
    v_exp_f32 v145, v145
    v_exp_f32 v146, v146
    v_exp_f32 v147, v147
    v_exp_f32 v148, v148
    v_exp_f32 v149, v149
    v_exp_f32 v150, v150
    v_exp_f32 v151, v151
    v_add_f32 v144, 1.0, v144
    v_add_f32 v145, 1.0, v145
    v_add_f32 v146, 1.0, v146
    v_add_f32 v147, 1.0, v147
    v_add_f32 v148, 1.0, v148
    v_add_f32 v149, 1.0, v149
    v_add_f32 v150, 1.0, v150
    v_add_f32 v151, 1.0, v151
    v_rcp_f32 v144, v144
    v_rcp_f32 v145, v145
    v_rcp_f32 v146, v146
    v_rcp_f32 v147, v147
    v_rcp_f32 v148, v148
    v_rcp_f32 v149, v149
    v_rcp_f32 v150, v150
    v_rcp_f32 v151, v151
    v_mul_f32 v104, v104, v144
    v_mul_f32 v105, v105, v145
    v_mul_f32 v106, v106, v146
    v_mul_f32 v107, v107, v147
    v_mul_f32 v108, v108, v148
    v_mul_f32 v109, v109, v149
    v_mul_f32 v110, v110, v150
    v_mul_f32 v111, v111, v151
    v_cvt_pk_bf16_f32 v224, v104, v105
    v_cvt_pk_bf16_f32 v225, v106, v107
    v_cvt_pk_bf16_f32 v226, v108, v109
    v_cvt_pk_bf16_f32 v227, v110, v111
    s_waitcnt vmcnt(10)
    v_lshlrev_b32 v72, 16, v64
    v_and_b32 v73, 0xffff0000, v64
    v_lshlrev_b32 v74, 16, v65
    v_and_b32 v75, 0xffff0000, v65
    v_lshlrev_b32 v76, 16, v66
    v_and_b32 v77, 0xffff0000, v66
    v_lshlrev_b32 v78, 16, v67
    v_and_b32 v79, 0xffff0000, v67
    s_waitcnt vmcnt(9)
    v_lshlrev_b32 v80, 16, v68
    v_and_b32 v81, 0xffff0000, v68
    v_lshlrev_b32 v82, 16, v69
    v_and_b32 v83, 0xffff0000, v69
    v_lshlrev_b32 v84, 16, v70
    v_and_b32 v85, 0xffff0000, v70
    v_lshlrev_b32 v86, 16, v71
    v_and_b32 v87, 0xffff0000, v71
    v_add_f32 v88, v72, v73
    v_add_f32 v90, v74, v75
    v_add_f32 v89, v80, v81
    v_add_f32 v91, v82, v83
    v_add_f32 v88, v88, v76
    v_add_f32 v90, v90, v77
    v_add_f32 v89, v89, v84
    v_add_f32 v91, v91, v85
    v_add_f32 v88, v88, v78
    v_add_f32 v90, v90, v79
    v_add_f32 v89, v89, v86
    v_add_f32 v91, v91, v87
    v_add_f32 v88, v88, v90
    v_add_f32 v89, v89, v91
    s_nop 0
    v_add_f32_dpp v88, v88, v88 row_ror:8 row_mask:0xf bank_mask:0xf
    v_add_f32_dpp v89, v89, v89 row_ror:8 row_mask:0xf bank_mask:0xf
    s_nop 0
    v_add_f32_dpp v88, v88, v88 row_ror:4 row_mask:0xf bank_mask:0xf
    v_add_f32_dpp v89, v89, v89 row_ror:4 row_mask:0xf bank_mask:0xf
    s_nop 0
    v_add_f32_dpp v88, v88, v88 row_ror:2 row_mask:0xf bank_mask:0xf
    v_add_f32_dpp v89, v89, v89 row_ror:2 row_mask:0xf bank_mask:0xf
    s_nop 0
    v_add_f32_dpp v88, v88, v88 row_ror:1 row_mask:0xf bank_mask:0xf
    v_add_f32_dpp v89, v89, v89 row_ror:1 row_mask:0xf bank_mask:0xf
    v_mov_b32 v90, v88
    v_mov_b32 v91, v89
    s_nop 0
    v_permlane16_swap_b32 v88, v90
    v_permlane16_swap_b32 v89, v91
    v_add_f32 v88, v88, v90
    v_add_f32 v89, v89, v91
    v_mov_b32 v90, v88
    v_mov_b32 v91, v89
    s_nop 0
    v_permlane32_swap_b32 v88, v90
    v_permlane32_swap_b32 v89, v91
    v_add_f32 v88, v88, v90
    v_add_f32 v89, v89, v91
    v_mul_f32 v88, 0x3b000000, v88
    v_mul_f32 v89, 0x3b000000, v89
    v_sub_f32 v72, v72, v88
    v_sub_f32 v80, v80, v89
    v_sub_f32 v73, v73, v88
    v_sub_f32 v81, v81, v89
    v_sub_f32 v74, v74, v88
    v_sub_f32 v82, v82, v89
    v_sub_f32 v75, v75, v88
    v_sub_f32 v83, v83, v89
    v_sub_f32 v76, v76, v88
    v_sub_f32 v84, v84, v89
    v_sub_f32 v77, v77, v88
    v_sub_f32 v85, v85, v89
    v_sub_f32 v78, v78, v88
    v_sub_f32 v86, v86, v89
    v_sub_f32 v79, v79, v88
    v_sub_f32 v87, v87, v89
    v_mul_f32 v88, v72, v72
    v_mul_f32 v89, v80, v80
    v_mul_f32 v90, v73, v73
    v_mul_f32 v91, v81, v81
    v_fmac_f32 v88, v74, v74
    v_fmac_f32 v89, v82, v82
    v_fmac_f32 v90, v75, v75
    v_fmac_f32 v91, v83, v83
    v_fmac_f32 v88, v76, v76
    v_fmac_f32 v89, v84, v84
    v_fmac_f32 v90, v77, v77
    v_fmac_f32 v91, v85, v85
    v_fmac_f32 v88, v78, v78
    v_fmac_f32 v89, v86, v86
    v_fmac_f32 v90, v79, v79
    v_fmac_f32 v91, v87, v87
    v_add_f32 v88, v88, v90
    v_add_f32 v89, v89, v91
    s_nop 0
    v_add_f32_dpp v88, v88, v88 row_ror:8 row_mask:0xf bank_mask:0xf
    v_add_f32_dpp v89, v89, v89 row_ror:8 row_mask:0xf bank_mask:0xf
    s_nop 0
    v_add_f32_dpp v88, v88, v88 row_ror:4 row_mask:0xf bank_mask:0xf
    v_add_f32_dpp v89, v89, v89 row_ror:4 row_mask:0xf bank_mask:0xf
    s_nop 0
    v_add_f32_dpp v88, v88, v88 row_ror:2 row_mask:0xf bank_mask:0xf
    v_add_f32_dpp v89, v89, v89 row_ror:2 row_mask:0xf bank_mask:0xf
    s_nop 0
    v_add_f32_dpp v88, v88, v88 row_ror:1 row_mask:0xf bank_mask:0xf
    v_add_f32_dpp v89, v89, v89 row_ror:1 row_mask:0xf bank_mask:0xf
    v_mov_b32 v90, v88
    v_mov_b32 v91, v89
    s_nop 0
    v_permlane16_swap_b32 v88, v90
    v_permlane16_swap_b32 v89, v91
    v_add_f32 v88, v88, v90
    v_add_f32 v89, v89, v91
    v_mov_b32 v90, v88
    v_mov_b32 v91, v89
    s_nop 0
    v_permlane32_swap_b32 v88, v90
    v_permlane32_swap_b32 v89, v91
    v_add_f32 v88, v88, v90
    v_add_f32 v89, v89, v91
    v_mov_b32 v90, 0x3727c5ac
    v_mov_b32 v91, 0x3727c5ac
    v_fmac_f32 v90, 0x3b000000, v88
    v_fmac_f32 v91, 0x3b000000, v89
    v_rsq_f32 v90, v90
    v_rsq_f32 v91, v91
    v_mul_f32 v72, v72, v90
    v_mul_f32 v80, v80, v91
    v_mul_f32 v73, v73, v90
    v_mul_f32 v81, v81, v91
    v_mul_f32 v74, v74, v90
    v_mul_f32 v82, v82, v91
    v_mul_f32 v75, v75, v90
    v_mul_f32 v83, v83, v91
    v_mul_f32 v76, v76, v90
    v_mul_f32 v84, v84, v91
    v_mul_f32 v77, v77, v90
    v_mul_f32 v85, v85, v91
    v_mul_f32 v78, v78, v90
    v_mul_f32 v86, v86, v91
    v_mul_f32 v79, v79, v90
    v_mul_f32 v87, v87, v91
    v_cvt_pk_f16_f32 v92, v72, v73
    v_cvt_pk_f16_f32 v93, v74, v75
    v_cvt_pk_f16_f32 v94, v76, v77
    v_cvt_pk_f16_f32 v95, v78, v79
    v_cvt_pk_f16_f32 v96, v80, v81
    v_cvt_pk_f16_f32 v97, v82, v83
    v_cvt_pk_f16_f32 v98, v84, v85
    v_cvt_pk_f16_f32 v99, v86, v87
    s_lshl_b32 s46, s28, 5
    s_add_u32 s46, s46, 139264
    v_lshlrev_b32 v236, 7, v1
    v_add_u32 v236, s46, v236
    ds_write_b128 v236, v[92:95]
    ds_write_b128 v236, v[96:99] offset:16
    s_mov_b32 s44, 0x05040100
    s_mov_b32 s45, 0x07060302
    v_mov_b32 v228, 0
    v_mov_b32 v229, 0
    v_mov_b32 v230, 0
    v_mov_b32 v231, 0
    v_mov_b32 v232, 0
    v_mov_b32 v233, 0
    v_mov_b32 v234, 0
    v_mov_b32 v235, 0
    s_waitcnt vmcnt(7)
    v_perm_b32 v236, v116, v112, s44
    v_perm_b32 v237, v116, v112, s45
    v_dot2c_f32_bf16 v228, v236, v224
    v_dot2c_f32_bf16 v229, v237, v224
    v_perm_b32 v238, v117, v113, s44
    v_perm_b32 v239, v117, v113, s45
    v_dot2c_f32_bf16 v230, v238, v224
    v_dot2c_f32_bf16 v231, v239, v224
    v_perm_b32 v236, v118, v114, s44
    v_perm_b32 v237, v118, v114, s45
    v_dot2c_f32_bf16 v232, v236, v224
    v_dot2c_f32_bf16 v233, v237, v224
    v_perm_b32 v238, v119, v115, s44
    v_perm_b32 v239, v119, v115, s45
    v_dot2c_f32_bf16 v234, v238, v224
    v_dot2c_f32_bf16 v235, v239, v224
    s_waitcnt vmcnt(5)
    v_perm_b32 v236, v124, v120, s44
    v_perm_b32 v237, v124, v120, s45
    v_dot2c_f32_bf16 v228, v236, v225
    v_dot2c_f32_bf16 v229, v237, v225
    v_perm_b32 v238, v125, v121, s44
    v_perm_b32 v239, v125, v121, s45
    v_dot2c_f32_bf16 v230, v238, v225
    v_dot2c_f32_bf16 v231, v239, v225
    v_perm_b32 v236, v126, v122, s44
    v_perm_b32 v237, v126, v122, s45
    v_dot2c_f32_bf16 v232, v236, v225
    v_dot2c_f32_bf16 v233, v237, v225
    v_perm_b32 v238, v127, v123, s44
    v_perm_b32 v239, v127, v123, s45
    v_dot2c_f32_bf16 v234, v238, v225
    v_dot2c_f32_bf16 v235, v239, v225
    s_waitcnt vmcnt(3)
    v_perm_b32 v236, v132, v128, s44
    v_perm_b32 v237, v132, v128, s45
    v_dot2c_f32_bf16 v228, v236, v226
    v_dot2c_f32_bf16 v229, v237, v226
    v_perm_b32 v238, v133, v129, s44
    v_perm_b32 v239, v133, v129, s45
    v_dot2c_f32_bf16 v230, v238, v226
    v_dot2c_f32_bf16 v231, v239, v226
    v_perm_b32 v236, v134, v130, s44
    v_perm_b32 v237, v134, v130, s45
    v_dot2c_f32_bf16 v232, v236, v226
    v_dot2c_f32_bf16 v233, v237, v226
    v_perm_b32 v238, v135, v131, s44
    v_perm_b32 v239, v135, v131, s45
    v_dot2c_f32_bf16 v234, v238, v226
    v_dot2c_f32_bf16 v235, v239, v226
    s_waitcnt vmcnt(1)
    v_perm_b32 v236, v140, v136, s44
    v_perm_b32 v237, v140, v136, s45
    v_dot2c_f32_bf16 v228, v236, v227
    v_dot2c_f32_bf16 v229, v237, v227
    v_perm_b32 v238, v141, v137, s44
    v_perm_b32 v239, v141, v137, s45
    v_dot2c_f32_bf16 v230, v238, v227
    v_dot2c_f32_bf16 v231, v239, v227
    v_perm_b32 v236, v142, v138, s44
    v_perm_b32 v237, v142, v138, s45
    v_dot2c_f32_bf16 v232, v236, v227
    v_dot2c_f32_bf16 v233, v237, v227
    v_perm_b32 v238, v143, v139, s44
    v_perm_b32 v239, v143, v139, s45
    v_dot2c_f32_bf16 v234, v238, v227
    v_dot2c_f32_bf16 v235, v239, v227
    s_nop 3
    ds_write_b128 v243, v[228:231]
    ds_write_b128 v243, v[232:235] offset:16
    s_waitcnt lgkmcnt(0)
    s_barrier
    v_lshlrev_b32 v236, 4, v0
    v_add_u32 v236, 139264, v236
    ds_read_b128 v[92:95], v236
    ds_read_b128 v[96:99], v236 offset:4096
    ds_read_b32 v144, v244 offset:0
    ds_read_b32 v145, v244 offset:128
    ds_read_b32 v146, v244 offset:256
    ds_read_b32 v147, v244 offset:384
    ds_read_b32 v148, v244 offset:512
    ds_read_b32 v149, v244 offset:640
    ds_read_b32 v150, v244 offset:768
    ds_read_b32 v151, v244 offset:896
    s_lshr_b32 s46, s36, 2
    s_lshl_b32 s46, s46, 15
    s_and_b32 s47, s36, 3
    s_lshl_b32 s47, s47, 7
    s_add_u32 s46, s46, s47
    s_add_u32 s47, s46, 16384
    s_waitcnt lgkmcnt(9)
    buffer_store_dwordx4 v[92:95], v242, s[16:19], s46 offen sc1
    s_waitcnt lgkmcnt(8)
    buffer_store_dwordx4 v[96:99], v242, s[16:19], s47 offen sc1
    s_cmp_ge_u32 s35, 16
    s_cselect_b32 s37, 0x3f800000, 0
    s_mov_b32 s38, 0x3e0293ee
    s_waitcnt lgkmcnt(3)
    v_add_f32 v144, v144, v148
    s_waitcnt lgkmcnt(2)
    v_add_f32 v145, v145, v149
    s_waitcnt lgkmcnt(1)
    v_add_f32 v146, v146, v150
    s_waitcnt lgkmcnt(0)
    v_add_f32 v147, v147, v151
    v_add_f32 v144, v144, v146
    v_add_f32 v145, v145, v147
    v_add_f32 v144, v144, v145
    s_nop 1
    v_add_f32_dpp v144, v144, v144 row_ror:8 row_mask:0xf bank_mask:0xf
    v_mov_b32 v145, v144
    s_nop 1
    v_permlane16_swap_b32 v144, v145
    v_add_f32 v144, v144, v145
    v_mov_b32 v145, v144
    s_nop 1
    v_permlane32_swap_b32 v144, v145
    v_add_f32 v144, v144, v145
    v_cvt_pk_bf16_f32 v144, v144, v144
    v_lshlrev_b32 v144, 16, v144
    v_add_f32 v144, s37, v144
    v_cvt_pk_bf16_f32 v144, v144, v144
    v_lshlrev_b32 v144, 16, v144
    v_mul_f32 v144, s38, v144
    s_lshl_b32 s46, s35, 7
    s_lshl_b32 s47, s28, 5
    s_add_u32 s46, s46, s47
    v_lshlrev_b32 v145, 2, v1
    s_mov_b64 exec, 0xff
    buffer_store_dword v144, v145, s[24:27], s46 offen sc1
    s_mov_b64 exec, -1
    s_lshl_b32 s44, s28, 13
    s_lshl_b32 s45, s28, 18
    s_add_u32 m0, s44, 0
    s_add_u32 s46, s45, 0
    buffer_load_dwordx4 v19, s[4:7], s46 offen offset:0 lds
    s_add_u32 m0, s44, 896
    s_nop 0
    buffer_load_dwordx4 v19, s[4:7], s46 offen offset:128 lds
    s_add_u32 m0, s44, 2048
    s_add_u32 s46, s45, 65536
    buffer_load_dwordx4 v19, s[4:7], s46 offen offset:0 lds
    s_add_u32 m0, s44, 2944
    s_nop 0
    buffer_load_dwordx4 v19, s[4:7], s46 offen offset:128 lds
    s_add_u32 m0, s44, 4096
    s_add_u32 s46, s45, 131072
    buffer_load_dwordx4 v19, s[4:7], s46 offen offset:0 lds
    s_add_u32 m0, s44, 4992
    s_nop 0
    buffer_load_dwordx4 v19, s[4:7], s46 offen offset:128 lds
    s_add_u32 m0, s44, 6144
    s_add_u32 s46, s45, 196608
    buffer_load_dwordx4 v19, s[4:7], s46 offen offset:0 lds
    s_add_u32 m0, s44, 7040
    s_nop 0
    buffer_load_dwordx4 v19, s[4:7], s46 offen offset:128 lds
    s_waitcnt vmcnt(8)
    s_barrier
    s_cmp_lg_u32 s28, 0
    s_cbranch_scc1 L_mg_pub
    s_waitcnt vmcnt(11)
    v_readfirstlane_b32 s46, v252
    v_readfirstlane_b32 s47, v253
    s_and_b32 s38, s2, 31
    s_lshl_b32 s37, s30, 13
    s_lshl_b32 s36, s38, 3
    s_add_u32 s36, s36, s37
    s_cmp_eq_u64 s[46:47], 0
    s_cselect_b64 s[42:43], s[42:43], s[46:47]
    v_lshlrev_b32 v251, 8, v1
    v_mov_b32 v252, s42
    v_mov_b32 v253, s43
    s_mov_b32 exec_hi, 0
    buffer_store_dwordx2 v[252:253], v251, s[20:23], s36 offen sc1
    s_cmp_lg_u32 s2, 0
    s_cbranch_scc1 L_mg_notag
    s_mov_b64 exec, 1
    s_mov_b32 s36, 65536
    buffer_store_dwordx2 v[252:253], v251, s[20:23], s36 offen
L_mg_notag:
    s_mov_b64 exec, -1
L_mg_pub:
    v_mov_b32 v64, 0
    v_mov_b32 v65, 0
    v_mov_b32 v66, 0
    v_mov_b32 v67, 0
    v_mov_b32 v68, 0
    v_mov_b32 v69, 0
    v_mov_b32 v70, 0
    v_mov_b32 v71, 0
    v_mov_b32 v72, 0
    v_mov_b32 v73, 0
    v_mov_b32 v74, 0
    v_mov_b32 v75, 0
    v_mov_b32 v76, 0
    v_mov_b32 v77, 0
    v_mov_b32 v78, 0
    v_mov_b32 v79, 0
    v_mov_b32 v80, 0
    v_mov_b32 v81, 0
    v_mov_b32 v82, 0
    v_mov_b32 v83, 0
    v_mov_b32 v84, 0
    v_mov_b32 v85, 0
    v_mov_b32 v86, 0
    v_mov_b32 v87, 0
    v_mov_b32 v88, 0
    v_mov_b32 v89, 0
    v_mov_b32 v90, 0
    v_mov_b32 v91, 0
    v_mov_b32 v92, 0
    v_mov_b32 v93, 0
    v_mov_b32 v94, 0
    v_mov_b32 v95, 0
    v_mov_b32 v96, 0
    v_mov_b32 v97, 0
    v_mov_b32 v98, 0
    v_mov_b32 v99, 0
    v_mov_b32 v100, 0
    v_mov_b32 v101, 0
    v_mov_b32 v102, 0
    v_mov_b32 v103, 0
    v_mov_b32 v104, 0
    v_mov_b32 v105, 0
    v_mov_b32 v106, 0
    v_mov_b32 v107, 0
    v_mov_b32 v108, 0
    v_mov_b32 v109, 0
    v_mov_b32 v110, 0
    v_mov_b32 v111, 0
    v_mov_b32 v112, 0
    v_mov_b32 v113, 0
    v_mov_b32 v114, 0
    v_mov_b32 v115, 0
    v_mov_b32 v116, 0
    v_mov_b32 v117, 0
    v_mov_b32 v118, 0
    v_mov_b32 v119, 0
    v_mov_b32 v120, 0
    v_mov_b32 v121, 0
    v_mov_b32 v122, 0
    v_mov_b32 v123, 0
    v_mov_b32 v124, 0
    v_mov_b32 v125, 0
    v_mov_b32 v126, 0
    v_mov_b32 v127, 0
    v_mov_b32 v128, 0
    v_mov_b32 v129, 0
    v_mov_b32 v130, 0
    v_mov_b32 v131, 0
    v_mov_b32 v132, 0
    v_mov_b32 v133, 0
    v_mov_b32 v134, 0
    v_mov_b32 v135, 0
    v_mov_b32 v136, 0
    v_mov_b32 v137, 0
    v_mov_b32 v138, 0
    v_mov_b32 v139, 0
    v_mov_b32 v140, 0
    v_mov_b32 v141, 0
    v_mov_b32 v142, 0
    v_mov_b32 v143, 0
    v_mov_b32 v144, 0
    v_mov_b32 v145, 0
    v_mov_b32 v146, 0
    v_mov_b32 v147, 0
    v_mov_b32 v148, 0
    v_mov_b32 v149, 0
    v_mov_b32 v150, 0
    v_mov_b32 v151, 0
    v_mov_b32 v152, 0
    v_mov_b32 v153, 0
    v_mov_b32 v154, 0
    v_mov_b32 v155, 0
    v_mov_b32 v156, 0
    v_mov_b32 v157, 0
    v_mov_b32 v158, 0
    v_mov_b32 v159, 0
    v_mov_b32 v160, 0
    v_mov_b32 v161, 0
    v_mov_b32 v162, 0
    v_mov_b32 v163, 0
    v_mov_b32 v164, 0
    v_mov_b32 v165, 0
    v_mov_b32 v166, 0
    v_mov_b32 v167, 0
    v_mov_b32 v168, 0
    v_mov_b32 v169, 0
    v_mov_b32 v170, 0
    v_mov_b32 v171, 0
    v_mov_b32 v172, 0
    v_mov_b32 v173, 0
    v_mov_b32 v174, 0
    v_mov_b32 v175, 0
    v_mov_b32 v176, 0
    v_mov_b32 v177, 0
    v_mov_b32 v178, 0
    v_mov_b32 v179, 0
    v_mov_b32 v180, 0
    v_mov_b32 v181, 0
    v_mov_b32 v182, 0
    v_mov_b32 v183, 0
    v_mov_b32 v184, 0
    v_mov_b32 v185, 0
    v_mov_b32 v186, 0
    v_mov_b32 v187, 0
    v_mov_b32 v188, 0
    v_mov_b32 v189, 0
    v_mov_b32 v190, 0
    v_mov_b32 v191, 0
    s_lshl_b32 s52, s2, 2
    s_add_u32 s52, s52, s28
    s_lshl_b32 s53, s28, 12
    s_add_u32 s53, s53, 139264
    v_lshrrev_b32 v28, 2, v1
    v_bfe_u32 v29, v1, 1, 1
    v_lshlrev_b32 v29, 6, v29
    v_lshl_add_u32 v20, v28, 10, v29
    v_and_b32 v29, 1, v1
    v_lshl_add_u32 v20, v29, 4, v20
    v_mul_u32_u24 v21, 2752, v28
    v_and_b32 v29, 3, v1
    v_lshl_add_u32 v21, v29, 4, v21
    v_bfe_u32 v28, v1, 4, 1
    v_lshlrev_b32 v22, 10, v28
    v_lshrrev_b32 v28, 5, v1
    v_lshl_add_u32 v22, v28, 9, v22
    v_bfe_u32 v28, v1, 2, 2
    v_lshl_add_u32 v22, v28, 6, v22
    v_and_b32 v28, 1, v1
    v_lshl_add_u32 v22, v28, 4, v22
    v_bfe_u32 v28, v1, 1, 1
    v_lshl_add_u32 v22, v28, 3, v22
    v_lshlrev_b32 v23, 4, v1
    v_add_u32 v22, s53, v22
    v_xor_b32 v22, 2048, v22
    s_add_u32 s72, s54, 0x2000000
    s_addc_u32 s73, s55, 0
    s_mov_b32 s74, 0x808000
    s_mov_b32 s75, 0x00020000
    s_mov_b32 s67, 0x00020000
    s_mov_b32 s71, 0x00020000
    s_mov_b32 s81, 4
    s_cmp_lt_u32 s52, 512
    s_cbranch_scc1 L_k2_rpw
    s_cmp_lt_u32 s52, 856
    s_cbranch_scc1 L_k2_rpg
    s_sub_u32 s52, s52, 856
    s_and_b32 s46, s52, 7
    s_lshr_b32 s47, s52, 3
    s_mov_b64 s[64:65], s[58:59]
    s_mov_b32 s66, 1409024
    s_mov_b32 s77, 344064
    s_mov_b32 s79, 43008
    s_mul_i32 s78, s46, 86
    s_add_u32 s78, s78, s47
    s_lshl_b32 s78, s78, 11
    s_add_u32 s78, s78, 4194304
    s_cmp_lt_u32 s47, 2
    s_cselect_b32 s81, 5, 4
    s_branch L_k2_rpj
L_k2_rpw:
    s_and_b32 s46, s52, 7
    s_lshr_b32 s47, s52, 3
    s_mov_b64 s[64:65], s[56:57]
    s_mov_b32 s66, 4194304
    s_mov_b32 s77, 1048576
    s_mov_b32 s79, 131072
    s_lshl_b32 s78, s46, 8
    s_add_u32 s78, s78, s47
    s_lshl_b32 s78, s78, 11
L_k2_rpj:
    s_lshl_b32 s46, s46, 7
    s_lshl_b32 s76, s47, 14
    s_add_u32 s76, s76, s46
    s_add_u32 s68, s64, 32
    s_addc_u32 s69, s65, 0
    s_sub_u32 s70, s66, 32
    s_mov_b32 s80, 1024
    s_branch L_k2_rpe
L_k2_rpg:
    s_sub_u32 s52, s52, 512
    s_mul_i32 s46, s52, 1525
    s_lshr_b32 s46, s46, 16
    s_mul_i32 s47, s46, 43
    s_sub_u32 s47, s52, s47
    s_mov_b64 s[64:65], s[60:61]
    s_mov_b64 s[68:69], s[62:63]
    s_mov_b32 s66, 1409024
    s_mov_b32 s70, 1409024
    s_mul_i32 s76, s46, 44032
    s_lshl_b32 s77, s47, 6
    s_add_u32 s76, s76, s77
    s_mov_b32 s77, 352256
    s_lshl_b32 s78, s47, 16
    s_lshl_b32 s79, s46, 10
    s_add_u32 s78, s78, s79
    s_add_u32 s78, s78, 5603328
    s_mov_b32 s79, 8192
    s_mov_b32 s80, 32768
    v_mov_b32 v20, v21
L_k2_rpe:
    s_lshl_b32 s46, s79, 1
    s_sub_u32 s78, s78, s46
    s_mov_b32 s57, -2
    v_add_u32 v4, 1024, v5
    v_add_u32 v5, 128, v5
    v_lshrrev_b32 v24, 4, v1
    v_and_b32 v25, 3, v1
    v_xor_b32 v25, v25, v24
    v_and_b32 v26, 12, v1
    v_or_b32 v25, v25, v26
    v_lshlrev_b32 v25, 4, v25
    v_lshl_add_u32 v2, v24, 8, v25
    v_add_u32 v3, 8192, v2
    v_bfe_u32 v24, v1, 3, 2
    v_mul_u32_u24 v6, 2112, v24
    v_and_b32 v24, 7, v1
    v_lshl_add_u32 v6, v24, 8, v6
    v_lshrrev_b32 v24, 5, v1
    v_and_b32 v25, 3, v1
    v_xor_b32 v25, v25, v24
    v_lshl_add_u32 v6, v25, 4, v6
    v_xor_b32 v7, 32, v6
    v_bfe_u32 v25, v1, 2, 2
    v_lshlrev_b32 v26, 7, v25
    v_bfe_u32 v25, v1, 3, 1
    v_lshl_add_u32 v26, v25, 6, v26
    v_bfe_u32 v25, v1, 4, 1
    v_lshl_add_u32 v26, v25, 5, v26
    v_and_b32 v25, 1, v1
    v_lshl_add_u32 v26, v25, 4, v26
    v_bfe_u32 v25, v1, 1, 1
    v_lshl_add_u32 v26, v25, 3, v26
    v_lshl_add_u32 v8, v24, 9, v26
    v_xor_b32 v9, 64, v8
    v_lshl_add_u32 v14, v24, 11, v26
    v_xor_b32 v15, 64, v14
    v_lshlrev_b32 v18, 5, v24
    v_add_u32 v18, 133120, v18
    s_cmp_lg_u32 s28, 0
    s_cbranch_scc1 L_mg_seen
    s_lshl_b32 s38, s38, 8
    s_add_u32 s38, s38, s37
    v_lshlrev_b32 v251, 3, v1
    v_add_u32 v251, s38, v251
    s_mov_b32 exec_hi, 0
    s_mov_b32 s31, 2048
L_mg_poll:
    buffer_load_dwordx2 v[254:255], v251, s[20:23], 0 offen sc1
    s_waitcnt vmcnt(0)
    v_cmp_eq_u64 vcc, s[42:43], v[254:255]
    s_nop 4
    s_cmp_eq_u32 vcc_lo, -1
    s_cbranch_scc1 L_mg_ok
    s_sub_u32 s31, s31, 1
    s_cmp_lg_u32 s31, 0
    s_cbranch_scc1 L_mg_poll
    v_mov_b32 v246, 1
    v_mov_b32 v247, 137504
    ds_write_b32 v247, v246
L_mg_ok:
    s_mov_b64 exec, -1
L_mg_seen:
    s_waitcnt vmcnt(0) lgkmcnt(0)
    s_barrier
L_mg_go:
    v_mov_b32 v25, 137504
    ds_read_b32 v24, v25
    v_lshlrev_b32 v26, 4, v0
    buffer_load_dwordx4 v[60:63], v26, s[24:27], 0 offen sc1
    s_mov_b32 s39, 4096
    buffer_load_dwordx4 v[192:195], v16, s[16:19], 0 offen offset:0 sc1
    buffer_load_dwordx4 v[196:199], v17, s[16:19], 0 offen offset:0 sc1
    buffer_load_dwordx4 v[200:203], v16, s[16:19], 0 offen offset:1024 sc1
    buffer_load_dwordx4 v[204:207], v17, s[16:19], 0 offen offset:1024 sc1
    buffer_load_dwordx4 v[208:211], v16, s[16:19], 0 offen offset:2048 sc1
    buffer_load_dwordx4 v[212:215], v17, s[16:19], 0 offen offset:2048 sc1
    buffer_load_dwordx4 v[216:219], v16, s[16:19], 0 offen offset:3072 sc1
    buffer_load_dwordx4 v[220:223], v17, s[16:19], 0 offen offset:3072 sc1
    buffer_load_dwordx4 v[224:227], v16, s[16:19], s39 offen offset:0 sc1
    buffer_load_dwordx4 v[228:231], v17, s[16:19], s39 offen offset:0 sc1
    buffer_load_dwordx4 v[232:235], v16, s[16:19], s39 offen offset:1024 sc1
    buffer_load_dwordx4 v[236:239], v17, s[16:19], s39 offen offset:1024 sc1
    buffer_load_dwordx4 v[240:243], v16, s[16:19], s39 offen offset:2048 sc1
    buffer_load_dwordx4 v[244:247], v17, s[16:19], s39 offen offset:2048 sc1
    s_waitcnt lgkmcnt(0)
    v_readfirstlane_b32 s46, v24
    s_nop 3
    s_cmp_lg_u32 s46, 0
    s_cbranch_scc1 L_mg_fb
    s_lshl_b32 s44, s28, 13
    s_lshl_b32 s45, s28, 18
    s_add_u32 m0, s44, 33280
    s_add_u32 s46, s45, 1048576
    buffer_load_dwordx4 v19, s[4:7], s46 offen offset:0 lds
    s_add_u32 m0, s44, 34176
    s_nop 0
    buffer_load_dwordx4 v19, s[4:7], s46 offen offset:128 lds
    s_add_u32 m0, s44, 35328
    s_add_u32 s46, s45, 1114112
    buffer_load_dwordx4 v19, s[4:7], s46 offen offset:0 lds
    s_add_u32 m0, s44, 36224
    s_nop 0
    buffer_load_dwordx4 v19, s[4:7], s46 offen offset:128 lds
    s_add_u32 m0, s44, 37376
    s_add_u32 s46, s45, 1179648
    buffer_load_dwordx4 v19, s[4:7], s46 offen offset:0 lds
    s_add_u32 m0, s44, 38272
    s_nop 0
    buffer_load_dwordx4 v19, s[4:7], s46 offen offset:128 lds
    s_add_u32 m0, s44, 39424
    s_add_u32 s46, s45, 1245184
    buffer_load_dwordx4 v19, s[4:7], s46 offen offset:0 lds
    s_add_u32 m0, s44, 40320
    s_nop 0
    buffer_load_dwordx4 v19, s[4:7], s46 offen offset:128 lds
    s_lshl_b32 s46, s29, 19
    s_add_u32 s47, s46, 393216
    s_add_u32 s8, s48, s47
    s_addc_u32 s9, s49, 0
    s_mov_b32 s10, 0x20000
    s_mov_b32 s11, 0x00020000
    s_add_u32 s47, s46, 384000
    s_add_u32 s12, s50, s47
    s_addc_u32 s13, s51, 0
    s_mov_b32 s14, 0x22400
    s_mov_b32 s15, 0x00020000
    s_add_u32 s20, s54, 0x400000
    s_addc_u32 s21, s55, 0
    s_mov_b32 s22, 0x1000000
    s_mov_b32 s23, 0x00020000
    s_mul_i32 s42, s28, 2112
    s_lshl_b32 s43, s28, 11
    s_mov_b32 s41, s43
    s_add_u32 s43, s43, 16896
    s_mov_b32 s33, 0
    s_mov_b32 s39, 7168
    s_mov_b32 s40, 11264
    s_mov_b32 s45, 0
    v_add_u32 v26, 133120, v26
    s_waitcnt vmcnt(22)
    ds_write_b128 v26, v[60:63]
    s_waitcnt lgkmcnt(0)
    s_barrier
    ds_read_b128 v[32:35], v18 offset:2048
    ds_read_b128 v[36:39], v18 offset:2064
    ds_read_b128 v[40:43], v18 offset:0
    ds_read_b128 v[44:47], v18 offset:16
    ds_read_b128 v[48:51], v18 offset:2112
    ds_read_b128 v[52:55], v18 offset:2128
    ds_read_b128 v[56:59], v18 offset:64
    ds_read_b128 v[60:63], v18 offset:80
    ds_read_b64_tr_b16 a[128:129], v14 offset:0
    ds_read_b64_tr_b16 a[130:131], v14 offset:512
    ds_read_b64_tr_b16 a[132:133], v15 offset:0
    ds_read_b64_tr_b16 a[134:135], v15 offset:512
    ds_read_b64_tr_b16 a[136:137], v14 offset:1024
    ds_read_b64_tr_b16 a[138:139], v14 offset:1536
    s_waitcnt vmcnt(21) lgkmcnt(11)
    v_fma_mix_f32 v24, v192, v32, v40 op_sel_hi:[1,0,0]
    v_fma_mix_f32 v25, v192, v33, v41 op_sel:[1,0,0] op_sel_hi:[1,0,0]
    v_cvt_pk_bf16_f32 v192, v24, v25
    v_fma_mix_f32 v26, v193, v34, v42 op_sel_hi:[1,0,0]
    v_fma_mix_f32 v27, v193, v35, v43 op_sel:[1,0,0] op_sel_hi:[1,0,0]
    v_cvt_pk_bf16_f32 v193, v26, v27
    s_waitcnt lgkmcnt(10)
    v_fma_mix_f32 v28, v194, v36, v44 op_sel_hi:[1,0,0]
    v_fma_mix_f32 v29, v194, v37, v45 op_sel:[1,0,0] op_sel_hi:[1,0,0]
    v_cvt_pk_bf16_f32 v194, v28, v29
    v_fma_mix_f32 v30, v195, v38, v46 op_sel_hi:[1,0,0]
    v_fma_mix_f32 v31, v195, v39, v47 op_sel:[1,0,0] op_sel_hi:[1,0,0]
    v_cvt_pk_bf16_f32 v195, v30, v31
    s_waitcnt vmcnt(20)
    v_fma_mix_f32 v24, v196, v32, v40 op_sel_hi:[1,0,0]
    v_fma_mix_f32 v25, v196, v33, v41 op_sel:[1,0,0] op_sel_hi:[1,0,0]
    v_cvt_pk_bf16_f32 v196, v24, v25
    v_fma_mix_f32 v26, v197, v34, v42 op_sel_hi:[1,0,0]
    v_fma_mix_f32 v27, v197, v35, v43 op_sel:[1,0,0] op_sel_hi:[1,0,0]
    v_cvt_pk_bf16_f32 v197, v26, v27
    v_fma_mix_f32 v28, v198, v36, v44 op_sel_hi:[1,0,0]
    v_fma_mix_f32 v29, v198, v37, v45 op_sel:[1,0,0] op_sel_hi:[1,0,0]
    v_cvt_pk_bf16_f32 v198, v28, v29
    v_fma_mix_f32 v30, v199, v38, v46 op_sel_hi:[1,0,0]
    v_fma_mix_f32 v31, v199, v39, v47 op_sel:[1,0,0] op_sel_hi:[1,0,0]
    v_cvt_pk_bf16_f32 v199, v30, v31
    s_mov_b32 s31, 2
    s_lshl_b32 s37, s28, 13
    s_add_u32 s37, s37, 66560
    s_lshl_b32 s36, s28, 18
    s_add_u32 s36, s36, 2097152
L_k2_q1:
    s_waitcnt lgkmcnt(4)
    v_mfma_f32_32x32x16_bf16 v[64:79], a[128:131], v[192:195], v[64:79]
    ds_read_b64_tr_b16 a[140:141], v15 offset:1024
    ds_read_b64_tr_b16 a[142:143], v15 offset:1536
    s_waitcnt vmcnt(16) lgkmcnt(5)
    v_fma_mix_f32 v24, v200, v48, v56 op_sel_hi:[1,0,0]
    v_fma_mix_f32 v25, v200, v49, v57 op_sel:[1,0,0] op_sel_hi:[1,0,0]
    v_cvt_pk_bf16_f32 v200, v24, v25
    v_mfma_f32_32x32x16_bf16 v[80:95], a[128:131], v[196:199], v[80:95]
    v_fma_mix_f32 v26, v201, v50, v58 op_sel_hi:[1,0,0]
    v_fma_mix_f32 v27, v201, v51, v59 op_sel:[1,0,0] op_sel_hi:[1,0,0]
    v_cvt_pk_bf16_f32 v201, v26, v27
    ds_read_b128 v[32:35], v18 offset:2176
    s_waitcnt lgkmcnt(5)
    v_mfma_f32_32x32x16_bf16 v[96:111], a[132:135], v[192:195], v[96:111]
    ds_read_b64_tr_b16 a[144:145], v14 offset:4096
    ds_read_b64_tr_b16 a[146:147], v14 offset:4608
    s_waitcnt lgkmcnt(5)
    v_fma_mix_f32 v28, v202, v52, v60 op_sel_hi:[1,0,0]
    v_fma_mix_f32 v29, v202, v53, v61 op_sel:[1,0,0] op_sel_hi:[1,0,0]
    v_cvt_pk_bf16_f32 v202, v28, v29
    buffer_load_dwordx4 v[248:251], v16, s[16:19], s39 offen offset:0 sc1
    v_mfma_f32_32x32x16_bf16 v[112:127], a[132:135], v[196:199], v[112:127]
    v_fma_mix_f32 v30, v203, v54, v62 op_sel_hi:[1,0,0]
    v_fma_mix_f32 v31, v203, v55, v63 op_sel:[1,0,0] op_sel_hi:[1,0,0]
    v_cvt_pk_bf16_f32 v203, v30, v31
    ds_read_b128 v[36:39], v18 offset:2192
    s_add_u32 m0, s37, 0
    s_add_u32 s35, s36, 0
    s_waitcnt lgkmcnt(6)
    v_mfma_f32_32x32x16_bf16 v[128:143], a[136:139], v[192:195], v[128:143]
    ds_read_b64_tr_b16 a[148:149], v15 offset:4096
    ds_read_b64_tr_b16 a[150:151], v15 offset:4608
    s_waitcnt vmcnt(16)
    v_fma_mix_f32 v24, v204, v48, v56 op_sel_hi:[1,0,0]
    v_fma_mix_f32 v25, v204, v49, v57 op_sel:[1,0,0] op_sel_hi:[1,0,0]
    v_cvt_pk_bf16_f32 v204, v24, v25
    buffer_load_dwordx4 v19, s[4:7], s35 offen offset:0 lds
    v_mfma_f32_32x32x16_bf16 v[144:159], a[136:139], v[196:199], v[144:159]
    v_fma_mix_f32 v26, v205, v50, v58 op_sel_hi:[1,0,0]
    v_fma_mix_f32 v27, v205, v51, v59 op_sel:[1,0,0] op_sel_hi:[1,0,0]
    v_cvt_pk_bf16_f32 v205, v26, v27
    ds_read_b128 v[40:43], v18 offset:128
    s_waitcnt lgkmcnt(7)
    v_mfma_f32_32x32x16_bf16 v[160:175], a[140:143], v[192:195], v[160:175]
    ds_read_b64_tr_b16 a[152:153], v14 offset:5120
    ds_read_b64_tr_b16 a[154:155], v14 offset:5632
    v_fma_mix_f32 v28, v206, v52, v60 op_sel_hi:[1,0,0]
    v_fma_mix_f32 v29, v206, v53, v61 op_sel:[1,0,0] op_sel_hi:[1,0,0]
    v_cvt_pk_bf16_f32 v206, v28, v29
    buffer_load_dwordx4 v[252:255], v17, s[16:19], s39 offen offset:0 sc1
    v_mfma_f32_32x32x16_bf16 v[176:191], a[140:143], v[196:199], v[176:191]
    v_fma_mix_f32 v30, v207, v54, v62 op_sel_hi:[1,0,0]
    v_fma_mix_f32 v31, v207, v55, v63 op_sel:[1,0,0] op_sel_hi:[1,0,0]
    v_cvt_pk_bf16_f32 v207, v30, v31
    ds_read_b128 v[44:47], v18 offset:144
    s_waitcnt lgkmcnt(7)
    v_mfma_f32_32x32x16_bf16 v[64:79], a[144:147], v[200:203], v[64:79]
    ds_read_b64_tr_b16 a[156:157], v15 offset:5120
    ds_read_b64_tr_b16 a[158:159], v15 offset:5632
    s_waitcnt vmcnt(16) lgkmcnt(5)
    v_fma_mix_f32 v24, v208, v32, v40 op_sel_hi:[1,0,0]
    v_fma_mix_f32 v25, v208, v33, v41 op_sel:[1,0,0] op_sel_hi:[1,0,0]
    v_cvt_pk_bf16_f32 v208, v24, v25
    v_mfma_f32_32x32x16_bf16 v[80:95], a[144:147], v[204:207], v[80:95]
    v_fma_mix_f32 v26, v209, v34, v42 op_sel_hi:[1,0,0]
    v_fma_mix_f32 v27, v209, v35, v43 op_sel:[1,0,0] op_sel_hi:[1,0,0]
    v_cvt_pk_bf16_f32 v209, v26, v27
    ds_read_b128 v[48:51], v18 offset:2240
    s_add_u32 m0, s37, 896
    v_mfma_f32_32x32x16_bf16 v[96:111], a[148:151], v[200:203], v[96:111]
    ds_read_b64_tr_b16 a[128:129], v14 offset:8192
    ds_read_b64_tr_b16 a[130:131], v14 offset:8704
    s_waitcnt lgkmcnt(5)
    v_fma_mix_f32 v28, v210, v36, v44 op_sel_hi:[1,0,0]
    v_fma_mix_f32 v29, v210, v37, v45 op_sel:[1,0,0] op_sel_hi:[1,0,0]
    v_cvt_pk_bf16_f32 v210, v28, v29
    buffer_load_dwordx4 v[192:195], v16, s[16:19], s39 offen offset:1024 sc1
    buffer_load_dwordx4 v19, s[4:7], s35 offen offset:128 lds
    v_mfma_f32_32x32x16_bf16 v[112:127], a[148:151], v[204:207], v[112:127]
    v_fma_mix_f32 v30, v211, v38, v46 op_sel_hi:[1,0,0]
    v_fma_mix_f32 v31, v211, v39, v47 op_sel:[1,0,0] op_sel_hi:[1,0,0]
    v_cvt_pk_bf16_f32 v211, v30, v31
    ds_read_b128 v[52:55], v18 offset:2256
    v_mfma_f32_32x32x16_bf16 v[128:143], a[152:155], v[200:203], v[128:143]
    ds_read_b64_tr_b16 a[132:133], v15 offset:8192
    ds_read_b64_tr_b16 a[134:135], v15 offset:8704
    s_waitcnt vmcnt(16)
    v_fma_mix_f32 v24, v212, v32, v40 op_sel_hi:[1,0,0]
    v_fma_mix_f32 v25, v212, v33, v41 op_sel:[1,0,0] op_sel_hi:[1,0,0]
    v_cvt_pk_bf16_f32 v212, v24, v25
    v_mfma_f32_32x32x16_bf16 v[144:159], a[152:155], v[204:207], v[144:159]
    v_fma_mix_f32 v26, v213, v34, v42 op_sel_hi:[1,0,0]
    v_fma_mix_f32 v27, v213, v35, v43 op_sel:[1,0,0] op_sel_hi:[1,0,0]
    v_cvt_pk_bf16_f32 v213, v26, v27
    ds_read_b128 v[56:59], v18 offset:192
    s_waitcnt lgkmcnt(7)
    v_mfma_f32_32x32x16_bf16 v[160:175], a[156:159], v[200:203], v[160:175]
    ds_read_b64_tr_b16 a[136:137], v14 offset:9216
    ds_read_b64_tr_b16 a[138:139], v14 offset:9728
    v_fma_mix_f32 v28, v214, v36, v44 op_sel_hi:[1,0,0]
    v_fma_mix_f32 v29, v214, v37, v45 op_sel:[1,0,0] op_sel_hi:[1,0,0]
    v_cvt_pk_bf16_f32 v214, v28, v29
    buffer_load_dwordx4 v[196:199], v17, s[16:19], s39 offen offset:1024 sc1
    v_mfma_f32_32x32x16_bf16 v[176:191], a[156:159], v[204:207], v[176:191]
    v_fma_mix_f32 v30, v215, v38, v46 op_sel_hi:[1,0,0]
    v_fma_mix_f32 v31, v215, v39, v47 op_sel:[1,0,0] op_sel_hi:[1,0,0]
    v_cvt_pk_bf16_f32 v215, v30, v31
    ds_read_b128 v[60:63], v18 offset:208
    s_add_u32 m0, s37, 2048
    s_add_u32 s35, s36, 65536
    s_waitcnt lgkmcnt(7)
    v_mfma_f32_32x32x16_bf16 v[64:79], a[128:131], v[208:211], v[64:79]
    ds_read_b64_tr_b16 a[140:141], v15 offset:9216
    ds_read_b64_tr_b16 a[142:143], v15 offset:9728
    s_waitcnt vmcnt(16) lgkmcnt(5)
    v_fma_mix_f32 v24, v216, v48, v56 op_sel_hi:[1,0,0]
    v_fma_mix_f32 v25, v216, v49, v57 op_sel:[1,0,0] op_sel_hi:[1,0,0]
    v_cvt_pk_bf16_f32 v216, v24, v25
    buffer_load_dwordx4 v19, s[4:7], s35 offen offset:0 lds
    v_mfma_f32_32x32x16_bf16 v[80:95], a[128:131], v[212:215], v[80:95]
    v_fma_mix_f32 v26, v217, v50, v58 op_sel_hi:[1,0,0]
    v_fma_mix_f32 v27, v217, v51, v59 op_sel:[1,0,0] op_sel_hi:[1,0,0]
    v_cvt_pk_bf16_f32 v217, v26, v27
    ds_read_b128 v[32:35], v18 offset:2304
    v_mfma_f32_32x32x16_bf16 v[96:111], a[132:135], v[208:211], v[96:111]
    ds_read_b64_tr_b16 a[144:145], v14 offset:12288
    ds_read_b64_tr_b16 a[146:147], v14 offset:12800
    s_waitcnt lgkmcnt(5)
    v_fma_mix_f32 v28, v218, v52, v60 op_sel_hi:[1,0,0]
    v_fma_mix_f32 v29, v218, v53, v61 op_sel:[1,0,0] op_sel_hi:[1,0,0]
    v_cvt_pk_bf16_f32 v218, v28, v29
    buffer_load_dwordx4 v[200:203], v16, s[16:19], s39 offen offset:2048 sc1
    v_mfma_f32_32x32x16_bf16 v[112:127], a[132:135], v[212:215], v[112:127]
    v_fma_mix_f32 v30, v219, v54, v62 op_sel_hi:[1,0,0]
    v_fma_mix_f32 v31, v219, v55, v63 op_sel:[1,0,0] op_sel_hi:[1,0,0]
    v_cvt_pk_bf16_f32 v219, v30, v31
    ds_read_b128 v[36:39], v18 offset:2320
    v_mfma_f32_32x32x16_bf16 v[128:143], a[136:139], v[208:211], v[128:143]
    ds_read_b64_tr_b16 a[148:149], v15 offset:12288
    ds_read_b64_tr_b16 a[150:151], v15 offset:12800
    s_waitcnt vmcnt(16)
    v_fma_mix_f32 v24, v220, v48, v56 op_sel_hi:[1,0,0]
    v_fma_mix_f32 v25, v220, v49, v57 op_sel:[1,0,0] op_sel_hi:[1,0,0]
    v_cvt_pk_bf16_f32 v220, v24, v25
    v_mfma_f32_32x32x16_bf16 v[144:159], a[136:139], v[212:215], v[144:159]
    v_fma_mix_f32 v26, v221, v50, v58 op_sel_hi:[1,0,0]
    v_fma_mix_f32 v27, v221, v51, v59 op_sel:[1,0,0] op_sel_hi:[1,0,0]
    v_cvt_pk_bf16_f32 v221, v26, v27
    ds_read_b128 v[40:43], v18 offset:256
    s_add_u32 m0, s37, 2944
    s_waitcnt lgkmcnt(7)
    v_mfma_f32_32x32x16_bf16 v[160:175], a[140:143], v[208:211], v[160:175]
    ds_read_b64_tr_b16 a[152:153], v14 offset:13312
    ds_read_b64_tr_b16 a[154:155], v14 offset:13824
    v_fma_mix_f32 v28, v222, v52, v60 op_sel_hi:[1,0,0]
    v_fma_mix_f32 v29, v222, v53, v61 op_sel:[1,0,0] op_sel_hi:[1,0,0]
    v_cvt_pk_bf16_f32 v222, v28, v29
    buffer_load_dwordx4 v[204:207], v17, s[16:19], s39 offen offset:2048 sc1
    buffer_load_dwordx4 v19, s[4:7], s35 offen offset:128 lds
    v_mfma_f32_32x32x16_bf16 v[176:191], a[140:143], v[212:215], v[176:191]
    v_fma_mix_f32 v30, v223, v54, v62 op_sel_hi:[1,0,0]
    v_fma_mix_f32 v31, v223, v55, v63 op_sel:[1,0,0] op_sel_hi:[1,0,0]
    v_cvt_pk_bf16_f32 v223, v30, v31
    ds_read_b128 v[44:47], v18 offset:272
    s_waitcnt lgkmcnt(7)
    v_mfma_f32_32x32x16_bf16 v[64:79], a[144:147], v[216:219], v[64:79]
    ds_read_b64_tr_b16 a[156:157], v15 offset:13312
    ds_read_b64_tr_b16 a[158:159], v15 offset:13824
    s_waitcnt vmcnt(16) lgkmcnt(5)
    v_fma_mix_f32 v24, v224, v32, v40 op_sel_hi:[1,0,0]
    v_fma_mix_f32 v25, v224, v33, v41 op_sel:[1,0,0] op_sel_hi:[1,0,0]
    v_cvt_pk_bf16_f32 v224, v24, v25
    v_mfma_f32_32x32x16_bf16 v[80:95], a[144:147], v[220:223], v[80:95]
    v_fma_mix_f32 v26, v225, v34, v42 op_sel_hi:[1,0,0]
    v_fma_mix_f32 v27, v225, v35, v43 op_sel:[1,0,0] op_sel_hi:[1,0,0]
    v_cvt_pk_bf16_f32 v225, v26, v27
    ds_read_b128 v[48:51], v18 offset:2368
    v_mfma_f32_32x32x16_bf16 v[96:111], a[148:151], v[216:219], v[96:111]
    ds_read_b64_tr_b16 a[128:129], v14 offset:16384
    ds_read_b64_tr_b16 a[130:131], v14 offset:16896
    s_waitcnt lgkmcnt(5)
    v_fma_mix_f32 v28, v226, v36, v44 op_sel_hi:[1,0,0]
    v_fma_mix_f32 v29, v226, v37, v45 op_sel:[1,0,0] op_sel_hi:[1,0,0]
    v_cvt_pk_bf16_f32 v226, v28, v29
    buffer_load_dwordx4 v[208:211], v16, s[16:19], s39 offen offset:3072 sc1
    v_mfma_f32_32x32x16_bf16 v[112:127], a[148:151], v[220:223], v[112:127]
    v_fma_mix_f32 v30, v227, v38, v46 op_sel_hi:[1,0,0]
    v_fma_mix_f32 v31, v227, v39, v47 op_sel:[1,0,0] op_sel_hi:[1,0,0]
    v_cvt_pk_bf16_f32 v227, v30, v31
    ds_read_b128 v[52:55], v18 offset:2384
    s_add_u32 m0, s37, 4096
    s_add_u32 s35, s36, 131072
    v_mfma_f32_32x32x16_bf16 v[128:143], a[152:155], v[216:219], v[128:143]
    ds_read_b64_tr_b16 a[132:133], v15 offset:16384
    ds_read_b64_tr_b16 a[134:135], v15 offset:16896
    s_waitcnt vmcnt(16)
    v_fma_mix_f32 v24, v228, v32, v40 op_sel_hi:[1,0,0]
    v_fma_mix_f32 v25, v228, v33, v41 op_sel:[1,0,0] op_sel_hi:[1,0,0]
    v_cvt_pk_bf16_f32 v228, v24, v25
    buffer_load_dwordx4 v19, s[4:7], s35 offen offset:0 lds
    v_mfma_f32_32x32x16_bf16 v[144:159], a[152:155], v[220:223], v[144:159]
    v_fma_mix_f32 v26, v229, v34, v42 op_sel_hi:[1,0,0]
    v_fma_mix_f32 v27, v229, v35, v43 op_sel:[1,0,0] op_sel_hi:[1,0,0]
    v_cvt_pk_bf16_f32 v229, v26, v27
    ds_read_b128 v[56:59], v18 offset:320
    s_waitcnt lgkmcnt(7)
    v_mfma_f32_32x32x16_bf16 v[160:175], a[156:159], v[216:219], v[160:175]
    ds_read_b64_tr_b16 a[136:137], v14 offset:17408
    ds_read_b64_tr_b16 a[138:139], v14 offset:17920
    v_fma_mix_f32 v28, v230, v36, v44 op_sel_hi:[1,0,0]
    v_fma_mix_f32 v29, v230, v37, v45 op_sel:[1,0,0] op_sel_hi:[1,0,0]
    v_cvt_pk_bf16_f32 v230, v28, v29
    buffer_load_dwordx4 v[212:215], v17, s[16:19], s39 offen offset:3072 sc1
    v_mfma_f32_32x32x16_bf16 v[176:191], a[156:159], v[220:223], v[176:191]
    v_fma_mix_f32 v30, v231, v38, v46 op_sel_hi:[1,0,0]
    v_fma_mix_f32 v31, v231, v39, v47 op_sel:[1,0,0] op_sel_hi:[1,0,0]
    v_cvt_pk_bf16_f32 v231, v30, v31
    ds_read_b128 v[60:63], v18 offset:336
    s_waitcnt lgkmcnt(7)
    v_mfma_f32_32x32x16_bf16 v[64:79], a[128:131], v[224:227], v[64:79]
    ds_read_b64_tr_b16 a[140:141], v15 offset:17408
    ds_read_b64_tr_b16 a[142:143], v15 offset:17920
    s_waitcnt vmcnt(16) lgkmcnt(5)
    v_fma_mix_f32 v24, v232, v48, v56 op_sel_hi:[1,0,0]
    v_fma_mix_f32 v25, v232, v49, v57 op_sel:[1,0,0] op_sel_hi:[1,0,0]
    v_cvt_pk_bf16_f32 v232, v24, v25
    v_mfma_f32_32x32x16_bf16 v[80:95], a[128:131], v[228:231], v[80:95]
    v_fma_mix_f32 v26, v233, v50, v58 op_sel_hi:[1,0,0]
    v_fma_mix_f32 v27, v233, v51, v59 op_sel:[1,0,0] op_sel_hi:[1,0,0]
    v_cvt_pk_bf16_f32 v233, v26, v27
    ds_read_b128 v[32:35], v18 offset:2432
    s_add_u32 m0, s37, 4992
    v_mfma_f32_32x32x16_bf16 v[96:111], a[132:135], v[224:227], v[96:111]
    ds_read_b64_tr_b16 a[144:145], v14 offset:20480
    ds_read_b64_tr_b16 a[146:147], v14 offset:20992
    s_waitcnt lgkmcnt(5)
    v_fma_mix_f32 v28, v234, v52, v60 op_sel_hi:[1,0,0]
    v_fma_mix_f32 v29, v234, v53, v61 op_sel:[1,0,0] op_sel_hi:[1,0,0]
    v_cvt_pk_bf16_f32 v234, v28, v29
    buffer_load_dwordx4 v[216:219], v16, s[16:19], s40 offen offset:0 sc1
    buffer_load_dwordx4 v19, s[4:7], s35 offen offset:128 lds
    v_mfma_f32_32x32x16_bf16 v[112:127], a[132:135], v[228:231], v[112:127]
    v_fma_mix_f32 v30, v235, v54, v62 op_sel_hi:[1,0,0]
    v_fma_mix_f32 v31, v235, v55, v63 op_sel:[1,0,0] op_sel_hi:[1,0,0]
    v_cvt_pk_bf16_f32 v235, v30, v31
    ds_read_b128 v[36:39], v18 offset:2448
    v_mfma_f32_32x32x16_bf16 v[128:143], a[136:139], v[224:227], v[128:143]
    ds_read_b64_tr_b16 a[148:149], v15 offset:20480
    ds_read_b64_tr_b16 a[150:151], v15 offset:20992
    s_waitcnt vmcnt(17)
    v_fma_mix_f32 v24, v236, v48, v56 op_sel_hi:[1,0,0]
    v_fma_mix_f32 v25, v236, v49, v57 op_sel:[1,0,0] op_sel_hi:[1,0,0]
    v_cvt_pk_bf16_f32 v236, v24, v25
    v_mfma_f32_32x32x16_bf16 v[144:159], a[136:139], v[228:231], v[144:159]
    v_fma_mix_f32 v26, v237, v50, v58 op_sel_hi:[1,0,0]
    v_fma_mix_f32 v27, v237, v51, v59 op_sel:[1,0,0] op_sel_hi:[1,0,0]
    v_cvt_pk_bf16_f32 v237, v26, v27
    ds_read_b128 v[40:43], v18 offset:384
    s_waitcnt lgkmcnt(7)
    v_mfma_f32_32x32x16_bf16 v[160:175], a[140:143], v[224:227], v[160:175]
    ds_read_b64_tr_b16 a[152:153], v14 offset:21504
    ds_read_b64_tr_b16 a[154:155], v14 offset:22016
    v_fma_mix_f32 v28, v238, v52, v60 op_sel_hi:[1,0,0]
    v_fma_mix_f32 v29, v238, v53, v61 op_sel:[1,0,0] op_sel_hi:[1,0,0]
    v_cvt_pk_bf16_f32 v238, v28, v29
    buffer_load_dwordx4 v[220:223], v17, s[16:19], s40 offen offset:0 sc1
    v_mfma_f32_32x32x16_bf16 v[176:191], a[140:143], v[228:231], v[176:191]
    v_fma_mix_f32 v30, v239, v54, v62 op_sel_hi:[1,0,0]
    v_fma_mix_f32 v31, v239, v55, v63 op_sel:[1,0,0] op_sel_hi:[1,0,0]
    v_cvt_pk_bf16_f32 v239, v30, v31
    ds_read_b128 v[44:47], v18 offset:400
    s_add_u32 m0, s37, 6144
    s_add_u32 s35, s36, 196608
    s_waitcnt lgkmcnt(7)
    v_mfma_f32_32x32x16_bf16 v[64:79], a[144:147], v[232:235], v[64:79]
    ds_read_b64_tr_b16 a[156:157], v15 offset:21504
    ds_read_b64_tr_b16 a[158:159], v15 offset:22016
    s_waitcnt vmcnt(17) lgkmcnt(5)
    v_fma_mix_f32 v24, v240, v32, v40 op_sel_hi:[1,0,0]
    v_fma_mix_f32 v25, v240, v33, v41 op_sel:[1,0,0] op_sel_hi:[1,0,0]
    v_cvt_pk_bf16_f32 v240, v24, v25
    buffer_load_dwordx4 v19, s[4:7], s35 offen offset:0 lds
    v_mfma_f32_32x32x16_bf16 v[80:95], a[144:147], v[236:239], v[80:95]
    v_fma_mix_f32 v26, v241, v34, v42 op_sel_hi:[1,0,0]
    v_fma_mix_f32 v27, v241, v35, v43 op_sel:[1,0,0] op_sel_hi:[1,0,0]
    v_cvt_pk_bf16_f32 v241, v26, v27
    ds_read_b128 v[48:51], v18 offset:2496
    v_mfma_f32_32x32x16_bf16 v[96:111], a[148:151], v[232:235], v[96:111]
    ds_read_b64_tr_b16 a[128:129], v14 offset:24576
    ds_read_b64_tr_b16 a[130:131], v14 offset:25088
    s_waitcnt lgkmcnt(5)
    v_fma_mix_f32 v28, v242, v36, v44 op_sel_hi:[1,0,0]
    v_fma_mix_f32 v29, v242, v37, v45 op_sel:[1,0,0] op_sel_hi:[1,0,0]
    v_cvt_pk_bf16_f32 v242, v28, v29
    buffer_load_dwordx4 v[224:227], v16, s[16:19], s40 offen offset:1024 sc1
    v_mfma_f32_32x32x16_bf16 v[112:127], a[148:151], v[236:239], v[112:127]
    v_fma_mix_f32 v30, v243, v38, v46 op_sel_hi:[1,0,0]
    v_fma_mix_f32 v31, v243, v39, v47 op_sel:[1,0,0] op_sel_hi:[1,0,0]
    v_cvt_pk_bf16_f32 v243, v30, v31
    ds_read_b128 v[52:55], v18 offset:2512
    v_mfma_f32_32x32x16_bf16 v[128:143], a[152:155], v[232:235], v[128:143]
    ds_read_b64_tr_b16 a[132:133], v15 offset:24576
    ds_read_b64_tr_b16 a[134:135], v15 offset:25088
    s_waitcnt vmcnt(18)
    v_fma_mix_f32 v24, v244, v32, v40 op_sel_hi:[1,0,0]
    v_fma_mix_f32 v25, v244, v33, v41 op_sel:[1,0,0] op_sel_hi:[1,0,0]
    v_cvt_pk_bf16_f32 v244, v24, v25
    v_mfma_f32_32x32x16_bf16 v[144:159], a[152:155], v[236:239], v[144:159]
    v_fma_mix_f32 v26, v245, v34, v42 op_sel_hi:[1,0,0]
    v_fma_mix_f32 v27, v245, v35, v43 op_sel:[1,0,0] op_sel_hi:[1,0,0]
    v_cvt_pk_bf16_f32 v245, v26, v27
    ds_read_b128 v[56:59], v18 offset:448
    s_add_u32 m0, s37, 7040
    s_waitcnt lgkmcnt(7)
    v_mfma_f32_32x32x16_bf16 v[160:175], a[156:159], v[232:235], v[160:175]
    ds_read_b64_tr_b16 a[136:137], v14 offset:25600
    ds_read_b64_tr_b16 a[138:139], v14 offset:26112
    v_fma_mix_f32 v28, v246, v36, v44 op_sel_hi:[1,0,0]
    v_fma_mix_f32 v29, v246, v37, v45 op_sel:[1,0,0] op_sel_hi:[1,0,0]
    v_cvt_pk_bf16_f32 v246, v28, v29
    buffer_load_dwordx4 v[228:231], v17, s[16:19], s40 offen offset:1024 sc1
    buffer_load_dwordx4 v19, s[4:7], s35 offen offset:128 lds
    v_mfma_f32_32x32x16_bf16 v[176:191], a[156:159], v[236:239], v[176:191]
    v_fma_mix_f32 v30, v247, v38, v46 op_sel_hi:[1,0,0]
    v_fma_mix_f32 v31, v247, v39, v47 op_sel:[1,0,0] op_sel_hi:[1,0,0]
    v_cvt_pk_bf16_f32 v247, v30, v31
    ds_read_b128 v[60:63], v18 offset:464
    s_waitcnt lgkmcnt(7)
    v_mfma_f32_32x32x16_bf16 v[64:79], a[128:131], v[240:243], v[64:79]
    ds_read_b64_tr_b16 a[140:141], v15 offset:25600
    ds_read_b64_tr_b16 a[142:143], v15 offset:26112
    s_waitcnt vmcnt(19) lgkmcnt(5)
    v_fma_mix_f32 v24, v248, v48, v56 op_sel_hi:[1,0,0]
    v_fma_mix_f32 v25, v248, v49, v57 op_sel:[1,0,0] op_sel_hi:[1,0,0]
    v_cvt_pk_bf16_f32 v248, v24, v25
    v_mfma_f32_32x32x16_bf16 v[80:95], a[128:131], v[244:247], v[80:95]
    v_fma_mix_f32 v26, v249, v50, v58 op_sel_hi:[1,0,0]
    v_fma_mix_f32 v27, v249, v51, v59 op_sel:[1,0,0] op_sel_hi:[1,0,0]
    v_cvt_pk_bf16_f32 v249, v26, v27
    ds_read_b128 v[32:35], v18 offset:2560
    v_mfma_f32_32x32x16_bf16 v[96:111], a[132:135], v[240:243], v[96:111]
    ds_read_b64_tr_b16 a[144:145], v14 offset:28672
    ds_read_b64_tr_b16 a[146:147], v14 offset:29184
    s_waitcnt lgkmcnt(5)
    v_fma_mix_f32 v28, v250, v52, v60 op_sel_hi:[1,0,0]
    v_fma_mix_f32 v29, v250, v53, v61 op_sel:[1,0,0] op_sel_hi:[1,0,0]
    v_cvt_pk_bf16_f32 v250, v28, v29
    buffer_load_dwordx4 v[232:235], v16, s[16:19], s40 offen offset:2048 sc1
    v_mfma_f32_32x32x16_bf16 v[112:127], a[132:135], v[244:247], v[112:127]
    v_fma_mix_f32 v30, v251, v54, v62 op_sel_hi:[1,0,0]
    v_fma_mix_f32 v31, v251, v55, v63 op_sel:[1,0,0] op_sel_hi:[1,0,0]
    v_cvt_pk_bf16_f32 v251, v30, v31
    ds_read_b128 v[36:39], v18 offset:2576
    v_mfma_f32_32x32x16_bf16 v[128:143], a[136:139], v[240:243], v[128:143]
    ds_read_b64_tr_b16 a[148:149], v15 offset:28672
    ds_read_b64_tr_b16 a[150:151], v15 offset:29184
    s_waitcnt vmcnt(18)
    v_fma_mix_f32 v24, v252, v48, v56 op_sel_hi:[1,0,0]
    v_fma_mix_f32 v25, v252, v49, v57 op_sel:[1,0,0] op_sel_hi:[1,0,0]
    v_cvt_pk_bf16_f32 v252, v24, v25
    v_mfma_f32_32x32x16_bf16 v[144:159], a[136:139], v[244:247], v[144:159]
    v_fma_mix_f32 v26, v253, v50, v58 op_sel_hi:[1,0,0]
    v_fma_mix_f32 v27, v253, v51, v59 op_sel:[1,0,0] op_sel_hi:[1,0,0]
    v_cvt_pk_bf16_f32 v253, v26, v27
    ds_read_b128 v[40:43], v18 offset:512
    s_waitcnt lgkmcnt(7)
    v_mfma_f32_32x32x16_bf16 v[160:175], a[140:143], v[240:243], v[160:175]
    ds_read_b64_tr_b16 a[152:153], v14 offset:29696
    ds_read_b64_tr_b16 a[154:155], v14 offset:30208
    v_fma_mix_f32 v28, v254, v52, v60 op_sel_hi:[1,0,0]
    v_fma_mix_f32 v29, v254, v53, v61 op_sel:[1,0,0] op_sel_hi:[1,0,0]
    v_cvt_pk_bf16_f32 v254, v28, v29
    buffer_load_dwordx4 v[236:239], v17, s[16:19], s40 offen offset:2048 sc1
    v_mfma_f32_32x32x16_bf16 v[176:191], a[140:143], v[244:247], v[176:191]
    v_fma_mix_f32 v30, v255, v54, v62 op_sel_hi:[1,0,0]
    v_fma_mix_f32 v31, v255, v55, v63 op_sel:[1,0,0] op_sel_hi:[1,0,0]
    v_cvt_pk_bf16_f32 v255, v30, v31
    ds_read_b128 v[44:47], v18 offset:528
    s_waitcnt vmcnt(22)
    s_barrier
    s_waitcnt lgkmcnt(7)
    v_mfma_f32_32x32x16_bf16 v[64:79], a[144:147], v[248:251], v[64:79]
    ds_read_b64_tr_b16 a[156:157], v15 offset:29696
    ds_read_b64_tr_b16 a[158:159], v15 offset:30208
    s_waitcnt vmcnt(18) lgkmcnt(5)
    v_fma_mix_f32 v24, v192, v32, v40 op_sel_hi:[1,0,0]
    v_fma_mix_f32 v25, v192, v33, v41 op_sel:[1,0,0] op_sel_hi:[1,0,0]
    v_cvt_pk_bf16_f32 v192, v24, v25
    v_add_u32 v14, 33280, v14
    v_add_u32 v15, 33280, v15
    v_mfma_f32_32x32x16_bf16 v[80:95], a[144:147], v[252:255], v[80:95]
    v_fma_mix_f32 v26, v193, v34, v42 op_sel_hi:[1,0,0]
    v_fma_mix_f32 v27, v193, v35, v43 op_sel:[1,0,0] op_sel_hi:[1,0,0]
    v_cvt_pk_bf16_f32 v193, v26, v27
    ds_read_b128 v[48:51], v18 offset:2624
    v_mfma_f32_32x32x16_bf16 v[96:111], a[148:151], v[248:251], v[96:111]
    ds_read_b64_tr_b16 a[128:129], v14 offset:0
    ds_read_b64_tr_b16 a[130:131], v14 offset:512
    s_waitcnt lgkmcnt(5)
    v_fma_mix_f32 v28, v194, v36, v44 op_sel_hi:[1,0,0]
    v_fma_mix_f32 v29, v194, v37, v45 op_sel:[1,0,0] op_sel_hi:[1,0,0]
    v_cvt_pk_bf16_f32 v194, v28, v29
    buffer_load_dwordx4 v[240:243], v16, s[16:19], s40 offen offset:3072 sc1
    v_mfma_f32_32x32x16_bf16 v[112:127], a[148:151], v[252:255], v[112:127]
    v_fma_mix_f32 v30, v195, v38, v46 op_sel_hi:[1,0,0]
    v_fma_mix_f32 v31, v195, v39, v47 op_sel:[1,0,0] op_sel_hi:[1,0,0]
    v_cvt_pk_bf16_f32 v195, v30, v31
    ds_read_b128 v[52:55], v18 offset:2640
    v_mfma_f32_32x32x16_bf16 v[128:143], a[152:155], v[248:251], v[128:143]
    ds_read_b64_tr_b16 a[132:133], v15 offset:0
    ds_read_b64_tr_b16 a[134:135], v15 offset:512
    s_waitcnt vmcnt(17)
    v_fma_mix_f32 v24, v196, v32, v40 op_sel_hi:[1,0,0]
    v_fma_mix_f32 v25, v196, v33, v41 op_sel:[1,0,0] op_sel_hi:[1,0,0]
    v_cvt_pk_bf16_f32 v196, v24, v25
    v_mfma_f32_32x32x16_bf16 v[144:159], a[152:155], v[252:255], v[144:159]
    v_fma_mix_f32 v26, v197, v34, v42 op_sel_hi:[1,0,0]
    v_fma_mix_f32 v27, v197, v35, v43 op_sel:[1,0,0] op_sel_hi:[1,0,0]
    v_cvt_pk_bf16_f32 v197, v26, v27
    ds_read_b128 v[56:59], v18 offset:576
    s_waitcnt lgkmcnt(7)
    v_mfma_f32_32x32x16_bf16 v[160:175], a[156:159], v[248:251], v[160:175]
    ds_read_b64_tr_b16 a[136:137], v14 offset:1024
    ds_read_b64_tr_b16 a[138:139], v14 offset:1536
    v_fma_mix_f32 v28, v198, v36, v44 op_sel_hi:[1,0,0]
    v_fma_mix_f32 v29, v198, v37, v45 op_sel:[1,0,0] op_sel_hi:[1,0,0]
    v_cvt_pk_bf16_f32 v198, v28, v29
    buffer_load_dwordx4 v[244:247], v17, s[16:19], s40 offen offset:3072 sc1
    v_mfma_f32_32x32x16_bf16 v[176:191], a[156:159], v[252:255], v[176:191]
    v_fma_mix_f32 v30, v199, v38, v46 op_sel_hi:[1,0,0]
    v_fma_mix_f32 v31, v199, v39, v47 op_sel:[1,0,0] op_sel_hi:[1,0,0]
    v_cvt_pk_bf16_f32 v199, v30, v31
    ds_read_b128 v[60:63], v18 offset:592
    v_add_u32 v18, 512, v18
    s_add_u32 s39, s39, 8192
    s_add_u32 s40, s40, 8192
    s_add_u32 s37, s37, 33280
    s_add_u32 s36, s36, 1048576
    s_sub_u32 s31, s31, 1
    s_cmp_lg_u32 s31, 0
    s_cbranch_scc1 L_k2_q1
    s_mov_b32 s31, 2
L_k2_q2:
    s_add_u32 s37, s33, s42
    s_add_u32 s38, s33, s43
    s_add_u32 s35, s41, 8192
    s_cmp_eq_u32 s33, 0
    s_cselect_b32 s36, s35, s41
    s_waitcnt lgkmcnt(7)
    v_mfma_f32_32x32x16_bf16 v[64:79], a[128:131], v[192:195], v[64:79]
    ds_read_b64_tr_b16 a[140:141], v15 offset:1024
    ds_read_b64_tr_b16 a[142:143], v15 offset:1536
    s_waitcnt vmcnt(16) lgkmcnt(5)
    v_fma_mix_f32 v24, v200, v48, v56 op_sel_hi:[1,0,0]
    v_fma_mix_f32 v25, v200, v49, v57 op_sel:[1,0,0] op_sel_hi:[1,0,0]
    v_cvt_pk_bf16_f32 v200, v24, v25
    v_mfma_f32_32x32x16_bf16 v[80:95], a[128:131], v[196:199], v[80:95]
    v_fma_mix_f32 v26, v201, v50, v58 op_sel_hi:[1,0,0]
    v_fma_mix_f32 v27, v201, v51, v59 op_sel:[1,0,0] op_sel_hi:[1,0,0]
    v_cvt_pk_bf16_f32 v201, v26, v27
    ds_read_b128 v[32:35], v18 offset:2176
    v_mfma_f32_32x32x16_bf16 v[96:111], a[132:135], v[192:195], v[96:111]
    ds_read_b64_tr_b16 a[144:145], v14 offset:4096
    ds_read_b64_tr_b16 a[146:147], v14 offset:4608
    s_waitcnt lgkmcnt(5)
    v_fma_mix_f32 v28, v202, v52, v60 op_sel_hi:[1,0,0]
    v_fma_mix_f32 v29, v202, v53, v61 op_sel:[1,0,0] op_sel_hi:[1,0,0]
    v_cvt_pk_bf16_f32 v202, v28, v29
    buffer_load_dwordx4 v[248:251], v16, s[16:19], s39 offen offset:0 sc1
    v_mfma_f32_32x32x16_bf16 v[112:127], a[132:135], v[196:199], v[112:127]
    v_fma_mix_f32 v30, v203, v54, v62 op_sel_hi:[1,0,0]
    v_fma_mix_f32 v31, v203, v55, v63 op_sel:[1,0,0] op_sel_hi:[1,0,0]
    v_cvt_pk_bf16_f32 v203, v30, v31
    ds_read_b128 v[36:39], v18 offset:2192
    s_mov_b32 m0, s37
    v_mfma_f32_32x32x16_bf16 v[128:143], a[136:139], v[192:195], v[128:143]
    ds_read_b64_tr_b16 a[148:149], v15 offset:4096
    ds_read_b64_tr_b16 a[150:151], v15 offset:4608
    s_waitcnt vmcnt(16)
    v_fma_mix_f32 v24, v204, v48, v56 op_sel_hi:[1,0,0]
    v_fma_mix_f32 v25, v204, v49, v57 op_sel:[1,0,0] op_sel_hi:[1,0,0]
    v_cvt_pk_bf16_f32 v204, v24, v25
    buffer_load_dwordx4 v2, s[8:11], s41 offen lds
    v_mfma_f32_32x32x16_bf16 v[144:159], a[136:139], v[196:199], v[144:159]
    v_fma_mix_f32 v26, v205, v50, v58 op_sel_hi:[1,0,0]
    v_fma_mix_f32 v27, v205, v51, v59 op_sel:[1,0,0] op_sel_hi:[1,0,0]
    v_cvt_pk_bf16_f32 v205, v26, v27
    ds_read_b128 v[40:43], v18 offset:128
    s_waitcnt lgkmcnt(7)
    v_mfma_f32_32x32x16_bf16 v[160:175], a[140:143], v[192:195], v[160:175]
    ds_read_b64_tr_b16 a[152:153], v14 offset:5120
    ds_read_b64_tr_b16 a[154:155], v14 offset:5632
    v_fma_mix_f32 v28, v206, v52, v60 op_sel_hi:[1,0,0]
    v_fma_mix_f32 v29, v206, v53, v61 op_sel:[1,0,0] op_sel_hi:[1,0,0]
    v_cvt_pk_bf16_f32 v206, v28, v29
    buffer_load_dwordx4 v[252:255], v17, s[16:19], s39 offen offset:0 sc1
    v_mfma_f32_32x32x16_bf16 v[176:191], a[140:143], v[196:199], v[176:191]
    v_fma_mix_f32 v30, v207, v54, v62 op_sel_hi:[1,0,0]
    v_fma_mix_f32 v31, v207, v55, v63 op_sel:[1,0,0] op_sel_hi:[1,0,0]
    v_cvt_pk_bf16_f32 v207, v30, v31
    ds_read_b128 v[44:47], v18 offset:144
    s_waitcnt lgkmcnt(7)
    v_mfma_f32_32x32x16_bf16 v[64:79], a[144:147], v[200:203], v[64:79]
    ds_read_b64_tr_b16 a[156:157], v15 offset:5120
    ds_read_b64_tr_b16 a[158:159], v15 offset:5632
    s_waitcnt vmcnt(16) lgkmcnt(5)
    v_fma_mix_f32 v24, v208, v32, v40 op_sel_hi:[1,0,0]
    v_fma_mix_f32 v25, v208, v33, v41 op_sel:[1,0,0] op_sel_hi:[1,0,0]
    v_cvt_pk_bf16_f32 v208, v24, v25
    v_mfma_f32_32x32x16_bf16 v[80:95], a[144:147], v[204:207], v[80:95]
    v_fma_mix_f32 v26, v209, v34, v42 op_sel_hi:[1,0,0]
    v_fma_mix_f32 v27, v209, v35, v43 op_sel:[1,0,0] op_sel_hi:[1,0,0]
    v_cvt_pk_bf16_f32 v209, v26, v27
    ds_read_b128 v[48:51], v18 offset:2240
    v_mfma_f32_32x32x16_bf16 v[96:111], a[148:151], v[200:203], v[96:111]
    ds_read_b64_tr_b16 a[128:129], v14 offset:8192
    ds_read_b64_tr_b16 a[130:131], v14 offset:8704
    s_waitcnt lgkmcnt(5)
    v_fma_mix_f32 v28, v210, v36, v44 op_sel_hi:[1,0,0]
    v_fma_mix_f32 v29, v210, v37, v45 op_sel:[1,0,0] op_sel_hi:[1,0,0]
    v_cvt_pk_bf16_f32 v210, v28, v29
    buffer_load_dwordx4 v[192:195], v16, s[16:19], s39 offen offset:1024 sc1
    buffer_load_dwordx4 v2, s[8:11], s41 offen offset:1024 lds
    v_mfma_f32_32x32x16_bf16 v[112:127], a[148:151], v[204:207], v[112:127]
    v_fma_mix_f32 v30, v211, v38, v46 op_sel_hi:[1,0,0]
    v_fma_mix_f32 v31, v211, v39, v47 op_sel:[1,0,0] op_sel_hi:[1,0,0]
    v_cvt_pk_bf16_f32 v211, v30, v31
    ds_read_b128 v[52:55], v18 offset:2256
    v_mfma_f32_32x32x16_bf16 v[128:143], a[152:155], v[200:203], v[128:143]
    ds_read_b64_tr_b16 a[132:133], v15 offset:8192
    ds_read_b64_tr_b16 a[134:135], v15 offset:8704
    s_waitcnt vmcnt(16)
    v_fma_mix_f32 v24, v212, v32, v40 op_sel_hi:[1,0,0]
    v_fma_mix_f32 v25, v212, v33, v41 op_sel:[1,0,0] op_sel_hi:[1,0,0]
    v_cvt_pk_bf16_f32 v212, v24, v25
    v_mfma_f32_32x32x16_bf16 v[144:159], a[152:155], v[204:207], v[144:159]
    v_fma_mix_f32 v26, v213, v34, v42 op_sel_hi:[1,0,0]
    v_fma_mix_f32 v27, v213, v35, v43 op_sel:[1,0,0] op_sel_hi:[1,0,0]
    v_cvt_pk_bf16_f32 v213, v26, v27
    ds_read_b128 v[56:59], v18 offset:192
    s_waitcnt lgkmcnt(7)
    v_mfma_f32_32x32x16_bf16 v[160:175], a[156:159], v[200:203], v[160:175]
    ds_read_b64_tr_b16 a[136:137], v14 offset:9216
    ds_read_b64_tr_b16 a[138:139], v14 offset:9728
    v_fma_mix_f32 v28, v214, v36, v44 op_sel_hi:[1,0,0]
    v_fma_mix_f32 v29, v214, v37, v45 op_sel:[1,0,0] op_sel_hi:[1,0,0]
    v_cvt_pk_bf16_f32 v214, v28, v29
    buffer_load_dwordx4 v[196:199], v17, s[16:19], s39 offen offset:1024 sc1
    v_mfma_f32_32x32x16_bf16 v[176:191], a[156:159], v[204:207], v[176:191]
    v_fma_mix_f32 v30, v215, v38, v46 op_sel_hi:[1,0,0]
    v_fma_mix_f32 v31, v215, v39, v47 op_sel:[1,0,0] op_sel_hi:[1,0,0]
    v_cvt_pk_bf16_f32 v215, v30, v31
    ds_read_b128 v[60:63], v18 offset:208
    s_add_u32 m0, s37, 8448
    s_waitcnt lgkmcnt(7)
    v_mfma_f32_32x32x16_bf16 v[64:79], a[128:131], v[208:211], v[64:79]
    ds_read_b64_tr_b16 a[140:141], v15 offset:9216
    ds_read_b64_tr_b16 a[142:143], v15 offset:9728
    s_waitcnt vmcnt(16) lgkmcnt(5)
    v_fma_mix_f32 v24, v216, v48, v56 op_sel_hi:[1,0,0]
    v_fma_mix_f32 v25, v216, v49, v57 op_sel:[1,0,0] op_sel_hi:[1,0,0]
    v_cvt_pk_bf16_f32 v216, v24, v25
    buffer_load_dwordx4 v3, s[8:11], s41 offen lds
    v_mfma_f32_32x32x16_bf16 v[80:95], a[128:131], v[212:215], v[80:95]
    v_fma_mix_f32 v26, v217, v50, v58 op_sel_hi:[1,0,0]
    v_fma_mix_f32 v27, v217, v51, v59 op_sel:[1,0,0] op_sel_hi:[1,0,0]
    v_cvt_pk_bf16_f32 v217, v26, v27
    ds_read_b128 v[32:35], v18 offset:2304
    v_mfma_f32_32x32x16_bf16 v[96:111], a[132:135], v[208:211], v[96:111]
    ds_read_b64_tr_b16 a[144:145], v14 offset:12288
    ds_read_b64_tr_b16 a[146:147], v14 offset:12800
    s_waitcnt lgkmcnt(5)
    v_fma_mix_f32 v28, v218, v52, v60 op_sel_hi:[1,0,0]
    v_fma_mix_f32 v29, v218, v53, v61 op_sel:[1,0,0] op_sel_hi:[1,0,0]
    v_cvt_pk_bf16_f32 v218, v28, v29
    buffer_load_dwordx4 v[200:203], v16, s[16:19], s39 offen offset:2048 sc1
    v_mfma_f32_32x32x16_bf16 v[112:127], a[132:135], v[212:215], v[112:127]
    v_fma_mix_f32 v30, v219, v54, v62 op_sel_hi:[1,0,0]
    v_fma_mix_f32 v31, v219, v55, v63 op_sel:[1,0,0] op_sel_hi:[1,0,0]
    v_cvt_pk_bf16_f32 v219, v30, v31
    ds_read_b128 v[36:39], v18 offset:2320
    v_mfma_f32_32x32x16_bf16 v[128:143], a[136:139], v[208:211], v[128:143]
    ds_read_b64_tr_b16 a[148:149], v15 offset:12288
    ds_read_b64_tr_b16 a[150:151], v15 offset:12800
    s_waitcnt vmcnt(16)
    v_fma_mix_f32 v24, v220, v48, v56 op_sel_hi:[1,0,0]
    v_fma_mix_f32 v25, v220, v49, v57 op_sel:[1,0,0] op_sel_hi:[1,0,0]
    v_cvt_pk_bf16_f32 v220, v24, v25
    v_mfma_f32_32x32x16_bf16 v[144:159], a[136:139], v[212:215], v[144:159]
    v_fma_mix_f32 v26, v221, v50, v58 op_sel_hi:[1,0,0]
    v_fma_mix_f32 v27, v221, v51, v59 op_sel:[1,0,0] op_sel_hi:[1,0,0]
    v_cvt_pk_bf16_f32 v221, v26, v27
    ds_read_b128 v[40:43], v18 offset:256
    s_waitcnt lgkmcnt(7)
    v_mfma_f32_32x32x16_bf16 v[160:175], a[140:143], v[208:211], v[160:175]
    ds_read_b64_tr_b16 a[152:153], v14 offset:13312
    ds_read_b64_tr_b16 a[154:155], v14 offset:13824
    v_fma_mix_f32 v28, v222, v52, v60 op_sel_hi:[1,0,0]
    v_fma_mix_f32 v29, v222, v53, v61 op_sel:[1,0,0] op_sel_hi:[1,0,0]
    v_cvt_pk_bf16_f32 v222, v28, v29
    buffer_load_dwordx4 v[204:207], v17, s[16:19], s39 offen offset:2048 sc1
    buffer_load_dwordx4 v3, s[8:11], s41 offen offset:1024 lds
    v_mfma_f32_32x32x16_bf16 v[176:191], a[140:143], v[212:215], v[176:191]
    v_fma_mix_f32 v30, v223, v54, v62 op_sel_hi:[1,0,0]
    v_fma_mix_f32 v31, v223, v55, v63 op_sel:[1,0,0] op_sel_hi:[1,0,0]
    v_cvt_pk_bf16_f32 v223, v30, v31
    ds_read_b128 v[44:47], v18 offset:272
    s_waitcnt lgkmcnt(7)
    v_mfma_f32_32x32x16_bf16 v[64:79], a[144:147], v[216:219], v[64:79]
    ds_read_b64_tr_b16 a[156:157], v15 offset:13312
    ds_read_b64_tr_b16 a[158:159], v15 offset:13824
    s_waitcnt vmcnt(16) lgkmcnt(5)
    v_fma_mix_f32 v24, v224, v32, v40 op_sel_hi:[1,0,0]
    v_fma_mix_f32 v25, v224, v33, v41 op_sel:[1,0,0] op_sel_hi:[1,0,0]
    v_cvt_pk_bf16_f32 v224, v24, v25
    v_mfma_f32_32x32x16_bf16 v[80:95], a[144:147], v[220:223], v[80:95]
    v_fma_mix_f32 v26, v225, v34, v42 op_sel_hi:[1,0,0]
    v_fma_mix_f32 v27, v225, v35, v43 op_sel:[1,0,0] op_sel_hi:[1,0,0]
    v_cvt_pk_bf16_f32 v225, v26, v27
    ds_read_b128 v[48:51], v18 offset:2368
    v_mfma_f32_32x32x16_bf16 v[96:111], a[148:151], v[216:219], v[96:111]
    ds_read_b64_tr_b16 a[128:129], v14 offset:16384
    ds_read_b64_tr_b16 a[130:131], v14 offset:16896
    s_waitcnt lgkmcnt(5)
    v_fma_mix_f32 v28, v226, v36, v44 op_sel_hi:[1,0,0]
    v_fma_mix_f32 v29, v226, v37, v45 op_sel:[1,0,0] op_sel_hi:[1,0,0]
    v_cvt_pk_bf16_f32 v226, v28, v29
    buffer_load_dwordx4 v[208:211], v16, s[16:19], s39 offen offset:3072 sc1
    v_mfma_f32_32x32x16_bf16 v[112:127], a[148:151], v[220:223], v[112:127]
    v_fma_mix_f32 v30, v227, v38, v46 op_sel_hi:[1,0,0]
    v_fma_mix_f32 v31, v227, v39, v47 op_sel:[1,0,0] op_sel_hi:[1,0,0]
    v_cvt_pk_bf16_f32 v227, v30, v31
    ds_read_b128 v[52:55], v18 offset:2384
    s_mov_b32 m0, s38
    v_mfma_f32_32x32x16_bf16 v[128:143], a[152:155], v[216:219], v[128:143]
    ds_read_b64_tr_b16 a[132:133], v15 offset:16384
    ds_read_b64_tr_b16 a[134:135], v15 offset:16896
    s_waitcnt vmcnt(16)
    v_fma_mix_f32 v24, v228, v32, v40 op_sel_hi:[1,0,0]
    v_fma_mix_f32 v25, v228, v33, v41 op_sel:[1,0,0] op_sel_hi:[1,0,0]
    v_cvt_pk_bf16_f32 v228, v24, v25
    buffer_load_dwordx4 v4, s[12:15], s36 offen lds
    v_mfma_f32_32x32x16_bf16 v[144:159], a[152:155], v[220:223], v[144:159]
    v_fma_mix_f32 v26, v229, v34, v42 op_sel_hi:[1,0,0]
    v_fma_mix_f32 v27, v229, v35, v43 op_sel:[1,0,0] op_sel_hi:[1,0,0]
    v_cvt_pk_bf16_f32 v229, v26, v27
    ds_read_b128 v[56:59], v18 offset:320
    s_waitcnt lgkmcnt(7)
    v_mfma_f32_32x32x16_bf16 v[160:175], a[156:159], v[216:219], v[160:175]
    ds_read_b64_tr_b16 a[136:137], v14 offset:17408
    ds_read_b64_tr_b16 a[138:139], v14 offset:17920
    v_fma_mix_f32 v28, v230, v36, v44 op_sel_hi:[1,0,0]
    v_fma_mix_f32 v29, v230, v37, v45 op_sel:[1,0,0] op_sel_hi:[1,0,0]
    v_cvt_pk_bf16_f32 v230, v28, v29
    buffer_load_dwordx4 v[212:215], v17, s[16:19], s39 offen offset:3072 sc1
    v_mfma_f32_32x32x16_bf16 v[176:191], a[156:159], v[220:223], v[176:191]
    v_fma_mix_f32 v30, v231, v38, v46 op_sel_hi:[1,0,0]
    v_fma_mix_f32 v31, v231, v39, v47 op_sel:[1,0,0] op_sel_hi:[1,0,0]
    v_cvt_pk_bf16_f32 v231, v30, v31
    ds_read_b128 v[60:63], v18 offset:336
    s_waitcnt lgkmcnt(7)
    v_mfma_f32_32x32x16_bf16 v[64:79], a[128:131], v[224:227], v[64:79]
    ds_read_b64_tr_b16 a[140:141], v15 offset:17408
    ds_read_b64_tr_b16 a[142:143], v15 offset:17920
    s_waitcnt vmcnt(16) lgkmcnt(5)
    v_fma_mix_f32 v24, v232, v48, v56 op_sel_hi:[1,0,0]
    v_fma_mix_f32 v25, v232, v49, v57 op_sel:[1,0,0] op_sel_hi:[1,0,0]
    v_cvt_pk_bf16_f32 v232, v24, v25
    v_mfma_f32_32x32x16_bf16 v[80:95], a[128:131], v[228:231], v[80:95]
    v_fma_mix_f32 v26, v233, v50, v58 op_sel_hi:[1,0,0]
    v_fma_mix_f32 v27, v233, v51, v59 op_sel:[1,0,0] op_sel_hi:[1,0,0]
    v_cvt_pk_bf16_f32 v233, v26, v27
    ds_read_b128 v[32:35], v18 offset:2432
    v_mfma_f32_32x32x16_bf16 v[96:111], a[132:135], v[224:227], v[96:111]
    ds_read_b64_tr_b16 a[144:145], v14 offset:20480
    ds_read_b64_tr_b16 a[146:147], v14 offset:20992
    s_waitcnt lgkmcnt(5)
    v_fma_mix_f32 v28, v234, v52, v60 op_sel_hi:[1,0,0]
    v_fma_mix_f32 v29, v234, v53, v61 op_sel:[1,0,0] op_sel_hi:[1,0,0]
    v_cvt_pk_bf16_f32 v234, v28, v29
    buffer_load_dwordx4 v[216:219], v16, s[16:19], s40 offen offset:0 sc1
    buffer_load_dwordx4 v5, s[12:15], s36 offen offset:1024 lds
    v_mfma_f32_32x32x16_bf16 v[112:127], a[132:135], v[228:231], v[112:127]
    v_fma_mix_f32 v30, v235, v54, v62 op_sel_hi:[1,0,0]
    v_fma_mix_f32 v31, v235, v55, v63 op_sel:[1,0,0] op_sel_hi:[1,0,0]
    v_cvt_pk_bf16_f32 v235, v30, v31
    ds_read_b128 v[36:39], v18 offset:2448
    v_mfma_f32_32x32x16_bf16 v[128:143], a[136:139], v[224:227], v[128:143]
    ds_read_b64_tr_b16 a[148:149], v15 offset:20480
    ds_read_b64_tr_b16 a[150:151], v15 offset:20992
    s_waitcnt vmcnt(17)
    v_fma_mix_f32 v24, v236, v48, v56 op_sel_hi:[1,0,0]
    v_fma_mix_f32 v25, v236, v49, v57 op_sel:[1,0,0] op_sel_hi:[1,0,0]
    v_cvt_pk_bf16_f32 v236, v24, v25
    v_mfma_f32_32x32x16_bf16 v[144:159], a[136:139], v[228:231], v[144:159]
    v_fma_mix_f32 v26, v237, v50, v58 op_sel_hi:[1,0,0]
    v_fma_mix_f32 v27, v237, v51, v59 op_sel:[1,0,0] op_sel_hi:[1,0,0]
    v_cvt_pk_bf16_f32 v237, v26, v27
    ds_read_b128 v[40:43], v18 offset:384
    s_waitcnt lgkmcnt(7)
    v_mfma_f32_32x32x16_bf16 v[160:175], a[140:143], v[224:227], v[160:175]
    ds_read_b64_tr_b16 a[152:153], v14 offset:21504
    ds_read_b64_tr_b16 a[154:155], v14 offset:22016
    v_fma_mix_f32 v28, v238, v52, v60 op_sel_hi:[1,0,0]
    v_fma_mix_f32 v29, v238, v53, v61 op_sel:[1,0,0] op_sel_hi:[1,0,0]
    v_cvt_pk_bf16_f32 v238, v28, v29
    buffer_load_dwordx4 v[220:223], v17, s[16:19], s40 offen offset:0 sc1
    v_mfma_f32_32x32x16_bf16 v[176:191], a[140:143], v[228:231], v[176:191]
    v_fma_mix_f32 v30, v239, v54, v62 op_sel_hi:[1,0,0]
    v_fma_mix_f32 v31, v239, v55, v63 op_sel:[1,0,0] op_sel_hi:[1,0,0]
    v_cvt_pk_bf16_f32 v239, v30, v31
    ds_read_b128 v[44:47], v18 offset:400
    s_add_u32 m0, s38, 8192
    s_waitcnt lgkmcnt(7)
    v_mfma_f32_32x32x16_bf16 v[64:79], a[144:147], v[232:235], v[64:79]
    ds_read_b64_tr_b16 a[156:157], v15 offset:21504
    ds_read_b64_tr_b16 a[158:159], v15 offset:22016
    s_waitcnt vmcnt(17) lgkmcnt(5)
    v_fma_mix_f32 v24, v240, v32, v40 op_sel_hi:[1,0,0]
    v_fma_mix_f32 v25, v240, v33, v41 op_sel:[1,0,0] op_sel_hi:[1,0,0]
    v_cvt_pk_bf16_f32 v240, v24, v25
    buffer_load_dwordx4 v4, s[12:15], s35 offen lds
    v_mfma_f32_32x32x16_bf16 v[80:95], a[144:147], v[236:239], v[80:95]
    v_fma_mix_f32 v26, v241, v34, v42 op_sel_hi:[1,0,0]
    v_fma_mix_f32 v27, v241, v35, v43 op_sel:[1,0,0] op_sel_hi:[1,0,0]
    v_cvt_pk_bf16_f32 v241, v26, v27
    ds_read_b128 v[48:51], v18 offset:2496
    v_mfma_f32_32x32x16_bf16 v[96:111], a[148:151], v[232:235], v[96:111]
    ds_read_b64_tr_b16 a[128:129], v14 offset:24576
    ds_read_b64_tr_b16 a[130:131], v14 offset:25088
    s_waitcnt lgkmcnt(5)
    v_fma_mix_f32 v28, v242, v36, v44 op_sel_hi:[1,0,0]
    v_fma_mix_f32 v29, v242, v37, v45 op_sel:[1,0,0] op_sel_hi:[1,0,0]
    v_cvt_pk_bf16_f32 v242, v28, v29
    buffer_load_dwordx4 v[224:227], v16, s[16:19], s40 offen offset:1024 sc1
    v_mfma_f32_32x32x16_bf16 v[112:127], a[148:151], v[236:239], v[112:127]
    v_fma_mix_f32 v30, v243, v38, v46 op_sel_hi:[1,0,0]
    v_fma_mix_f32 v31, v243, v39, v47 op_sel:[1,0,0] op_sel_hi:[1,0,0]
    v_cvt_pk_bf16_f32 v243, v30, v31
    ds_read_b128 v[52:55], v18 offset:2512
    v_mfma_f32_32x32x16_bf16 v[128:143], a[152:155], v[232:235], v[128:143]
    ds_read_b64_tr_b16 a[132:133], v15 offset:24576
    ds_read_b64_tr_b16 a[134:135], v15 offset:25088
    s_waitcnt vmcnt(18)
    v_fma_mix_f32 v24, v244, v32, v40 op_sel_hi:[1,0,0]
    v_fma_mix_f32 v25, v244, v33, v41 op_sel:[1,0,0] op_sel_hi:[1,0,0]
    v_cvt_pk_bf16_f32 v244, v24, v25
    v_mfma_f32_32x32x16_bf16 v[144:159], a[152:155], v[236:239], v[144:159]
    v_fma_mix_f32 v26, v245, v34, v42 op_sel_hi:[1,0,0]
    v_fma_mix_f32 v27, v245, v35, v43 op_sel:[1,0,0] op_sel_hi:[1,0,0]
    v_cvt_pk_bf16_f32 v245, v26, v27
    ds_read_b128 v[56:59], v18 offset:448
    s_waitcnt lgkmcnt(7)
    v_mfma_f32_32x32x16_bf16 v[160:175], a[156:159], v[232:235], v[160:175]
    ds_read_b64_tr_b16 a[136:137], v14 offset:25600
    ds_read_b64_tr_b16 a[138:139], v14 offset:26112
    v_fma_mix_f32 v28, v246, v36, v44 op_sel_hi:[1,0,0]
    v_fma_mix_f32 v29, v246, v37, v45 op_sel:[1,0,0] op_sel_hi:[1,0,0]
    v_cvt_pk_bf16_f32 v246, v28, v29
    buffer_load_dwordx4 v[228:231], v17, s[16:19], s40 offen offset:1024 sc1
    buffer_load_dwordx4 v5, s[12:15], s35 offen offset:1024 lds
    v_mfma_f32_32x32x16_bf16 v[176:191], a[156:159], v[236:239], v[176:191]
    v_fma_mix_f32 v30, v247, v38, v46 op_sel_hi:[1,0,0]
    v_fma_mix_f32 v31, v247, v39, v47 op_sel:[1,0,0] op_sel_hi:[1,0,0]
    v_cvt_pk_bf16_f32 v247, v30, v31
    ds_read_b128 v[60:63], v18 offset:464
    s_waitcnt lgkmcnt(7)
    v_mfma_f32_32x32x16_bf16 v[64:79], a[128:131], v[240:243], v[64:79]
    ds_read_b64_tr_b16 a[140:141], v15 offset:25600
    ds_read_b64_tr_b16 a[142:143], v15 offset:26112
    s_waitcnt vmcnt(19) lgkmcnt(5)
    v_fma_mix_f32 v24, v248, v48, v56 op_sel_hi:[1,0,0]
    v_fma_mix_f32 v25, v248, v49, v57 op_sel:[1,0,0] op_sel_hi:[1,0,0]
    v_cvt_pk_bf16_f32 v248, v24, v25
    v_mfma_f32_32x32x16_bf16 v[80:95], a[128:131], v[244:247], v[80:95]
    v_fma_mix_f32 v26, v249, v50, v58 op_sel_hi:[1,0,0]
    v_fma_mix_f32 v27, v249, v51, v59 op_sel:[1,0,0] op_sel_hi:[1,0,0]
    v_cvt_pk_bf16_f32 v249, v26, v27
    ds_read_b128 v[32:35], v18 offset:2560
    v_mfma_f32_32x32x16_bf16 v[96:111], a[132:135], v[240:243], v[96:111]
    ds_read_b64_tr_b16 a[144:145], v14 offset:28672
    ds_read_b64_tr_b16 a[146:147], v14 offset:29184
    s_waitcnt lgkmcnt(5)
    v_fma_mix_f32 v28, v250, v52, v60 op_sel_hi:[1,0,0]
    v_fma_mix_f32 v29, v250, v53, v61 op_sel:[1,0,0] op_sel_hi:[1,0,0]
    v_cvt_pk_bf16_f32 v250, v28, v29
    buffer_load_dwordx4 v[232:235], v16, s[16:19], s40 offen offset:2048 sc1
    v_mfma_f32_32x32x16_bf16 v[112:127], a[132:135], v[244:247], v[112:127]
    v_fma_mix_f32 v30, v251, v54, v62 op_sel_hi:[1,0,0]
    v_fma_mix_f32 v31, v251, v55, v63 op_sel:[1,0,0] op_sel_hi:[1,0,0]
    v_cvt_pk_bf16_f32 v251, v30, v31
    ds_read_b128 v[36:39], v18 offset:2576
    v_mfma_f32_32x32x16_bf16 v[128:143], a[136:139], v[240:243], v[128:143]
    ds_read_b64_tr_b16 a[148:149], v15 offset:28672
    ds_read_b64_tr_b16 a[150:151], v15 offset:29184
    s_waitcnt vmcnt(18)
    v_fma_mix_f32 v24, v252, v48, v56 op_sel_hi:[1,0,0]
    v_fma_mix_f32 v25, v252, v49, v57 op_sel:[1,0,0] op_sel_hi:[1,0,0]
    v_cvt_pk_bf16_f32 v252, v24, v25
    v_mfma_f32_32x32x16_bf16 v[144:159], a[136:139], v[244:247], v[144:159]
    v_fma_mix_f32 v26, v253, v50, v58 op_sel_hi:[1,0,0]
    v_fma_mix_f32 v27, v253, v51, v59 op_sel:[1,0,0] op_sel_hi:[1,0,0]
    v_cvt_pk_bf16_f32 v253, v26, v27
    ds_read_b128 v[40:43], v18 offset:512
    s_waitcnt lgkmcnt(7)
    v_mfma_f32_32x32x16_bf16 v[160:175], a[140:143], v[240:243], v[160:175]
    ds_read_b64_tr_b16 a[152:153], v14 offset:29696
    ds_read_b64_tr_b16 a[154:155], v14 offset:30208
    v_fma_mix_f32 v28, v254, v52, v60 op_sel_hi:[1,0,0]
    v_fma_mix_f32 v29, v254, v53, v61 op_sel:[1,0,0] op_sel_hi:[1,0,0]
    v_cvt_pk_bf16_f32 v254, v28, v29
    buffer_load_dwordx4 v[236:239], v17, s[16:19], s40 offen offset:2048 sc1
    v_mfma_f32_32x32x16_bf16 v[176:191], a[140:143], v[244:247], v[176:191]
    v_fma_mix_f32 v30, v255, v54, v62 op_sel_hi:[1,0,0]
    v_fma_mix_f32 v31, v255, v55, v63 op_sel:[1,0,0] op_sel_hi:[1,0,0]
    v_cvt_pk_bf16_f32 v255, v30, v31
    ds_read_b128 v[44:47], v18 offset:528
    s_waitcnt vmcnt(22)
    s_barrier
    s_waitcnt lgkmcnt(7)
    v_mfma_f32_32x32x16_bf16 v[64:79], a[144:147], v[248:251], v[64:79]
    ds_read_b64_tr_b16 a[156:157], v15 offset:29696
    ds_read_b64_tr_b16 a[158:159], v15 offset:30208
    s_waitcnt vmcnt(18) lgkmcnt(5)
    v_fma_mix_f32 v24, v192, v32, v40 op_sel_hi:[1,0,0]
    v_fma_mix_f32 v25, v192, v33, v41 op_sel:[1,0,0] op_sel_hi:[1,0,0]
    v_cvt_pk_bf16_f32 v192, v24, v25
    v_add_u32 v14, 33280, v14
    v_add_u32 v15, 33280, v15
    v_mfma_f32_32x32x16_bf16 v[80:95], a[144:147], v[252:255], v[80:95]
    v_fma_mix_f32 v26, v193, v34, v42 op_sel_hi:[1,0,0]
    v_fma_mix_f32 v27, v193, v35, v43 op_sel:[1,0,0] op_sel_hi:[1,0,0]
    v_cvt_pk_bf16_f32 v193, v26, v27
    ds_read_b128 v[48:51], v18 offset:2624
    v_mfma_f32_32x32x16_bf16 v[96:111], a[148:151], v[248:251], v[96:111]
    ds_read_b64_tr_b16 a[128:129], v14 offset:0
    ds_read_b64_tr_b16 a[130:131], v14 offset:512
    s_waitcnt lgkmcnt(5)
    v_fma_mix_f32 v28, v194, v36, v44 op_sel_hi:[1,0,0]
    v_fma_mix_f32 v29, v194, v37, v45 op_sel:[1,0,0] op_sel_hi:[1,0,0]
    v_cvt_pk_bf16_f32 v194, v28, v29
    buffer_load_dwordx4 v[240:243], v16, s[16:19], s40 offen offset:3072 sc1
    v_mfma_f32_32x32x16_bf16 v[112:127], a[148:151], v[252:255], v[112:127]
    v_fma_mix_f32 v30, v195, v38, v46 op_sel_hi:[1,0,0]
    v_fma_mix_f32 v31, v195, v39, v47 op_sel:[1,0,0] op_sel_hi:[1,0,0]
    v_cvt_pk_bf16_f32 v195, v30, v31
    ds_read_b128 v[52:55], v18 offset:2640
    v_mfma_f32_32x32x16_bf16 v[128:143], a[152:155], v[248:251], v[128:143]
    ds_read_b64_tr_b16 a[132:133], v15 offset:0
    ds_read_b64_tr_b16 a[134:135], v15 offset:512
    s_waitcnt vmcnt(17)
    v_fma_mix_f32 v24, v196, v32, v40 op_sel_hi:[1,0,0]
    v_fma_mix_f32 v25, v196, v33, v41 op_sel:[1,0,0] op_sel_hi:[1,0,0]
    v_cvt_pk_bf16_f32 v196, v24, v25
    v_mfma_f32_32x32x16_bf16 v[144:159], a[152:155], v[252:255], v[144:159]
    v_fma_mix_f32 v26, v197, v34, v42 op_sel_hi:[1,0,0]
    v_fma_mix_f32 v27, v197, v35, v43 op_sel:[1,0,0] op_sel_hi:[1,0,0]
    v_cvt_pk_bf16_f32 v197, v26, v27
    ds_read_b128 v[56:59], v18 offset:576
    s_waitcnt lgkmcnt(7)
    v_mfma_f32_32x32x16_bf16 v[160:175], a[156:159], v[248:251], v[160:175]
    ds_read_b64_tr_b16 a[136:137], v14 offset:1024
    ds_read_b64_tr_b16 a[138:139], v14 offset:1536
    v_fma_mix_f32 v28, v198, v36, v44 op_sel_hi:[1,0,0]
    v_fma_mix_f32 v29, v198, v37, v45 op_sel:[1,0,0] op_sel_hi:[1,0,0]
    v_cvt_pk_bf16_f32 v198, v28, v29
    buffer_load_dwordx4 v[244:247], v17, s[16:19], s40 offen offset:3072 sc1
    v_mfma_f32_32x32x16_bf16 v[176:191], a[156:159], v[252:255], v[176:191]
    v_fma_mix_f32 v30, v199, v38, v46 op_sel_hi:[1,0,0]
    v_fma_mix_f32 v31, v199, v39, v47 op_sel:[1,0,0] op_sel_hi:[1,0,0]
    v_cvt_pk_bf16_f32 v199, v30, v31
    ds_read_b128 v[60:63], v18 offset:592
    v_add_u32 v18, 512, v18
    s_add_u32 s39, s39, 8192
    s_add_u32 s40, s40, 8192
    s_add_u32 s33, s33, 33280
    s_add_u32 s41, s41, 16384
    s_sub_u32 s31, s31, 1
    s_cmp_lg_u32 s31, 0
    s_cbranch_scc1 L_k2_q2
    v_cvt_pk_bf16_f32 v192, v64, v65
    v_cvt_pk_bf16_f32 v193, v66, v67
    v_cvt_pk_bf16_f32 v194, v68, v69
    v_cvt_pk_bf16_f32 v195, v70, v71
    v_cvt_pk_bf16_f32 v196, v80, v81
    v_cvt_pk_bf16_f32 v197, v82, v83
    v_cvt_pk_bf16_f32 v198, v84, v85
    v_cvt_pk_bf16_f32 v199, v86, v87
    s_waitcnt vmcnt(16)
    v_cvt_pk_bf16_f32 v200, v72, v73
    v_cvt_pk_bf16_f32 v201, v74, v75
    v_cvt_pk_bf16_f32 v202, v76, v77
    v_cvt_pk_bf16_f32 v203, v78, v79
    s_waitcnt vmcnt(15)
    v_cvt_pk_bf16_f32 v204, v88, v89
    v_cvt_pk_bf16_f32 v205, v90, v91
    v_cvt_pk_bf16_f32 v206, v92, v93
    v_cvt_pk_bf16_f32 v207, v94, v95
    s_waitcnt vmcnt(13)
    v_cvt_pk_bf16_f32 v208, v96, v97
    v_cvt_pk_bf16_f32 v209, v98, v99
    v_cvt_pk_bf16_f32 v210, v100, v101
    v_cvt_pk_bf16_f32 v211, v102, v103
    s_waitcnt vmcnt(11)
    v_cvt_pk_bf16_f32 v212, v112, v113
    v_cvt_pk_bf16_f32 v213, v114, v115
    v_cvt_pk_bf16_f32 v214, v116, v117
    v_cvt_pk_bf16_f32 v215, v118, v119
    s_waitcnt vmcnt(10)
    v_cvt_pk_bf16_f32 v216, v104, v105
    v_cvt_pk_bf16_f32 v217, v106, v107
    v_cvt_pk_bf16_f32 v218, v108, v109
    v_cvt_pk_bf16_f32 v219, v110, v111
    s_waitcnt vmcnt(8)
    v_cvt_pk_bf16_f32 v220, v120, v121
    v_cvt_pk_bf16_f32 v221, v122, v123
    v_cvt_pk_bf16_f32 v222, v124, v125
    v_cvt_pk_bf16_f32 v223, v126, v127
    s_waitcnt vmcnt(6)
    v_cvt_pk_bf16_f32 v224, v128, v129
    v_cvt_pk_bf16_f32 v225, v130, v131
    v_cvt_pk_bf16_f32 v226, v132, v133
    v_cvt_pk_bf16_f32 v227, v134, v135
    s_waitcnt vmcnt(5)
    v_cvt_pk_bf16_f32 v228, v144, v145
    v_cvt_pk_bf16_f32 v229, v146, v147
    v_cvt_pk_bf16_f32 v230, v148, v149
    v_cvt_pk_bf16_f32 v231, v150, v151
    s_waitcnt vmcnt(3)
    v_cvt_pk_bf16_f32 v232, v136, v137
    v_cvt_pk_bf16_f32 v233, v138, v139
    v_cvt_pk_bf16_f32 v234, v140, v141
    v_cvt_pk_bf16_f32 v235, v142, v143
    s_waitcnt vmcnt(2)
    v_cvt_pk_bf16_f32 v236, v152, v153
    v_cvt_pk_bf16_f32 v237, v154, v155
    v_cvt_pk_bf16_f32 v238, v156, v157
    v_cvt_pk_bf16_f32 v239, v158, v159
    s_waitcnt vmcnt(1)
    v_cvt_pk_bf16_f32 v240, v160, v161
    v_cvt_pk_bf16_f32 v241, v162, v163
    v_cvt_pk_bf16_f32 v242, v164, v165
    v_cvt_pk_bf16_f32 v243, v166, v167
    s_waitcnt vmcnt(0)
    v_cvt_pk_bf16_f32 v244, v176, v177
    v_cvt_pk_bf16_f32 v245, v178, v179
    v_cvt_pk_bf16_f32 v246, v180, v181
    v_cvt_pk_bf16_f32 v247, v182, v183
    v_cvt_pk_bf16_f32 v248, v168, v169
    v_cvt_pk_bf16_f32 v249, v170, v171
    v_cvt_pk_bf16_f32 v250, v172, v173
    v_cvt_pk_bf16_f32 v251, v174, v175
    v_cvt_pk_bf16_f32 v252, v184, v185
    v_cvt_pk_bf16_f32 v253, v186, v187
    v_cvt_pk_bf16_f32 v254, v188, v189
    v_cvt_pk_bf16_f32 v255, v190, v191
    v_mov_b32 v32, 0
    v_mov_b32 v33, 0
    v_mov_b32 v34, 0
    v_mov_b32 v35, 0
    v_mov_b32 v36, 0
    v_mov_b32 v37, 0
    v_mov_b32 v38, 0
    v_mov_b32 v39, 0
    v_mov_b32 v40, 0
    v_mov_b32 v41, 0
    v_mov_b32 v42, 0
    v_mov_b32 v43, 0
    v_mov_b32 v44, 0
    v_mov_b32 v45, 0
    v_mov_b32 v46, 0
    v_mov_b32 v47, 0
    s_waitcnt lgkmcnt(9)
    v_mov_b32 v48, 0
    v_mov_b32 v49, 0
    v_mov_b32 v50, 0
    v_mov_b32 v51, 0
    s_waitcnt lgkmcnt(6)
    v_mov_b32 v52, 0
    v_mov_b32 v53, 0
    v_mov_b32 v54, 0
    v_mov_b32 v55, 0
    s_waitcnt lgkmcnt(3)
    v_mov_b32 v56, 0
    v_mov_b32 v57, 0
    v_mov_b32 v58, 0
    v_mov_b32 v59, 0
    s_waitcnt lgkmcnt(0)
    v_mov_b32 v60, 0
    v_mov_b32 v61, 0
    v_mov_b32 v62, 0
    v_mov_b32 v63, 0
    s_mov_b32 s24, s84
    s_mov_b32 s25, s85
    s_mov_b32 s26, 0x300000
    s_mov_b32 s27, 0x00020000
    s_mov_b32 s4, s82
    s_mov_b32 s5, s83
    s_mov_b32 s6, 0x400
    s_mov_b32 s7, 0x00020000
    v_lshrrev_b32 v24, 2, v0
    v_and_b32 v25, 3, v0
    v_mul_u32_u24 v26, 49152, v24
    v_lshl_add_u32 v26, v25, 4, v26
    v_lshlrev_b32 v27, 4, v24
    s_add_u32 s47, s2, 32
    s_and_b32 s58, s47, 7
    s_lshl_b32 s58, s58, 1
    s_bfe_u32 s46, s47, 0x10003
    s_add_u32 s58, s58, s46
    s_lshr_b32 s46, s47, 4
    s_lshl_b32 s46, s46, 4
    s_add_u32 s58, s58, s46
    s_lshl_b32 s46, s58, 6
    s_cmp_lt_u32 s2, 64
    s_cselect_b32 s46, s46, 0x7ff00000
    buffer_load_dwordx4 a[224:227], v27, s[4:7], 0 offen
    buffer_load_dwordx4 a[192:195], v26, s[24:27], s46 offen
    s_add_u32 s46, s46, 6144
    buffer_load_dwordx4 a[196:199], v26, s[24:27], s46 offen
    s_add_u32 s46, s46, 6144
    buffer_load_dwordx4 a[200:203], v26, s[24:27], s46 offen
    s_add_u32 s46, s46, 6144
    buffer_load_dwordx4 a[204:207], v26, s[24:27], s46 offen
    s_add_u32 s46, s46, 6144
    buffer_load_dwordx4 a[208:211], v26, s[24:27], s46 offen
    s_add_u32 s46, s46, 6144
    buffer_load_dwordx4 a[212:215], v26, s[24:27], s46 offen
    s_add_u32 s46, s46, 6144
    buffer_load_dwordx4 a[216:219], v26, s[24:27], s46 offen
    s_add_u32 s46, s46, 6144
    buffer_load_dwordx4 a[220:223], v26, s[24:27], s46 offen
    v_mov_b32 v14, v20
    v_mov_b32 v15, v22
    v_mov_b32 v16, v23
L_k2_init:
    s_mov_b32 s32, 0
    s_mov_b32 s33, 66560
    s_lshl_b32 s41, s28, 11
    s_add_u32 s41, s41, 32768
    v_mov_b32 v10, v6
    v_mov_b32 v11, v7
    v_mov_b32 v12, v8
    v_mov_b32 v13, v9
    ds_read_b128 a[128:131], v10 offset:0
    ds_read_b128 a[132:135], v11 offset:0
    ds_read_b128 a[136:139], v10 offset:64
    v_accvgpr_write_b32 a0, 0
    v_accvgpr_write_b32 a1, 0
    v_accvgpr_write_b32 a2, 0
    v_accvgpr_write_b32 a3, 0
    v_accvgpr_write_b32 a4, 0
    v_accvgpr_write_b32 a5, 0
    v_accvgpr_write_b32 a6, 0
    v_accvgpr_write_b32 a7, 0
    v_accvgpr_write_b32 a8, 0
    v_accvgpr_write_b32 a9, 0
    v_accvgpr_write_b32 a10, 0
    v_accvgpr_write_b32 a11, 0
    v_accvgpr_write_b32 a12, 0
    v_accvgpr_write_b32 a13, 0
    v_accvgpr_write_b32 a14, 0
    v_accvgpr_write_b32 a15, 0
    v_accvgpr_write_b32 a16, 0
    v_accvgpr_write_b32 a17, 0
    v_accvgpr_write_b32 a18, 0
    v_accvgpr_write_b32 a19, 0
    v_accvgpr_write_b32 a20, 0
    v_accvgpr_write_b32 a21, 0
    v_accvgpr_write_b32 a22, 0
    v_accvgpr_write_b32 a23, 0
    v_accvgpr_write_b32 a24, 0
    v_accvgpr_write_b32 a25, 0
    v_accvgpr_write_b32 a26, 0
    v_accvgpr_write_b32 a27, 0
    v_accvgpr_write_b32 a28, 0
    v_accvgpr_write_b32 a29, 0
    v_accvgpr_write_b32 a30, 0
    v_accvgpr_write_b32 a31, 0
    v_accvgpr_write_b32 a32, 0
    v_accvgpr_write_b32 a33, 0
    v_accvgpr_write_b32 a34, 0
    v_accvgpr_write_b32 a35, 0
    v_accvgpr_write_b32 a36, 0
    v_accvgpr_write_b32 a37, 0
    v_accvgpr_write_b32 a38, 0
    v_accvgpr_write_b32 a39, 0
    v_accvgpr_write_b32 a40, 0
    v_accvgpr_write_b32 a41, 0
    v_accvgpr_write_b32 a42, 0
    v_accvgpr_write_b32 a43, 0
    v_accvgpr_write_b32 a44, 0
    v_accvgpr_write_b32 a45, 0
    v_accvgpr_write_b32 a46, 0
    v_accvgpr_write_b32 a47, 0
    v_accvgpr_write_b32 a48, 0
    v_accvgpr_write_b32 a49, 0
    v_accvgpr_write_b32 a50, 0
    v_accvgpr_write_b32 a51, 0
    v_accvgpr_write_b32 a52, 0
    v_accvgpr_write_b32 a53, 0
    v_accvgpr_write_b32 a54, 0
    v_accvgpr_write_b32 a55, 0
    v_accvgpr_write_b32 a56, 0
    v_accvgpr_write_b32 a57, 0
    v_accvgpr_write_b32 a58, 0
    v_accvgpr_write_b32 a59, 0
    v_accvgpr_write_b32 a60, 0
    v_accvgpr_write_b32 a61, 0
    v_accvgpr_write_b32 a62, 0
    v_accvgpr_write_b32 a63, 0
    v_accvgpr_write_b32 a64, 0
    v_accvgpr_write_b32 a65, 0
    v_accvgpr_write_b32 a66, 0
    v_accvgpr_write_b32 a67, 0
    v_accvgpr_write_b32 a68, 0
    v_accvgpr_write_b32 a69, 0
    v_accvgpr_write_b32 a70, 0
    v_accvgpr_write_b32 a71, 0
    v_accvgpr_write_b32 a72, 0
    v_accvgpr_write_b32 a73, 0
    v_accvgpr_write_b32 a74, 0
    v_accvgpr_write_b32 a75, 0
    v_accvgpr_write_b32 a76, 0
    v_accvgpr_write_b32 a77, 0
    v_accvgpr_write_b32 a78, 0
    v_accvgpr_write_b32 a79, 0
    v_accvgpr_write_b32 a80, 0
    v_accvgpr_write_b32 a81, 0
    v_accvgpr_write_b32 a82, 0
    v_accvgpr_write_b32 a83, 0
    v_accvgpr_write_b32 a84, 0
    v_accvgpr_write_b32 a85, 0
    v_accvgpr_write_b32 a86, 0
    v_accvgpr_write_b32 a87, 0
    v_accvgpr_write_b32 a88, 0
    v_accvgpr_write_b32 a89, 0
    v_accvgpr_write_b32 a90, 0
    v_accvgpr_write_b32 a91, 0
    v_accvgpr_write_b32 a92, 0
    v_accvgpr_write_b32 a93, 0
    v_accvgpr_write_b32 a94, 0
    v_accvgpr_write_b32 a95, 0
    v_accvgpr_write_b32 a96, 0
    v_accvgpr_write_b32 a97, 0
    v_accvgpr_write_b32 a98, 0
    v_accvgpr_write_b32 a99, 0
    v_accvgpr_write_b32 a100, 0
    v_accvgpr_write_b32 a101, 0
    v_accvgpr_write_b32 a102, 0
    v_accvgpr_write_b32 a103, 0
    v_accvgpr_write_b32 a104, 0
    v_accvgpr_write_b32 a105, 0
    v_accvgpr_write_b32 a106, 0
    v_accvgpr_write_b32 a107, 0
    v_accvgpr_write_b32 a108, 0
    v_accvgpr_write_b32 a109, 0
    v_accvgpr_write_b32 a110, 0
    v_accvgpr_write_b32 a111, 0
    v_accvgpr_write_b32 a112, 0
    v_accvgpr_write_b32 a113, 0
    v_accvgpr_write_b32 a114, 0
    v_accvgpr_write_b32 a115, 0
    v_accvgpr_write_b32 a116, 0
    v_accvgpr_write_b32 a117, 0
    v_accvgpr_write_b32 a118, 0
    v_accvgpr_write_b32 a119, 0
    v_accvgpr_write_b32 a120, 0
    v_accvgpr_write_b32 a121, 0
    v_accvgpr_write_b32 a122, 0
    v_accvgpr_write_b32 a123, 0
    v_accvgpr_write_b32 a124, 0
    v_accvgpr_write_b32 a125, 0
    v_accvgpr_write_b32 a126, 0
    v_accvgpr_write_b32 a127, 0
    v_mov_b32 v20, 0
    v_mov_b32 v21, 0
    v_mov_b32 v22, 0
    v_mov_b32 v23, 0
    v_mov_b32 v96, 0
    v_mov_b32 v97, 0
    v_mov_b32 v98, 0
    v_mov_b32 v99, 0
    v_mov_b32 v100, 0
    v_mov_b32 v101, 0
    v_mov_b32 v102, 0
    v_mov_b32 v103, 0
    v_mov_b32 v112, 0
    v_mov_b32 v113, 0
    v_mov_b32 v114, 0
    v_mov_b32 v115, 0
    v_mov_b32 v116, 0
    v_mov_b32 v117, 0
    v_mov_b32 v118, 0xf149f2ca
    v_mov_b32 v119, 0xf149f2ca
    v_mov_b32 v104, 0xf149f2ca
    v_mov_b32 v105, 0xf149f2ca
    v_mov_b32 v106, 0xf149f2ca
    v_mov_b32 v107, 0xf149f2ca
    v_mov_b32 v108, 0xf149f2ca
    v_mov_b32 v109, 0xf149f2ca
    v_mov_b32 v110, 0xf149f2ca
    v_mov_b32 v111, 0xf149f2ca
    v_mov_b32 v120, 0xf149f2ca
    v_mov_b32 v121, 0xf149f2ca
    v_mov_b32 v122, 0xf149f2ca
    v_mov_b32 v123, 0xf149f2ca
    v_mov_b32 v124, 0xf149f2ca
    v_mov_b32 v125, 0xf149f2ca
    v_mov_b32 v126, 0xf149f2ca
    v_mov_b32 v127, 0xf149f2ca
    v_mov_b32 v144, 0
    v_mov_b32 v145, 0
    v_mov_b32 v146, 0
    v_mov_b32 v147, 0
    v_mov_b32 v148, 0
    v_mov_b32 v149, 0
    v_mov_b32 v150, 0
    v_mov_b32 v151, 0
    v_mov_b32 v152, 0
    v_mov_b32 v153, 0
    v_mov_b32 v154, 0
    v_mov_b32 v155, 0
    v_mov_b32 v156, 0
    v_mov_b32 v157, 0
    v_mov_b32 v158, 0
    v_mov_b32 v159, 0
    s_mov_b32 s31, 8
L_k2_att:
    s_add_u32 s37, s33, s42
    s_add_u32 s38, s33, s43
    s_add_u32 s35, s41, 8192
    s_mov_b32 s36, s41
    s_waitcnt lgkmcnt(2)
    v_mfma_f32_32x32x16_bf16 v[64:79], a[128:131], v[192:195], v[32:47]
    s_mov_b32 m0, s53
    s_xor_b32 s53, s53, 2048
    buffer_load_dwordx4 v14, s[64:67], s76 offen lds
    ds_read_b128 a[140:143], v11 offset:64
    v_add_f32 v23, v23, v117
    v_cvt_pk_bf16_f32 v154, v116, v117
    v_exp_f32 v118, v118
    v_mfma_f32_32x32x16_bf16 v[80:95], a[128:131], v[196:199], v[48:63]
    s_add_u32 m0, m0, 1024
    v_add_f32 v22, v22, v118
    v_exp_f32 v119, v119
    s_waitcnt lgkmcnt(2)
    v_mfma_f32_32x32x16_bf16 v[64:79], a[132:135], v[200:203], v[64:79]
    buffer_load_dwordx4 v14, s[68:71], s76 offen lds
    ds_read_b128 a[144:147], v10 offset:128
    v_add_f32 v23, v23, v119
    v_cvt_pk_bf16_f32 v155, v118, v119
    v_exp_f32 v104, v104
    v_mfma_f32_32x32x16_bf16 v[80:95], a[132:135], v[204:207], v[80:95]
    v_add_f32 v20, v20, v104
    v_exp_f32 v105, v105
    s_mov_b32 m0, s37
    s_waitcnt lgkmcnt(2)
    v_mfma_f32_32x32x16_bf16 v[64:79], a[136:139], v[208:211], v[64:79]
    ds_read_b128 a[148:151], v11 offset:128
    v_add_f32 v21, v21, v105
    v_cvt_pk_bf16_f32 v148, v104, v105
    v_exp_f32 v106, v106
    buffer_load_dwordx4 v2, s[8:11], s41 offen lds
    v_mfma_f32_32x32x16_bf16 v[80:95], a[136:139], v[212:215], v[80:95]
    s_add_u32 s76, s76, s77
    v_add_f32 v20, v20, v106
    v_exp_f32 v107, v107
    s_waitcnt lgkmcnt(2)
    v_mfma_f32_32x32x16_bf16 v[64:79], a[140:143], v[216:219], v[64:79]
    ds_read_b128 a[152:155], v10 offset:192
    v_add_f32 v21, v21, v107
    v_cvt_pk_bf16_f32 v149, v106, v107
    v_exp_f32 v108, v108
    v_mfma_f32_32x32x16_bf16 v[80:95], a[140:143], v[220:223], v[80:95]
    s_cmp_lt_u32 s57, s81
    s_cselect_b32 s56, s78, 0x7ff00000
    v_add_f32 v20, v20, v108
    v_exp_f32 v109, v109
    s_waitcnt lgkmcnt(2)
    v_mfma_f32_32x32x16_bf16 v[64:79], a[144:147], v[224:227], v[64:79]
    ds_read_b128 a[156:159], v11 offset:192
    v_add_f32 v21, v21, v109
    v_cvt_pk_bf16_f32 v150, v108, v109
    v_exp_f32 v110, v110
    v_mfma_f32_32x32x16_bf16 v[80:95], a[144:147], v[228:231], v[80:95]
    s_add_u32 s46, s56, s80
    s_add_u32 s78, s78, s79
    v_add_f32 v20, v20, v110
    v_exp_f32 v111, v111
    s_waitcnt lgkmcnt(2)
    v_mfma_f32_32x32x16_bf16 v[64:79], a[148:151], v[232:235], v[64:79]
    ds_read_b64_tr_b16 a[128:129], v12 offset:16896
    ds_read_b64_tr_b16 a[130:131], v12 offset:18944
    v_add_f32 v21, v21, v111
    v_cvt_pk_bf16_f32 v151, v110, v111
    v_exp_f32 v120, v120
    buffer_load_dwordx4 v2, s[8:11], s41 offen offset:1024 lds
    v_mfma_f32_32x32x16_bf16 v[80:95], a[148:151], v[236:239], v[80:95]
    buffer_store_dwordx4 a[160:163], v16, s[72:75], s56 offen sc0 sc1
    v_add_f32 v22, v22, v120
    v_exp_f32 v121, v121
    s_waitcnt lgkmcnt(3)
    v_mfma_f32_32x32x16_bf16 v[64:79], a[152:155], v[240:243], v[64:79]
    ds_read_b64_tr_b16 a[132:133], v13 offset:16896
    ds_read_b64_tr_b16 a[134:135], v13 offset:18944
    v_add_f32 v23, v23, v121
    v_cvt_pk_bf16_f32 v156, v120, v121
    v_exp_f32 v122, v122
    v_mfma_f32_32x32x16_bf16 v[80:95], a[152:155], v[244:247], v[80:95]
    buffer_store_dwordx4 a[164:167], v16, s[72:75], s46 offen sc0 sc1
    v_add_f32 v22, v22, v122
    v_exp_f32 v123, v123
    s_waitcnt lgkmcnt(4)
    v_mfma_f32_32x32x16_bf16 v[64:79], a[156:159], v[248:251], v[64:79]
    ds_read_b64_tr_b16 a[136:137], v12 offset:17920
    ds_read_b64_tr_b16 a[138:139], v12 offset:19968
    v_add_f32 v23, v23, v123
    v_cvt_pk_bf16_f32 v157, v122, v123
    v_exp_f32 v124, v124
    v_mfma_f32_32x32x16_bf16 v[80:95], a[156:159], v[252:255], v[80:95]
    s_add_u32 s57, s57, 1
    v_add_f32 v22, v22, v124
    v_exp_f32 v125, v125
    s_add_u32 m0, s37, 8448
    s_waitcnt lgkmcnt(4)
    v_mfma_f32_32x32x16_bf16 a[0:15], a[128:131], v[144:147], a[0:15]
    ds_read_b64_tr_b16 a[140:141], v13 offset:17920
    ds_read_b64_tr_b16 a[142:143], v13 offset:19968
    v_add_f32 v23, v23, v125
    v_cvt_pk_bf16_f32 v158, v124, v125
    v_exp_f32 v126, v126
    buffer_load_dwordx4 v3, s[8:11], s41 offen lds
    v_mfma_f32_32x32x16_bf16 a[16:31], a[128:131], v[152:155], a[16:31]
    v_add_f32 v22, v22, v126
    v_exp_f32 v127, v127
    s_waitcnt lgkmcnt(4)
    v_mfma_f32_32x32x16_bf16 a[32:47], a[132:135], v[144:147], a[32:47]
    ds_read_b64_tr_b16 a[144:145], v12 offset:20992
    ds_read_b64_tr_b16 a[146:147], v12 offset:23040
    v_exp_f32 v64, v64
    v_add_f32 v23, v23, v127
    v_cvt_pk_bf16_f32 v159, v126, v127
    v_mfma_f32_32x32x16_bf16 a[48:63], a[132:135], v[152:155], a[48:63]
    v_add_f32 v20, v20, v64
    v_exp_f32 v65, v65
    s_waitcnt lgkmcnt(4)
    v_mfma_f32_32x32x16_bf16 a[64:79], a[136:139], v[144:147], a[64:79]
    ds_read_b64_tr_b16 a[148:149], v13 offset:20992
    ds_read_b64_tr_b16 a[150:151], v13 offset:23040
    v_add_f32 v21, v21, v65
    v_cvt_pk_bf16_f32 v128, v64, v65
    v_exp_f32 v66, v66
    v_mfma_f32_32x32x16_bf16 a[80:95], a[136:139], v[152:155], a[80:95]
    v_add_f32 v20, v20, v66
    v_exp_f32 v67, v67
    s_waitcnt lgkmcnt(4)
    v_mfma_f32_32x32x16_bf16 a[96:111], a[140:143], v[144:147], a[96:111]
    ds_read_b64_tr_b16 a[152:153], v12 offset:22016
    ds_read_b64_tr_b16 a[154:155], v12 offset:24064
    v_add_f32 v21, v21, v67
    v_cvt_pk_bf16_f32 v129, v66, v67
    v_exp_f32 v68, v68
    buffer_load_dwordx4 v3, s[8:11], s41 offen offset:1024 lds
    v_mfma_f32_32x32x16_bf16 a[112:127], a[140:143], v[152:155], a[112:127]
    v_add_f32 v20, v20, v68
    v_exp_f32 v69, v69
    s_waitcnt lgkmcnt(4)
    v_mfma_f32_32x32x16_bf16 a[0:15], a[144:147], v[148:151], a[0:15]
    ds_read_b64_tr_b16 a[156:157], v13 offset:22016
    ds_read_b64_tr_b16 a[158:159], v13 offset:24064
    v_add_f32 v21, v21, v69
    v_cvt_pk_bf16_f32 v130, v68, v69
    v_exp_f32 v70, v70
    v_mfma_f32_32x32x16_bf16 a[16:31], a[144:147], v[156:159], a[16:31]
    v_add_f32 v20, v20, v70
    v_exp_f32 v71, v71
    s_waitcnt lgkmcnt(4)
    v_mfma_f32_32x32x16_bf16 a[32:47], a[148:151], v[148:151], a[32:47]
    ds_read_b128 a[128:131], v10 offset:8448
    v_add_f32 v21, v21, v71
    v_cvt_pk_bf16_f32 v131, v70, v71
    v_exp_f32 v80, v80
    v_mfma_f32_32x32x16_bf16 a[48:63], a[148:151], v[156:159], a[48:63]
    v_add_f32 v22, v22, v80
    v_exp_f32 v81, v81
    s_mov_b32 m0, s38
    s_waitcnt lgkmcnt(3)
    v_mfma_f32_32x32x16_bf16 a[64:79], a[152:155], v[148:151], a[64:79]
    ds_read_b128 a[132:135], v11 offset:8448
    v_add_f32 v23, v23, v81
    v_cvt_pk_bf16_f32 v136, v80, v81
    v_exp_f32 v82, v82
    buffer_load_dwordx4 v4, s[12:15], s36 offen lds
    v_mfma_f32_32x32x16_bf16 a[80:95], a[152:155], v[156:159], a[80:95]
    v_add_f32 v22, v22, v82
    v_exp_f32 v83, v83
    s_waitcnt lgkmcnt(2)
    v_mfma_f32_32x32x16_bf16 a[96:111], a[156:159], v[148:151], a[96:111]
    ds_read_b128 a[136:139], v10 offset:8512
    v_add_f32 v23, v23, v83
    v_cvt_pk_bf16_f32 v137, v82, v83
    v_exp_f32 v84, v84
    v_mfma_f32_32x32x16_bf16 a[112:127], a[156:159], v[156:159], a[112:127]
    v_add_f32 v22, v22, v84
    v_exp_f32 v85, v85
    s_waitcnt lgkmcnt(2)
    v_mfma_f32_32x32x16_bf16 v[96:111], a[128:131], v[192:195], v[32:47]
    ds_read_b128 a[140:143], v11 offset:8512
    v_add_f32 v23, v23, v85
    v_cvt_pk_bf16_f32 v138, v84, v85
    v_exp_f32 v86, v86
    v_mfma_f32_32x32x16_bf16 v[112:127], a[128:131], v[196:199], v[48:63]
    v_add_f32 v22, v22, v86
    v_exp_f32 v87, v87
    s_waitcnt lgkmcnt(2)
    v_mfma_f32_32x32x16_bf16 v[96:111], a[132:135], v[200:203], v[96:111]
    ds_read_b128 a[144:147], v10 offset:8576
    v_add_f32 v23, v23, v87
    v_cvt_pk_bf16_f32 v139, v86, v87
    v_exp_f32 v72, v72
    buffer_load_dwordx4 v5, s[12:15], s36 offen offset:1024 lds
    v_mfma_f32_32x32x16_bf16 v[112:127], a[132:135], v[204:207], v[112:127]
    v_add_f32 v20, v20, v72
    v_exp_f32 v73, v73
    s_waitcnt lgkmcnt(2)
    v_mfma_f32_32x32x16_bf16 v[96:111], a[136:139], v[208:211], v[96:111]
    ds_read_b128 a[148:151], v11 offset:8576
    v_add_f32 v21, v21, v73
    v_cvt_pk_bf16_f32 v132, v72, v73
    v_exp_f32 v74, v74
    v_mfma_f32_32x32x16_bf16 v[112:127], a[136:139], v[212:215], v[112:127]
    v_add_f32 v20, v20, v74
    v_exp_f32 v75, v75
    s_waitcnt lgkmcnt(2)
    v_mfma_f32_32x32x16_bf16 v[96:111], a[140:143], v[216:219], v[96:111]
    ds_read_b128 a[152:155], v10 offset:8640
    v_add_f32 v21, v21, v75
    v_cvt_pk_bf16_f32 v133, v74, v75
    v_exp_f32 v76, v76
    v_mfma_f32_32x32x16_bf16 v[112:127], a[140:143], v[220:223], v[112:127]
    v_add_f32 v20, v20, v76
    v_exp_f32 v77, v77
    s_add_u32 m0, s38, 8192
    s_waitcnt lgkmcnt(2)
    v_mfma_f32_32x32x16_bf16 v[96:111], a[144:147], v[224:227], v[96:111]
    ds_read_b128 a[156:159], v11 offset:8640
    v_add_f32 v21, v21, v77
    v_cvt_pk_bf16_f32 v134, v76, v77
    v_exp_f32 v78, v78
    buffer_load_dwordx4 v4, s[12:15], s35 offen lds
    v_mfma_f32_32x32x16_bf16 v[112:127], a[144:147], v[228:231], v[112:127]
    v_add_f32 v20, v20, v78
    v_exp_f32 v79, v79
    s_waitcnt lgkmcnt(2)
    v_mfma_f32_32x32x16_bf16 v[96:111], a[148:151], v[232:235], v[96:111]
    ds_read_b64_tr_b16 a[128:129], v12 offset:25088
    ds_read_b64_tr_b16 a[130:131], v12 offset:27136
    v_add_f32 v21, v21, v79
    v_cvt_pk_bf16_f32 v135, v78, v79
    v_exp_f32 v88, v88
    v_mfma_f32_32x32x16_bf16 v[112:127], a[148:151], v[236:239], v[112:127]
    v_add_f32 v22, v22, v88
    v_exp_f32 v89, v89
    s_waitcnt lgkmcnt(3)
    v_mfma_f32_32x32x16_bf16 v[96:111], a[152:155], v[240:243], v[96:111]
    ds_read_b64_tr_b16 a[132:133], v13 offset:25088
    ds_read_b64_tr_b16 a[134:135], v13 offset:27136
    v_add_f32 v23, v23, v89
    v_cvt_pk_bf16_f32 v140, v88, v89
    v_exp_f32 v90, v90
    v_mfma_f32_32x32x16_bf16 v[112:127], a[152:155], v[244:247], v[112:127]
    v_add_f32 v22, v22, v90
    v_exp_f32 v91, v91
    s_waitcnt lgkmcnt(4)
    v_mfma_f32_32x32x16_bf16 v[96:111], a[156:159], v[248:251], v[96:111]
    ds_read_b64_tr_b16 a[136:137], v12 offset:26112
    ds_read_b64_tr_b16 a[138:139], v12 offset:28160
    v_add_f32 v23, v23, v91
    v_cvt_pk_bf16_f32 v141, v90, v91
    v_exp_f32 v92, v92
    buffer_load_dwordx4 v5, s[12:15], s35 offen offset:1024 lds
    v_mfma_f32_32x32x16_bf16 v[112:127], a[156:159], v[252:255], v[112:127]
    v_add_f32 v22, v22, v92
    v_exp_f32 v93, v93
    s_waitcnt lgkmcnt(4)
    v_mfma_f32_32x32x16_bf16 a[0:15], a[128:131], v[128:131], a[0:15]
    ds_read_b64_tr_b16 a[140:141], v13 offset:26112
    ds_read_b64_tr_b16 a[142:143], v13 offset:28160
    v_add_f32 v23, v23, v93
    v_cvt_pk_bf16_f32 v142, v92, v93
    v_exp_f32 v94, v94
    s_add_u32 s32, s32, 33280
    s_cmp_ge_u32 s32, 133120
    s_cselect_b32 s32, 0, s32
    v_add_u32 v10, s32, v6
    v_add_u32 v11, s32, v7
    v_mfma_f32_32x32x16_bf16 a[16:31], a[128:131], v[136:139], a[16:31]
    v_add_f32 v22, v22, v94
    v_exp_f32 v95, v95
    s_waitcnt lgkmcnt(4)
    v_mfma_f32_32x32x16_bf16 a[32:47], a[132:135], v[128:131], a[32:47]
    ds_read_b64_tr_b16 a[144:145], v12 offset:29184
    ds_read_b64_tr_b16 a[146:147], v12 offset:31232
    v_add_f32 v23, v23, v95
    v_cvt_pk_bf16_f32 v143, v94, v95
    v_exp_f32 v96, v96
    v_mfma_f32_32x32x16_bf16 a[48:63], a[132:135], v[136:139], a[48:63]
    v_add_f32 v20, v20, v96
    v_exp_f32 v97, v97
    s_waitcnt lgkmcnt(4)
    v_mfma_f32_32x32x16_bf16 a[64:79], a[136:139], v[128:131], a[64:79]
    ds_read_b64_tr_b16 a[148:149], v13 offset:29184
    ds_read_b64_tr_b16 a[150:151], v13 offset:31232
    v_add_f32 v21, v21, v97
    v_cvt_pk_bf16_f32 v144, v96, v97
    v_exp_f32 v98, v98
    v_mfma_f32_32x32x16_bf16 a[80:95], a[136:139], v[136:139], a[80:95]
    v_add_f32 v20, v20, v98
    v_exp_f32 v99, v99
    s_waitcnt lgkmcnt(4)
    v_mfma_f32_32x32x16_bf16 a[96:111], a[140:143], v[128:131], a[96:111]
    ds_read_b64_tr_b16 a[152:153], v12 offset:30208
    ds_read_b64_tr_b16 a[154:155], v12 offset:32256
    v_add_f32 v21, v21, v99
    v_cvt_pk_bf16_f32 v145, v98, v99
    v_exp_f32 v100, v100
    v_mfma_f32_32x32x16_bf16 a[112:127], a[140:143], v[136:139], a[112:127]
    v_add_f32 v20, v20, v100
    v_exp_f32 v101, v101
    s_waitcnt vmcnt(12)
    s_barrier
    s_waitcnt lgkmcnt(4)
    v_mfma_f32_32x32x16_bf16 a[0:15], a[144:147], v[132:135], a[0:15]
    ds_read_b64_tr_b16 a[156:157], v13 offset:30208
    ds_read_b64_tr_b16 a[158:159], v13 offset:32256
    v_add_f32 v21, v21, v101
    v_cvt_pk_bf16_f32 v146, v100, v101
    v_exp_f32 v102, v102
    ds_read_b64_tr_b16 a[160:161], v15 offset:0
    ds_read_b64_tr_b16 a[162:163], v15 offset:256
    v_add_u32 v12, s32, v8
    v_add_u32 v13, s32, v9
    s_add_u32 s33, s33, 33280
    s_cmp_ge_u32 s33, 133120
    s_cselect_b32 s33, 0, s33
    s_add_u32 s41, s41, 16384
    v_mfma_f32_32x32x16_bf16 a[16:31], a[144:147], v[140:143], a[16:31]
    v_add_f32 v20, v20, v102
    v_exp_f32 v103, v103
    ds_read_b64_tr_b16 a[164:165], v15 offset:32
    ds_read_b64_tr_b16 a[166:167], v15 offset:288
    v_xor_b32 v15, 2048, v15
    s_waitcnt lgkmcnt(8)
    v_mfma_f32_32x32x16_bf16 a[32:47], a[148:151], v[132:135], a[32:47]
    ds_read_b128 a[128:131], v10 offset:0
    v_add_f32 v21, v21, v103
    v_cvt_pk_bf16_f32 v147, v102, v103
    v_exp_f32 v112, v112
    v_mfma_f32_32x32x16_bf16 a[48:63], a[148:151], v[140:143], a[48:63]
    v_add_f32 v22, v22, v112
    v_exp_f32 v113, v113
    s_waitcnt lgkmcnt(7)
    v_mfma_f32_32x32x16_bf16 a[64:79], a[152:155], v[132:135], a[64:79]
    ds_read_b128 a[132:135], v11 offset:0
    v_add_f32 v23, v23, v113
    v_cvt_pk_bf16_f32 v152, v112, v113
    v_exp_f32 v114, v114
    v_mfma_f32_32x32x16_bf16 a[80:95], a[152:155], v[140:143], a[80:95]
    v_add_f32 v22, v22, v114
    v_exp_f32 v115, v115
    s_waitcnt lgkmcnt(6)
    v_mfma_f32_32x32x16_bf16 a[96:111], a[156:159], v[132:135], a[96:111]
    ds_read_b128 a[136:139], v10 offset:64
    v_add_f32 v23, v23, v115
    v_cvt_pk_bf16_f32 v153, v114, v115
    v_exp_f32 v116, v116
    v_mfma_f32_32x32x16_bf16 a[112:127], a[156:159], v[140:143], a[112:127]
    v_add_f32 v22, v22, v116
    v_exp_f32 v117, v117
    s_sub_u32 s31, s31, 1
    s_cmp_lg_u32 s31, 0
    s_cbranch_scc1 L_k2_att
    s_waitcnt lgkmcnt(2)
    ds_read_b64_tr_b16 a[128:129], v12 offset:16896
    ds_read_b64_tr_b16 a[130:131], v12 offset:18944
    s_waitcnt lgkmcnt(3)
    ds_read_b64_tr_b16 a[132:133], v13 offset:16896
    ds_read_b64_tr_b16 a[134:135], v13 offset:18944
    s_waitcnt lgkmcnt(4)
    ds_read_b64_tr_b16 a[136:137], v12 offset:17920
    ds_read_b64_tr_b16 a[138:139], v12 offset:19968
    ds_read_b64_tr_b16 a[140:141], v13 offset:17920
    ds_read_b64_tr_b16 a[142:143], v13 offset:19968
    ds_read_b64_tr_b16 a[144:145], v12 offset:20992
    ds_read_b64_tr_b16 a[146:147], v12 offset:23040
    ds_read_b64_tr_b16 a[148:149], v13 offset:20992
    ds_read_b64_tr_b16 a[150:151], v13 offset:23040
    v_add_f32 v23, v23, v117
    v_cvt_pk_bf16_f32 v154, v116, v117
    v_exp_f32 v118, v118
    v_exp_f32 v119, v119
    v_add_f32 v22, v22, v118
    v_exp_f32 v104, v104
    v_add_f32 v23, v23, v119
    v_cvt_pk_bf16_f32 v155, v118, v119
    v_exp_f32 v105, v105
    v_add_f32 v20, v20, v104
    v_exp_f32 v106, v106
    v_add_f32 v21, v21, v105
    v_cvt_pk_bf16_f32 v148, v104, v105
    v_exp_f32 v107, v107
    v_add_f32 v20, v20, v106
    v_exp_f32 v108, v108
    v_add_f32 v21, v21, v107
    v_cvt_pk_bf16_f32 v149, v106, v107
    v_exp_f32 v109, v109
    v_add_f32 v20, v20, v108
    v_exp_f32 v110, v110
    v_add_f32 v21, v21, v109
    v_cvt_pk_bf16_f32 v150, v108, v109
    v_exp_f32 v111, v111
    v_add_f32 v20, v20, v110
    v_exp_f32 v120, v120
    v_add_f32 v21, v21, v111
    v_cvt_pk_bf16_f32 v151, v110, v111
    v_exp_f32 v121, v121
    v_add_f32 v22, v22, v120
    v_exp_f32 v122, v122
    v_add_f32 v23, v23, v121
    v_cvt_pk_bf16_f32 v156, v120, v121
    v_exp_f32 v123, v123
    v_add_f32 v22, v22, v122
    v_exp_f32 v124, v124
    v_add_f32 v23, v23, v123
    v_cvt_pk_bf16_f32 v157, v122, v123
    v_exp_f32 v125, v125
    v_add_f32 v22, v22, v124
    v_exp_f32 v126, v126
    v_add_f32 v23, v23, v125
    v_cvt_pk_bf16_f32 v158, v124, v125
    v_exp_f32 v127, v127
    v_add_f32 v22, v22, v126
    v_add_f32 v23, v23, v127
    v_cvt_pk_bf16_f32 v159, v126, v127
    v_add_f32 v20, v20, v21
    v_add_f32 v22, v22, v23
    v_mov_b32 v21, v20
    v_mov_b32 v23, v22
    s_nop 0
    v_permlane32_swap_b32 v20, v21
    v_permlane32_swap_b32 v22, v23
    v_add_f32 v20, v20, v21
    v_add_f32 v22, v22, v23
    s_waitcnt lgkmcnt(10)
    v_mfma_f32_32x32x16_bf16 a[0:15], a[128:131], v[144:147], a[0:15]
    ds_read_b64_tr_b16 a[152:153], v12 offset:22016
    ds_read_b64_tr_b16 a[154:155], v12 offset:24064
    v_mfma_f32_32x32x16_bf16 a[16:31], a[128:131], v[152:155], a[16:31]
    v_min_f32 v24, v20, v22
    v_max_f32 v25, v20, v22
    s_waitcnt lgkmcnt(10)
    v_mfma_f32_32x32x16_bf16 a[32:47], a[132:135], v[144:147], a[32:47]
    ds_read_b64_tr_b16 a[156:157], v13 offset:22016
    ds_read_b64_tr_b16 a[158:159], v13 offset:24064
    s_mov_b32 s48, 0x53800000
    v_mfma_f32_32x32x16_bf16 a[48:63], a[132:135], v[152:155], a[48:63]
    v_cmp_nle_f32 vcc, 0x21800000, v24
    v_cmp_nge_f32 s[46:47], s48, v25
    s_waitcnt lgkmcnt(10)
    v_mfma_f32_32x32x16_bf16 a[64:79], a[136:139], v[144:147], a[64:79]
    v_cmp_u_f32 s[50:51], v20, v22
    v_rcp_f32 v20, v20
    v_rcp_f32 v22, v22
    v_mfma_f32_32x32x16_bf16 a[80:95], a[136:139], v[152:155], a[80:95]
    s_waitcnt lgkmcnt(8)
    v_mfma_f32_32x32x16_bf16 a[96:111], a[140:143], v[144:147], a[96:111]
    s_or_b64 vcc, vcc, s[46:47]
    s_or_b64 vcc, vcc, s[50:51]
    s_cmp_lg_u64 vcc, 0
    s_cselect_b32 s46, 1, 0
    v_mov_b32 v24, s46
    s_lshl_b32 s46, s28, 2
    s_add_u32 s46, s46, 137472
    v_mov_b32 v25, s46
    ds_write_b32 v25, v24
    v_mfma_f32_32x32x16_bf16 a[112:127], a[140:143], v[152:155], a[112:127]
    s_waitcnt lgkmcnt(7)
    v_mfma_f32_32x32x16_bf16 a[0:15], a[144:147], v[148:151], a[0:15]
    v_mfma_f32_32x32x16_bf16 a[16:31], a[144:147], v[156:159], a[16:31]
    s_waitcnt lgkmcnt(5)
    v_mfma_f32_32x32x16_bf16 a[32:47], a[148:151], v[148:151], a[32:47]
    v_mfma_f32_32x32x16_bf16 a[48:63], a[148:151], v[156:159], a[48:63]
    s_waitcnt lgkmcnt(3)
    v_mfma_f32_32x32x16_bf16 a[64:79], a[152:155], v[148:151], a[64:79]
    v_mfma_f32_32x32x16_bf16 a[80:95], a[152:155], v[156:159], a[80:95]
    s_waitcnt lgkmcnt(1)
    v_mfma_f32_32x32x16_bf16 a[96:111], a[156:159], v[148:151], a[96:111]
    v_mfma_f32_32x32x16_bf16 a[112:127], a[156:159], v[156:159], a[112:127]
    s_waitcnt lgkmcnt(0)
    s_barrier
    v_mov_b32 v28, 137472
    ds_read_b128 v[24:27], v28
    s_waitcnt lgkmcnt(0)
    v_or_b32 v24, v24, v25
    v_or_b32 v26, v26, v27
    v_or_b32 v24, v24, v26
    s_nop 0
    v_readfirstlane_b32 s46, v24
    s_nop 3
    s_andn2_b32 s46, s46, s45
    s_cmp_lg_u32 s46, 0
    s_cbranch_scc1 L_k2_fallback
    v_lshlrev_b32 v24, 4, v1
    v_add_u32 v24, s34, v24
    v_add_u32 v25, 262144, v24
    s_mov_b32 s46, 4096
    v_accvgpr_read_b32 v64, a0
    v_accvgpr_read_b32 v65, a1
    v_accvgpr_read_b32 v66, a2
    v_accvgpr_read_b32 v67, a3
    v_accvgpr_read_b32 v68, a4
    v_accvgpr_read_b32 v69, a5
    v_accvgpr_read_b32 v70, a6
    v_accvgpr_read_b32 v71, a7
    v_mul_f32 v64, v64, v20
    v_mul_f32 v65, v65, v20
    v_mul_f32 v66, v66, v20
    v_mul_f32 v67, v67, v20
    v_mul_f32 v68, v68, v20
    v_mul_f32 v69, v69, v20
    v_mul_f32 v70, v70, v20
    v_mul_f32 v71, v71, v20
    v_cvt_pk_bf16_f32 v72, v64, v65
    v_cvt_pk_bf16_f32 v73, v66, v67
    v_cvt_pk_bf16_f32 v74, v68, v69
    v_cvt_pk_bf16_f32 v75, v70, v71
    buffer_store_dwordx4 v[72:75], v24, s[20:23], 0 offen offset:0 sc0 sc1
    v_accvgpr_read_b32 v80, a8
    v_accvgpr_read_b32 v81, a9
    v_accvgpr_read_b32 v82, a10
    v_accvgpr_read_b32 v83, a11
    v_accvgpr_read_b32 v84, a12
    v_accvgpr_read_b32 v85, a13
    v_accvgpr_read_b32 v86, a14
    v_accvgpr_read_b32 v87, a15
    v_mul_f32 v80, v80, v20
    v_mul_f32 v81, v81, v20
    v_mul_f32 v82, v82, v20
    v_mul_f32 v83, v83, v20
    v_mul_f32 v84, v84, v20
    v_mul_f32 v85, v85, v20
    v_mul_f32 v86, v86, v20
    v_mul_f32 v87, v87, v20
    v_cvt_pk_bf16_f32 v88, v80, v81
    v_cvt_pk_bf16_f32 v89, v82, v83
    v_cvt_pk_bf16_f32 v90, v84, v85
    v_cvt_pk_bf16_f32 v91, v86, v87
    buffer_store_dwordx4 v[88:91], v24, s[20:23], 0 offen offset:1024 sc0 sc1
    v_accvgpr_read_b32 v96, a32
    v_accvgpr_read_b32 v97, a33
    v_accvgpr_read_b32 v98, a34
    v_accvgpr_read_b32 v99, a35
    v_accvgpr_read_b32 v100, a36
    v_accvgpr_read_b32 v101, a37
    v_accvgpr_read_b32 v102, a38
    v_accvgpr_read_b32 v103, a39
    v_mul_f32 v96, v96, v20
    v_mul_f32 v97, v97, v20
    v_mul_f32 v98, v98, v20
    v_mul_f32 v99, v99, v20
    v_mul_f32 v100, v100, v20
    v_mul_f32 v101, v101, v20
    v_mul_f32 v102, v102, v20
    v_mul_f32 v103, v103, v20
    v_cvt_pk_bf16_f32 v104, v96, v97
    v_cvt_pk_bf16_f32 v105, v98, v99
    v_cvt_pk_bf16_f32 v106, v100, v101
    v_cvt_pk_bf16_f32 v107, v102, v103
    buffer_store_dwordx4 v[104:107], v24, s[20:23], 0 offen offset:2048 sc0 sc1
    v_accvgpr_read_b32 v112, a40
    v_accvgpr_read_b32 v113, a41
    v_accvgpr_read_b32 v114, a42
    v_accvgpr_read_b32 v115, a43
    v_accvgpr_read_b32 v116, a44
    v_accvgpr_read_b32 v117, a45
    v_accvgpr_read_b32 v118, a46
    v_accvgpr_read_b32 v119, a47
    v_mul_f32 v112, v112, v20
    v_mul_f32 v113, v113, v20
    v_mul_f32 v114, v114, v20
    v_mul_f32 v115, v115, v20
    v_mul_f32 v116, v116, v20
    v_mul_f32 v117, v117, v20
    v_mul_f32 v118, v118, v20
    v_mul_f32 v119, v119, v20
    v_cvt_pk_bf16_f32 v120, v112, v113
    v_cvt_pk_bf16_f32 v121, v114, v115
    v_cvt_pk_bf16_f32 v122, v116, v117
    v_cvt_pk_bf16_f32 v123, v118, v119
    buffer_store_dwordx4 v[120:123], v24, s[20:23], 0 offen offset:3072 sc0 sc1
    v_accvgpr_read_b32 v64, a64
    v_accvgpr_read_b32 v65, a65
    v_accvgpr_read_b32 v66, a66
    v_accvgpr_read_b32 v67, a67
    v_accvgpr_read_b32 v68, a68
    v_accvgpr_read_b32 v69, a69
    v_accvgpr_read_b32 v70, a70
    v_accvgpr_read_b32 v71, a71
    v_mul_f32 v64, v64, v20
    v_mul_f32 v65, v65, v20
    v_mul_f32 v66, v66, v20
    v_mul_f32 v67, v67, v20
    v_mul_f32 v68, v68, v20
    v_mul_f32 v69, v69, v20
    v_mul_f32 v70, v70, v20
    v_mul_f32 v71, v71, v20
    v_cvt_pk_bf16_f32 v72, v64, v65
    v_cvt_pk_bf16_f32 v73, v66, v67
    v_cvt_pk_bf16_f32 v74, v68, v69
    v_cvt_pk_bf16_f32 v75, v70, v71
    buffer_store_dwordx4 v[72:75], v24, s[20:23], s46 offen offset:0 sc0 sc1
    v_accvgpr_read_b32 v80, a72
    v_accvgpr_read_b32 v81, a73
    v_accvgpr_read_b32 v82, a74
    v_accvgpr_read_b32 v83, a75
    v_accvgpr_read_b32 v84, a76
    v_accvgpr_read_b32 v85, a77
    v_accvgpr_read_b32 v86, a78
    v_accvgpr_read_b32 v87, a79
    v_mul_f32 v80, v80, v20
    v_mul_f32 v81, v81, v20
    v_mul_f32 v82, v82, v20
    v_mul_f32 v83, v83, v20
    v_mul_f32 v84, v84, v20
    v_mul_f32 v85, v85, v20
    v_mul_f32 v86, v86, v20
    v_mul_f32 v87, v87, v20
    v_cvt_pk_bf16_f32 v88, v80, v81
    v_cvt_pk_bf16_f32 v89, v82, v83
    v_cvt_pk_bf16_f32 v90, v84, v85
    v_cvt_pk_bf16_f32 v91, v86, v87
    buffer_store_dwordx4 v[88:91], v24, s[20:23], s46 offen offset:1024 sc0 sc1
    v_accvgpr_read_b32 v96, a96
    v_accvgpr_read_b32 v97, a97
    v_accvgpr_read_b32 v98, a98
    v_accvgpr_read_b32 v99, a99
    v_accvgpr_read_b32 v100, a100
    v_accvgpr_read_b32 v101, a101
    v_accvgpr_read_b32 v102, a102
    v_accvgpr_read_b32 v103, a103
    v_mul_f32 v96, v96, v20
    v_mul_f32 v97, v97, v20
    v_mul_f32 v98, v98, v20
    v_mul_f32 v99, v99, v20
    v_mul_f32 v100, v100, v20
    v_mul_f32 v101, v101, v20
    v_mul_f32 v102, v102, v20
    v_mul_f32 v103, v103, v20
    v_cvt_pk_bf16_f32 v104, v96, v97
    v_cvt_pk_bf16_f32 v105, v98, v99
    v_cvt_pk_bf16_f32 v106, v100, v101
    v_cvt_pk_bf16_f32 v107, v102, v103
    buffer_store_dwordx4 v[104:107], v24, s[20:23], s46 offen offset:2048 sc0 sc1
    v_accvgpr_read_b32 v112, a104
    v_accvgpr_read_b32 v113, a105
    v_accvgpr_read_b32 v114, a106
    v_accvgpr_read_b32 v115, a107
    v_accvgpr_read_b32 v116, a108
    v_accvgpr_read_b32 v117, a109
    v_accvgpr_read_b32 v118, a110
    v_accvgpr_read_b32 v119, a111
    v_mul_f32 v112, v112, v20
    v_mul_f32 v113, v113, v20
    v_mul_f32 v114, v114, v20
    v_mul_f32 v115, v115, v20
    v_mul_f32 v116, v116, v20
    v_mul_f32 v117, v117, v20
    v_mul_f32 v118, v118, v20
    v_mul_f32 v119, v119, v20
    v_cvt_pk_bf16_f32 v120, v112, v113
    v_cvt_pk_bf16_f32 v121, v114, v115
    v_cvt_pk_bf16_f32 v122, v116, v117
    v_cvt_pk_bf16_f32 v123, v118, v119
    buffer_store_dwordx4 v[120:123], v24, s[20:23], s46 offen offset:3072 sc0 sc1
    v_accvgpr_read_b32 v64, a16
    v_accvgpr_read_b32 v65, a17
    v_accvgpr_read_b32 v66, a18
    v_accvgpr_read_b32 v67, a19
    v_accvgpr_read_b32 v68, a20
    v_accvgpr_read_b32 v69, a21
    v_accvgpr_read_b32 v70, a22
    v_accvgpr_read_b32 v71, a23
    v_mul_f32 v64, v64, v22
    v_mul_f32 v65, v65, v22
    v_mul_f32 v66, v66, v22
    v_mul_f32 v67, v67, v22
    v_mul_f32 v68, v68, v22
    v_mul_f32 v69, v69, v22
    v_mul_f32 v70, v70, v22
    v_mul_f32 v71, v71, v22
    v_cvt_pk_bf16_f32 v72, v64, v65
    v_cvt_pk_bf16_f32 v73, v66, v67
    v_cvt_pk_bf16_f32 v74, v68, v69
    v_cvt_pk_bf16_f32 v75, v70, v71
    buffer_store_dwordx4 v[72:75], v25, s[20:23], 0 offen offset:0 sc0 sc1
    v_accvgpr_read_b32 v80, a24
    v_accvgpr_read_b32 v81, a25
    v_accvgpr_read_b32 v82, a26
    v_accvgpr_read_b32 v83, a27
    v_accvgpr_read_b32 v84, a28
    v_accvgpr_read_b32 v85, a29
    v_accvgpr_read_b32 v86, a30
    v_accvgpr_read_b32 v87, a31
    v_mul_f32 v80, v80, v22
    v_mul_f32 v81, v81, v22
    v_mul_f32 v82, v82, v22
    v_mul_f32 v83, v83, v22
    v_mul_f32 v84, v84, v22
    v_mul_f32 v85, v85, v22
    v_mul_f32 v86, v86, v22
    v_mul_f32 v87, v87, v22
    v_cvt_pk_bf16_f32 v88, v80, v81
    v_cvt_pk_bf16_f32 v89, v82, v83
    v_cvt_pk_bf16_f32 v90, v84, v85
    v_cvt_pk_bf16_f32 v91, v86, v87
    buffer_store_dwordx4 v[88:91], v25, s[20:23], 0 offen offset:1024 sc0 sc1
    v_accvgpr_read_b32 v96, a48
    v_accvgpr_read_b32 v97, a49
    v_accvgpr_read_b32 v98, a50
    v_accvgpr_read_b32 v99, a51
    v_accvgpr_read_b32 v100, a52
    v_accvgpr_read_b32 v101, a53
    v_accvgpr_read_b32 v102, a54
    v_accvgpr_read_b32 v103, a55
    v_mul_f32 v96, v96, v22
    v_mul_f32 v97, v97, v22
    v_mul_f32 v98, v98, v22
    v_mul_f32 v99, v99, v22
    v_mul_f32 v100, v100, v22
    v_mul_f32 v101, v101, v22
    v_mul_f32 v102, v102, v22
    v_mul_f32 v103, v103, v22
    v_cvt_pk_bf16_f32 v104, v96, v97
    v_cvt_pk_bf16_f32 v105, v98, v99
    v_cvt_pk_bf16_f32 v106, v100, v101
    v_cvt_pk_bf16_f32 v107, v102, v103
    buffer_store_dwordx4 v[104:107], v25, s[20:23], 0 offen offset:2048 sc0 sc1
    v_accvgpr_read_b32 v112, a56
    v_accvgpr_read_b32 v113, a57
    v_accvgpr_read_b32 v114, a58
    v_accvgpr_read_b32 v115, a59
    v_accvgpr_read_b32 v116, a60
    v_accvgpr_read_b32 v117, a61
    v_accvgpr_read_b32 v118, a62
    v_accvgpr_read_b32 v119, a63
    v_mul_f32 v112, v112, v22
    v_mul_f32 v113, v113, v22
    v_mul_f32 v114, v114, v22
    v_mul_f32 v115, v115, v22
    v_mul_f32 v116, v116, v22
    v_mul_f32 v117, v117, v22
    v_mul_f32 v118, v118, v22
    v_mul_f32 v119, v119, v22
    v_cvt_pk_bf16_f32 v120, v112, v113
    v_cvt_pk_bf16_f32 v121, v114, v115
    v_cvt_pk_bf16_f32 v122, v116, v117
    v_cvt_pk_bf16_f32 v123, v118, v119
    buffer_store_dwordx4 v[120:123], v25, s[20:23], 0 offen offset:3072 sc0 sc1
    v_accvgpr_read_b32 v64, a80
    v_accvgpr_read_b32 v65, a81
    v_accvgpr_read_b32 v66, a82
    v_accvgpr_read_b32 v67, a83
    v_accvgpr_read_b32 v68, a84
    v_accvgpr_read_b32 v69, a85
    v_accvgpr_read_b32 v70, a86
    v_accvgpr_read_b32 v71, a87
    v_mul_f32 v64, v64, v22
    v_mul_f32 v65, v65, v22
    v_mul_f32 v66, v66, v22
    v_mul_f32 v67, v67, v22
    v_mul_f32 v68, v68, v22
    v_mul_f32 v69, v69, v22
    v_mul_f32 v70, v70, v22
    v_mul_f32 v71, v71, v22
    v_cvt_pk_bf16_f32 v72, v64, v65
    v_cvt_pk_bf16_f32 v73, v66, v67
    v_cvt_pk_bf16_f32 v74, v68, v69
    v_cvt_pk_bf16_f32 v75, v70, v71
    buffer_store_dwordx4 v[72:75], v25, s[20:23], s46 offen offset:0 sc0 sc1
    v_accvgpr_read_b32 v80, a88
    v_accvgpr_read_b32 v81, a89
    v_accvgpr_read_b32 v82, a90
    v_accvgpr_read_b32 v83, a91
    v_accvgpr_read_b32 v84, a92
    v_accvgpr_read_b32 v85, a93
    v_accvgpr_read_b32 v86, a94
    v_accvgpr_read_b32 v87, a95
    v_mul_f32 v80, v80, v22
    v_mul_f32 v81, v81, v22
    v_mul_f32 v82, v82, v22
    v_mul_f32 v83, v83, v22
    v_mul_f32 v84, v84, v22
    v_mul_f32 v85, v85, v22
    v_mul_f32 v86, v86, v22
    v_mul_f32 v87, v87, v22
    v_cvt_pk_bf16_f32 v88, v80, v81
    v_cvt_pk_bf16_f32 v89, v82, v83
    v_cvt_pk_bf16_f32 v90, v84, v85
    v_cvt_pk_bf16_f32 v91, v86, v87
    buffer_store_dwordx4 v[88:91], v25, s[20:23], s46 offen offset:1024 sc0 sc1
    v_accvgpr_read_b32 v96, a112
    v_accvgpr_read_b32 v97, a113
    v_accvgpr_read_b32 v98, a114
    v_accvgpr_read_b32 v99, a115
    v_accvgpr_read_b32 v100, a116
    v_accvgpr_read_b32 v101, a117
    v_accvgpr_read_b32 v102, a118
    v_accvgpr_read_b32 v103, a119
    v_mul_f32 v96, v96, v22
    v_mul_f32 v97, v97, v22
    v_mul_f32 v98, v98, v22
    v_mul_f32 v99, v99, v22
    v_mul_f32 v100, v100, v22
    v_mul_f32 v101, v101, v22
    v_mul_f32 v102, v102, v22
    v_mul_f32 v103, v103, v22
    v_cvt_pk_bf16_f32 v104, v96, v97
    v_cvt_pk_bf16_f32 v105, v98, v99
    v_cvt_pk_bf16_f32 v106, v100, v101
    v_cvt_pk_bf16_f32 v107, v102, v103
    buffer_store_dwordx4 v[104:107], v25, s[20:23], s46 offen offset:2048 sc0 sc1
    v_accvgpr_read_b32 v112, a120
    v_accvgpr_read_b32 v113, a121
    v_accvgpr_read_b32 v114, a122
    v_accvgpr_read_b32 v115, a123
    v_accvgpr_read_b32 v116, a124
    v_accvgpr_read_b32 v117, a125
    v_accvgpr_read_b32 v118, a126
    v_accvgpr_read_b32 v119, a127
    v_mul_f32 v112, v112, v22
    v_mul_f32 v113, v113, v22
    v_mul_f32 v114, v114, v22
    v_mul_f32 v115, v115, v22
    v_mul_f32 v116, v116, v22
    v_mul_f32 v117, v117, v22
    v_mul_f32 v118, v118, v22
    v_mul_f32 v119, v119, v22
    v_cvt_pk_bf16_f32 v120, v112, v113
    v_cvt_pk_bf16_f32 v121, v114, v115
    v_cvt_pk_bf16_f32 v122, v116, v117
    v_cvt_pk_bf16_f32 v123, v118, v119
    buffer_store_dwordx4 v[120:123], v25, s[20:23], s46 offen offset:3072 sc0 sc1
    s_cmp_ge_u32 s2, 64
    s_cbranch_scc1 L_mg_noc
    v_lshrrev_b32 v236, 2, v0
    v_and_b32 v237, 3, v0
    v_mul_u32_u24 v240, 49152, v236
    v_lshl_add_u32 v240, v237, 4, v240
    v_lshlrev_b32 v241, 4, v236
    v_lshlrev_b32 v243, 7, v236
    v_lshl_add_u32 v243, v237, 5, v243
    v_add_u32 v243, 147456, v243
    v_lshrrev_b32 v236, 3, v0
    v_and_b32 v237, 7, v0
    v_lshlrev_b32 v242, 9, v236
    v_lshl_add_u32 v242, v237, 4, v242
    v_lshrrev_b32 v236, 3, v1
    v_lshlrev_b32 v244, 10, v236
    v_and_b32 v237, 7, v1
    v_lshl_add_u32 v244, v237, 2, v244
    s_lshl_b32 s46, s28, 5
    s_add_u32 s46, s46, 147456
    v_add_u32 v244, s46, v244
    s_waitcnt vmcnt(16)
    v_accvgpr_read_b32 v100, a224
    v_accvgpr_read_b32 v101, a225
    v_accvgpr_read_b32 v102, a226
    v_accvgpr_read_b32 v103, a227
    v_accvgpr_read_b32 v192, a192
    v_accvgpr_read_b32 v193, a193
    v_accvgpr_read_b32 v194, a194
    v_accvgpr_read_b32 v195, a195
    v_accvgpr_read_b32 v196, a196
    v_accvgpr_read_b32 v197, a197
    v_accvgpr_read_b32 v198, a198
    v_accvgpr_read_b32 v199, a199
    v_accvgpr_read_b32 v200, a200
    v_accvgpr_read_b32 v201, a201
    v_accvgpr_read_b32 v202, a202
    v_accvgpr_read_b32 v203, a203
    v_accvgpr_read_b32 v204, a204
    v_accvgpr_read_b32 v205, a205
    v_accvgpr_read_b32 v206, a206
    v_accvgpr_read_b32 v207, a207
    v_accvgpr_read_b32 v208, a208
    v_accvgpr_read_b32 v209, a209
    v_accvgpr_read_b32 v210, a210
    v_accvgpr_read_b32 v211, a211
    v_accvgpr_read_b32 v212, a212
    v_accvgpr_read_b32 v213, a213
    v_accvgpr_read_b32 v214, a214
    v_accvgpr_read_b32 v215, a215
    v_accvgpr_read_b32 v216, a216
    v_accvgpr_read_b32 v217, a217
    v_accvgpr_read_b32 v218, a218
    v_accvgpr_read_b32 v219, a219
    v_accvgpr_read_b32 v220, a220
    v_accvgpr_read_b32 v221, a221
    v_accvgpr_read_b32 v222, a222
    v_accvgpr_read_b32 v223, a223
    v_lshlrev_b32 v104, 16, v100
    v_and_b32 v105, 0xffff0000, v100
    v_lshlrev_b32 v106, 16, v101
    v_and_b32 v107, 0xffff0000, v101
    v_lshlrev_b32 v108, 16, v102
    v_and_b32 v109, 0xffff0000, v102
    v_lshlrev_b32 v110, 16, v103
    v_and_b32 v111, 0xffff0000, v103
    v_mul_f32 v144, 0xbfb8aa3b, v104
    v_mul_f32 v145, 0xbfb8aa3b, v105
    v_mul_f32 v146, 0xbfb8aa3b, v106
    v_mul_f32 v147, 0xbfb8aa3b, v107
    v_mul_f32 v148, 0xbfb8aa3b, v108
    v_mul_f32 v149, 0xbfb8aa3b, v109
    v_mul_f32 v150, 0xbfb8aa3b, v110
    v_mul_f32 v151, 0xbfb8aa3b, v111
    v_exp_f32 v144, v144
    v_exp_f32 v145, v145
    v_exp_f32 v146, v146
    v_exp_f32 v147, v147
    v_exp_f32 v148, v148
    v_exp_f32 v149, v149
    v_exp_f32 v150, v150
    v_exp_f32 v151, v151
    v_add_f32 v144, 1.0, v144
    v_add_f32 v145, 1.0, v145
    v_add_f32 v146, 1.0, v146
    v_add_f32 v147, 1.0, v147
    v_add_f32 v148, 1.0, v148
    v_add_f32 v149, 1.0, v149
    v_add_f32 v150, 1.0, v150
    v_add_f32 v151, 1.0, v151
    v_rcp_f32 v144, v144
    v_rcp_f32 v145, v145
    v_rcp_f32 v146, v146
    v_rcp_f32 v147, v147
    v_rcp_f32 v148, v148
    v_rcp_f32 v149, v149
    v_rcp_f32 v150, v150
    v_rcp_f32 v151, v151
    v_mul_f32 v104, v104, v144
    v_mul_f32 v105, v105, v145
    v_mul_f32 v106, v106, v146
    v_mul_f32 v107, v107, v147
    v_mul_f32 v108, v108, v148
    v_mul_f32 v109, v109, v149
    v_mul_f32 v110, v110, v150
    v_mul_f32 v111, v111, v151
    v_cvt_pk_bf16_f32 v224, v104, v105
    v_cvt_pk_bf16_f32 v225, v106, v107
    v_cvt_pk_bf16_f32 v226, v108, v109
    v_cvt_pk_bf16_f32 v227, v110, v111
    s_mov_b32 s44, 0x05040100
    s_mov_b32 s45, 0x07060302
    s_barrier
    v_mov_b32 v228, 0
    v_mov_b32 v229, 0
    v_mov_b32 v230, 0
    v_mov_b32 v231, 0
    v_mov_b32 v232, 0
    v_mov_b32 v233, 0
    v_mov_b32 v234, 0
    v_mov_b32 v235, 0
    v_perm_b32 v236, v196, v192, s44
    v_perm_b32 v237, v196, v192, s45
    v_dot2c_f32_bf16 v228, v236, v224
    v_dot2c_f32_bf16 v229, v237, v224
    v_perm_b32 v238, v197, v193, s44
    v_perm_b32 v239, v197, v193, s45
    v_dot2c_f32_bf16 v230, v238, v224
    v_dot2c_f32_bf16 v231, v239, v224
    v_perm_b32 v236, v198, v194, s44
    v_perm_b32 v237, v198, v194, s45
    v_dot2c_f32_bf16 v232, v236, v224
    v_dot2c_f32_bf16 v233, v237, v224
    v_perm_b32 v238, v199, v195, s44
    v_perm_b32 v239, v199, v195, s45
    v_dot2c_f32_bf16 v234, v238, v224
    v_dot2c_f32_bf16 v235, v239, v224
    v_perm_b32 v236, v204, v200, s44
    v_perm_b32 v237, v204, v200, s45
    v_dot2c_f32_bf16 v228, v236, v225
    v_dot2c_f32_bf16 v229, v237, v225
    v_perm_b32 v238, v205, v201, s44
    v_perm_b32 v239, v205, v201, s45
    v_dot2c_f32_bf16 v230, v238, v225
    v_dot2c_f32_bf16 v231, v239, v225
    v_perm_b32 v236, v206, v202, s44
    v_perm_b32 v237, v206, v202, s45
    v_dot2c_f32_bf16 v232, v236, v225
    v_dot2c_f32_bf16 v233, v237, v225
    v_perm_b32 v238, v207, v203, s44
    v_perm_b32 v239, v207, v203, s45
    v_dot2c_f32_bf16 v234, v238, v225
    v_dot2c_f32_bf16 v235, v239, v225
    v_perm_b32 v236, v212, v208, s44
    v_perm_b32 v237, v212, v208, s45
    v_dot2c_f32_bf16 v228, v236, v226
    v_dot2c_f32_bf16 v229, v237, v226
    v_perm_b32 v238, v213, v209, s44
    v_perm_b32 v239, v213, v209, s45
    v_dot2c_f32_bf16 v230, v238, v226
    v_dot2c_f32_bf16 v231, v239, v226
    v_perm_b32 v236, v214, v210, s44
    v_perm_b32 v237, v214, v210, s45
    v_dot2c_f32_bf16 v232, v236, v226
    v_dot2c_f32_bf16 v233, v237, v226
    v_perm_b32 v238, v215, v211, s44
    v_perm_b32 v239, v215, v211, s45
    v_dot2c_f32_bf16 v234, v238, v226
    v_dot2c_f32_bf16 v235, v239, v226
    v_perm_b32 v236, v220, v216, s44
    v_perm_b32 v237, v220, v216, s45
    v_dot2c_f32_bf16 v228, v236, v227
    v_dot2c_f32_bf16 v229, v237, v227
    v_perm_b32 v238, v221, v217, s44
    v_perm_b32 v239, v221, v217, s45
    v_dot2c_f32_bf16 v230, v238, v227
    v_dot2c_f32_bf16 v231, v239, v227
    v_perm_b32 v236, v222, v218, s44
    v_perm_b32 v237, v222, v218, s45
    v_dot2c_f32_bf16 v232, v236, v227
    v_dot2c_f32_bf16 v233, v237, v227
    v_perm_b32 v238, v223, v219, s44
    v_perm_b32 v239, v223, v219, s45
    v_dot2c_f32_bf16 v234, v238, v227
    v_dot2c_f32_bf16 v235, v239, v227
    s_nop 3
    ds_write_b128 v243, v[228:231]
    ds_write_b128 v243, v[232:235] offset:16
    s_waitcnt lgkmcnt(0)
    s_barrier
    ds_read_b32 v24, v244 offset:0
    ds_read_b32 v25, v244 offset:128
    ds_read_b32 v26, v244 offset:256
    ds_read_b32 v27, v244 offset:384
    ds_read_b32 v28, v244 offset:512
    ds_read_b32 v29, v244 offset:640
    ds_read_b32 v30, v244 offset:768
    ds_read_b32 v31, v244 offset:896
    s_mov_b32 s8, s54
    s_mov_b32 s9, s55
    s_mov_b32 s10, 0x3000
    s_mov_b32 s11, 0x00020000
    s_lshr_b32 s46, s58, 4
    s_cmp_eq_u32 s46, 4
    s_cselect_b32 s37, 0x3f800000, 0
    s_mov_b32 s38, 1.0
    s_waitcnt lgkmcnt(3)
    v_add_f32 v24, v24, v28
    s_waitcnt lgkmcnt(2)
    v_add_f32 v25, v25, v29
    s_waitcnt lgkmcnt(1)
    v_add_f32 v26, v26, v30
    s_waitcnt lgkmcnt(0)
    v_add_f32 v27, v27, v31
    v_add_f32 v24, v24, v26
    v_add_f32 v25, v25, v27
    v_add_f32 v24, v24, v25
    s_nop 1
    v_add_f32_dpp v24, v24, v24 row_ror:8 row_mask:0xf bank_mask:0xf
    v_mov_b32 v25, v24
    s_nop 1
    v_permlane16_swap_b32 v24, v25
    v_add_f32 v24, v24, v25
    v_mov_b32 v25, v24
    s_nop 1
    v_permlane32_swap_b32 v24, v25
    v_add_f32 v24, v24, v25
    v_cvt_pk_bf16_f32 v24, v24, v24
    v_lshlrev_b32 v24, 16, v24
    v_add_f32 v24, s37, v24
    v_cvt_pk_bf16_f32 v24, v24, v24
    v_lshlrev_b32 v24, 16, v24
    v_mul_f32 v24, s38, v24
    s_lshl_b32 s46, s58, 7
    s_lshl_b32 s47, s28, 5
    s_add_u32 s46, s46, s47
    v_lshlrev_b32 v25, 2, v1
    s_mov_b64 exec, 0xff
    buffer_store_dword v24, v25, s[8:11], s46 offen
    s_mov_b64 exec, -1
L_mg_noc:
    s_endpgm
L_k2_fallback:
    s_waitcnt vmcnt(0) lgkmcnt(0)
    s_nop 15
    s_nop 3
    s_mov_b32 s45, 1
    v_mov_b32 v20, 0xff61b1e6
    v_mov_b32 v22, 0xff61b1e6
    v_add_u32 v10, 33280, v6
    v_add_u32 v11, 33280, v7
    s_lshl_b32 s41, s28, 11
    s_mov_b32 s31, 16
L_k2_max:
    s_barrier
    s_add_u32 m0, s42, 33280
    s_nop 0
    buffer_load_dwordx4 v2, s[8:11], s41 offen lds
    buffer_load_dwordx4 v2, s[8:11], s41 offen offset:1024 lds
    s_waitcnt vmcnt(0)
    s_barrier
    ds_read_b128 a[128:131], v10 offset:0
    ds_read_b128 a[132:135], v11 offset:0
    ds_read_b128 a[136:139], v10 offset:64
    ds_read_b128 a[140:143], v11 offset:64
    ds_read_b128 a[144:147], v10 offset:128
    ds_read_b128 a[148:151], v11 offset:128
    ds_read_b128 a[152:155], v10 offset:192
    ds_read_b128 a[156:159], v11 offset:192
    s_waitcnt lgkmcnt(7)
    v_mfma_f32_32x32x16_bf16 v[64:79], a[128:131], v[192:195], 0
    v_mfma_f32_32x32x16_bf16 v[80:95], a[128:131], v[196:199], 0
    s_waitcnt lgkmcnt(6)
    v_mfma_f32_32x32x16_bf16 v[64:79], a[132:135], v[200:203], v[64:79]
    v_mfma_f32_32x32x16_bf16 v[80:95], a[132:135], v[204:207], v[80:95]
    s_waitcnt lgkmcnt(5)
    v_mfma_f32_32x32x16_bf16 v[64:79], a[136:139], v[208:211], v[64:79]
    v_mfma_f32_32x32x16_bf16 v[80:95], a[136:139], v[212:215], v[80:95]
    s_waitcnt lgkmcnt(4)
    v_mfma_f32_32x32x16_bf16 v[64:79], a[140:143], v[216:219], v[64:79]
    v_mfma_f32_32x32x16_bf16 v[80:95], a[140:143], v[220:223], v[80:95]
    s_waitcnt lgkmcnt(3)
    v_mfma_f32_32x32x16_bf16 v[64:79], a[144:147], v[224:227], v[64:79]
    v_mfma_f32_32x32x16_bf16 v[80:95], a[144:147], v[228:231], v[80:95]
    s_waitcnt lgkmcnt(2)
    v_mfma_f32_32x32x16_bf16 v[64:79], a[148:151], v[232:235], v[64:79]
    v_mfma_f32_32x32x16_bf16 v[80:95], a[148:151], v[236:239], v[80:95]
    s_waitcnt lgkmcnt(1)
    v_mfma_f32_32x32x16_bf16 v[64:79], a[152:155], v[240:243], v[64:79]
    v_mfma_f32_32x32x16_bf16 v[80:95], a[152:155], v[244:247], v[80:95]
    s_waitcnt lgkmcnt(0)
    v_mfma_f32_32x32x16_bf16 v[64:79], a[156:159], v[248:251], v[64:79]
    v_mfma_f32_32x32x16_bf16 v[80:95], a[156:159], v[252:255], v[80:95]
    s_nop 10
    v_max_f32 v20, v20, v64
    v_max_f32 v20, v20, v65
    v_max_f32 v20, v20, v66
    v_max_f32 v20, v20, v67
    v_max_f32 v20, v20, v68
    v_max_f32 v20, v20, v69
    v_max_f32 v20, v20, v70
    v_max_f32 v20, v20, v71
    v_max_f32 v20, v20, v72
    v_max_f32 v20, v20, v73
    v_max_f32 v20, v20, v74
    v_max_f32 v20, v20, v75
    v_max_f32 v20, v20, v76
    v_max_f32 v20, v20, v77
    v_max_f32 v20, v20, v78
    v_max_f32 v20, v20, v79
    v_max_f32 v22, v22, v80
    v_max_f32 v22, v22, v81
    v_max_f32 v22, v22, v82
    v_max_f32 v22, v22, v83
    v_max_f32 v22, v22, v84
    v_max_f32 v22, v22, v85
    v_max_f32 v22, v22, v86
    v_max_f32 v22, v22, v87
    v_max_f32 v22, v22, v88
    v_max_f32 v22, v22, v89
    v_max_f32 v22, v22, v90
    v_max_f32 v22, v22, v91
    v_max_f32 v22, v22, v92
    v_max_f32 v22, v22, v93
    v_max_f32 v22, v22, v94
    v_max_f32 v22, v22, v95
    s_add_u32 s41, s41, 8192
    s_sub_u32 s31, s31, 1
    s_cmp_lg_u32 s31, 0
    s_cbranch_scc1 L_k2_max
    v_mov_b32 v21, v20
    v_mov_b32 v23, v22
    s_nop 0
    v_permlane32_swap_b32 v20, v21
    v_permlane32_swap_b32 v22, v23
    v_max_f32 v20, v20, v21
    v_max_f32 v22, v22, v23
    v_sub_f32 v32, 0, v20
    v_sub_f32 v48, 0, v22
    v_sub_f32 v33, 0, v20
    v_sub_f32 v49, 0, v22
    v_sub_f32 v34, 0, v20
    v_sub_f32 v50, 0, v22
    v_sub_f32 v35, 0, v20
    v_sub_f32 v51, 0, v22
    v_sub_f32 v36, 0, v20
    v_sub_f32 v52, 0, v22
    v_sub_f32 v37, 0, v20
    v_sub_f32 v53, 0, v22
    v_sub_f32 v38, 0, v20
    v_sub_f32 v54, 0, v22
    v_sub_f32 v39, 0, v20
    v_sub_f32 v55, 0, v22
    v_sub_f32 v40, 0, v20
    v_sub_f32 v56, 0, v22
    v_sub_f32 v41, 0, v20
    v_sub_f32 v57, 0, v22
    v_sub_f32 v42, 0, v20
    v_sub_f32 v58, 0, v22
    v_sub_f32 v43, 0, v20
    v_sub_f32 v59, 0, v22
    v_sub_f32 v44, 0, v20
    v_sub_f32 v60, 0, v22
    v_sub_f32 v45, 0, v20
    v_sub_f32 v61, 0, v22
    v_sub_f32 v46, 0, v20
    v_sub_f32 v62, 0, v22
    v_sub_f32 v47, 0, v20
    v_sub_f32 v63, 0, v22
    s_barrier
    s_lshl_b32 s41, s28, 11
    s_add_u32 s37, s42, 0
    s_add_u32 s38, s43, 0
    s_add_u32 s35, s41, 8192
    s_mov_b32 s36, s35
    s_mov_b32 m0, s37
    s_nop 0
    buffer_load_dwordx4 v2, s[8:11], s41 offen lds
    buffer_load_dwordx4 v2, s[8:11], s41 offen offset:1024 lds
    s_add_u32 m0, s37, 8448
    s_nop 0
    buffer_load_dwordx4 v3, s[8:11], s41 offen lds
    buffer_load_dwordx4 v3, s[8:11], s41 offen offset:1024 lds
    s_mov_b32 m0, s38
    s_nop 0
    buffer_load_dwordx4 v4, s[12:15], s36 offen lds
    buffer_load_dwordx4 v5, s[12:15], s36 offen offset:1024 lds
    s_add_u32 m0, s38, 8192
    s_nop 0
    buffer_load_dwordx4 v4, s[12:15], s35 offen lds
    buffer_load_dwordx4 v5, s[12:15], s35 offen offset:1024 lds
    s_add_u32 s41, s41, 16384
    s_add_u32 s37, s42, 33280
    s_add_u32 s38, s43, 33280
    s_add_u32 s35, s41, 8192
    s_mov_b32 s36, s41
    s_mov_b32 m0, s37
    s_nop 0
    buffer_load_dwordx4 v2, s[8:11], s41 offen lds
    buffer_load_dwordx4 v2, s[8:11], s41 offen offset:1024 lds
    s_add_u32 m0, s37, 8448
    s_nop 0
    buffer_load_dwordx4 v3, s[8:11], s41 offen lds
    buffer_load_dwordx4 v3, s[8:11], s41 offen offset:1024 lds
    s_mov_b32 m0, s38
    s_nop 0
    buffer_load_dwordx4 v4, s[12:15], s36 offen lds
    buffer_load_dwordx4 v5, s[12:15], s36 offen offset:1024 lds
    s_add_u32 m0, s38, 8192
    s_nop 0
    buffer_load_dwordx4 v4, s[12:15], s35 offen lds
    buffer_load_dwordx4 v5, s[12:15], s35 offen offset:1024 lds
    s_add_u32 s41, s41, 16384
    s_waitcnt vmcnt(0)
    s_barrier
    s_waitcnt vmcnt(0) lgkmcnt(0)
    s_nop 15
    s_nop 3
    s_branch L_k2_init
L_mg_fb:
    s_waitcnt vmcnt(0) lgkmcnt(0)
    s_nop 15
    s_nop 3
    s_load_dwordx2 s[32:33], s[0:1], 0
    s_load_dwordx2 s[36:37], s[0:1], 72
    s_load_dwordx2 s[38:39], s[0:1], 80
    s_waitcnt lgkmcnt(0)
    s_mov_b32 s8, s32
    s_mov_b32 s9, s33
    s_mov_b32 s10, 0x200000
    s_mov_b32 s11, 0x00020000
    s_mov_b32 s12, s38
    s_mov_b32 s13, s39
    s_mov_b32 s14, 0x300000
    s_mov_b32 s15, 0x00020000
    s_mov_b32 s20, s36
    s_mov_b32 s21, s37
    s_mov_b32 s22, 0x400
    s_mov_b32 s23, 0x00020000
    v_lshrrev_b32 v236, 2, v0
    v_and_b32 v237, 3, v0
    v_mul_u32_u24 v240, 49152, v236
    v_lshl_add_u32 v240, v237, 4, v240
    v_lshlrev_b32 v241, 4, v236
    v_lshlrev_b32 v243, 7, v236
    v_lshl_add_u32 v243, v237, 5, v243
    v_add_u32 v243, 147456, v243
    v_lshrrev_b32 v236, 3, v0
    v_and_b32 v237, 7, v0
    v_lshlrev_b32 v242, 9, v236
    v_lshl_add_u32 v242, v237, 4, v242
    v_lshrrev_b32 v236, 3, v1
    v_lshlrev_b32 v244, 10, v236
    v_and_b32 v237, 7, v1
    v_lshl_add_u32 v244, v237, 2, v244
    s_lshl_b32 s46, s28, 5
    s_add_u32 s46, s46, 147456
    v_add_u32 v244, s46, v244
    s_mov_b32 s31, 0
    s_barrier
L_mg_fbl:
    s_lshl_b32 s36, s30, 5
    s_add_u32 s36, s36, s31
    s_and_b32 s35, s31, 7
    s_lshl_b32 s35, s35, 1
    s_bfe_u32 s46, s31, 0x10003
    s_add_u32 s35, s35, s46
    s_lshr_b32 s46, s31, 4
    s_lshl_b32 s46, s46, 4
    s_add_u32 s35, s35, s46
    buffer_load_dwordx4 v[100:103], v241, s[20:23], 0 offen
    s_lshl_b32 s46, s36, 13
    s_lshl_b32 s47, s28, 11
    s_add_u32 s46, s46, s47
    v_lshlrev_b32 v236, 4, v1
    buffer_load_dwordx4 v[64:67], v236, s[8:11], s46 offen
    buffer_load_dwordx4 v[68:71], v236, s[8:11], s46 offen offset:1024
    s_lshl_b32 s46, s35, 6
    buffer_load_dwordx4 v[112:115], v240, s[12:15], s46 offen
    s_add_u32 s46, s46, 6144
    buffer_load_dwordx4 v[116:119], v240, s[12:15], s46 offen
    s_add_u32 s46, s46, 6144
    buffer_load_dwordx4 v[120:123], v240, s[12:15], s46 offen
    s_add_u32 s46, s46, 6144
    buffer_load_dwordx4 v[124:127], v240, s[12:15], s46 offen
    s_add_u32 s46, s46, 6144
    buffer_load_dwordx4 v[128:131], v240, s[12:15], s46 offen
    s_add_u32 s46, s46, 6144
    buffer_load_dwordx4 v[132:135], v240, s[12:15], s46 offen
    s_add_u32 s46, s46, 6144
    buffer_load_dwordx4 v[136:139], v240, s[12:15], s46 offen
    s_add_u32 s46, s46, 6144
    buffer_load_dwordx4 v[140:143], v240, s[12:15], s46 offen
    s_waitcnt vmcnt(10)
    v_lshlrev_b32 v104, 16, v100
    v_and_b32 v105, 0xffff0000, v100
    v_lshlrev_b32 v106, 16, v101
    v_and_b32 v107, 0xffff0000, v101
    v_lshlrev_b32 v108, 16, v102
    v_and_b32 v109, 0xffff0000, v102
    v_lshlrev_b32 v110, 16, v103
    v_and_b32 v111, 0xffff0000, v103
    v_mul_f32 v144, 0xbfb8aa3b, v104
    v_mul_f32 v145, 0xbfb8aa3b, v105
    v_mul_f32 v146, 0xbfb8aa3b, v106
    v_mul_f32 v147, 0xbfb8aa3b, v107
    v_mul_f32 v148, 0xbfb8aa3b, v108
    v_mul_f32 v149, 0xbfb8aa3b, v109
    v_mul_f32 v150, 0xbfb8aa3b, v110
    v_mul_f32 v151, 0xbfb8aa3b, v111
    v_exp_f32 v144, v144
    v_exp_f32 v145, v145
    v_exp_f32 v146, v146
    v_exp_f32 v147, v147
    v_exp_f32 v148, v148
    v_exp_f32 v149, v149
    v_exp_f32 v150, v150
    v_exp_f32 v151, v151
    v_add_f32 v144, 1.0, v144
    v_add_f32 v145, 1.0, v145
    v_add_f32 v146, 1.0, v146
    v_add_f32 v147, 1.0, v147
    v_add_f32 v148, 1.0, v148
    v_add_f32 v149, 1.0, v149
    v_add_f32 v150, 1.0, v150
    v_add_f32 v151, 1.0, v151
    v_rcp_f32 v144, v144
    v_rcp_f32 v145, v145
    v_rcp_f32 v146, v146
    v_rcp_f32 v147, v147
    v_rcp_f32 v148, v148
    v_rcp_f32 v149, v149
    v_rcp_f32 v150, v150
    v_rcp_f32 v151, v151
    v_mul_f32 v104, v104, v144
    v_mul_f32 v105, v105, v145
    v_mul_f32 v106, v106, v146
    v_mul_f32 v107, v107, v147
    v_mul_f32 v108, v108, v148
    v_mul_f32 v109, v109, v149
    v_mul_f32 v110, v110, v150
    v_mul_f32 v111, v111, v151
    v_cvt_pk_bf16_f32 v224, v104, v105
    v_cvt_pk_bf16_f32 v225, v106, v107
    v_cvt_pk_bf16_f32 v226, v108, v109
    v_cvt_pk_bf16_f32 v227, v110, v111
    s_waitcnt vmcnt(9)
    v_lshlrev_b32 v72, 16, v64
    v_and_b32 v73, 0xffff0000, v64
    v_lshlrev_b32 v74, 16, v65
    v_and_b32 v75, 0xffff0000, v65
    v_lshlrev_b32 v76, 16, v66
    v_and_b32 v77, 0xffff0000, v66
    v_lshlrev_b32 v78, 16, v67
    v_and_b32 v79, 0xffff0000, v67
    s_waitcnt vmcnt(8)
    v_lshlrev_b32 v80, 16, v68
    v_and_b32 v81, 0xffff0000, v68
    v_lshlrev_b32 v82, 16, v69
    v_and_b32 v83, 0xffff0000, v69
    v_lshlrev_b32 v84, 16, v70
    v_and_b32 v85, 0xffff0000, v70
    v_lshlrev_b32 v86, 16, v71
    v_and_b32 v87, 0xffff0000, v71
    v_add_f32 v88, v72, v73
    v_add_f32 v90, v74, v75
    v_add_f32 v89, v80, v81
    v_add_f32 v91, v82, v83
    v_add_f32 v88, v88, v76
    v_add_f32 v90, v90, v77
    v_add_f32 v89, v89, v84
    v_add_f32 v91, v91, v85
    v_add_f32 v88, v88, v78
    v_add_f32 v90, v90, v79
    v_add_f32 v89, v89, v86
    v_add_f32 v91, v91, v87
    v_add_f32 v88, v88, v90
    v_add_f32 v89, v89, v91
    s_nop 0
    v_add_f32_dpp v88, v88, v88 row_ror:8 row_mask:0xf bank_mask:0xf
    v_add_f32_dpp v89, v89, v89 row_ror:8 row_mask:0xf bank_mask:0xf
    s_nop 0
    v_add_f32_dpp v88, v88, v88 row_ror:4 row_mask:0xf bank_mask:0xf
    v_add_f32_dpp v89, v89, v89 row_ror:4 row_mask:0xf bank_mask:0xf
    s_nop 0
    v_add_f32_dpp v88, v88, v88 row_ror:2 row_mask:0xf bank_mask:0xf
    v_add_f32_dpp v89, v89, v89 row_ror:2 row_mask:0xf bank_mask:0xf
    s_nop 0
    v_add_f32_dpp v88, v88, v88 row_ror:1 row_mask:0xf bank_mask:0xf
    v_add_f32_dpp v89, v89, v89 row_ror:1 row_mask:0xf bank_mask:0xf
    v_mov_b32 v90, v88
    v_mov_b32 v91, v89
    s_nop 0
    v_permlane16_swap_b32 v88, v90
    v_permlane16_swap_b32 v89, v91
    v_add_f32 v88, v88, v90
    v_add_f32 v89, v89, v91
    v_mov_b32 v90, v88
    v_mov_b32 v91, v89
    s_nop 0
    v_permlane32_swap_b32 v88, v90
    v_permlane32_swap_b32 v89, v91
    v_add_f32 v88, v88, v90
    v_add_f32 v89, v89, v91
    v_mul_f32 v88, 0x3b000000, v88
    v_mul_f32 v89, 0x3b000000, v89
    v_sub_f32 v72, v72, v88
    v_sub_f32 v80, v80, v89
    v_sub_f32 v73, v73, v88
    v_sub_f32 v81, v81, v89
    v_sub_f32 v74, v74, v88
    v_sub_f32 v82, v82, v89
    v_sub_f32 v75, v75, v88
    v_sub_f32 v83, v83, v89
    v_sub_f32 v76, v76, v88
    v_sub_f32 v84, v84, v89
    v_sub_f32 v77, v77, v88
    v_sub_f32 v85, v85, v89
    v_sub_f32 v78, v78, v88
    v_sub_f32 v86, v86, v89
    v_sub_f32 v79, v79, v88
    v_sub_f32 v87, v87, v89
    v_mul_f32 v88, v72, v72
    v_mul_f32 v89, v80, v80
    v_mul_f32 v90, v73, v73
    v_mul_f32 v91, v81, v81
    v_fmac_f32 v88, v74, v74
    v_fmac_f32 v89, v82, v82
    v_fmac_f32 v90, v75, v75
    v_fmac_f32 v91, v83, v83
    v_fmac_f32 v88, v76, v76
    v_fmac_f32 v89, v84, v84
    v_fmac_f32 v90, v77, v77
    v_fmac_f32 v91, v85, v85
    v_fmac_f32 v88, v78, v78
    v_fmac_f32 v89, v86, v86
    v_fmac_f32 v90, v79, v79
    v_fmac_f32 v91, v87, v87
    v_add_f32 v88, v88, v90
    v_add_f32 v89, v89, v91
    s_nop 0
    v_add_f32_dpp v88, v88, v88 row_ror:8 row_mask:0xf bank_mask:0xf
    v_add_f32_dpp v89, v89, v89 row_ror:8 row_mask:0xf bank_mask:0xf
    s_nop 0
    v_add_f32_dpp v88, v88, v88 row_ror:4 row_mask:0xf bank_mask:0xf
    v_add_f32_dpp v89, v89, v89 row_ror:4 row_mask:0xf bank_mask:0xf
    s_nop 0
    v_add_f32_dpp v88, v88, v88 row_ror:2 row_mask:0xf bank_mask:0xf
    v_add_f32_dpp v89, v89, v89 row_ror:2 row_mask:0xf bank_mask:0xf
    s_nop 0
    v_add_f32_dpp v88, v88, v88 row_ror:1 row_mask:0xf bank_mask:0xf
    v_add_f32_dpp v89, v89, v89 row_ror:1 row_mask:0xf bank_mask:0xf
    v_mov_b32 v90, v88
    v_mov_b32 v91, v89
    s_nop 0
    v_permlane16_swap_b32 v88, v90
    v_permlane16_swap_b32 v89, v91
    v_add_f32 v88, v88, v90
    v_add_f32 v89, v89, v91
    v_mov_b32 v90, v88
    v_mov_b32 v91, v89
    s_nop 0
    v_permlane32_swap_b32 v88, v90
    v_permlane32_swap_b32 v89, v91
    v_add_f32 v88, v88, v90
    v_add_f32 v89, v89, v91
    v_mov_b32 v90, 0x3727c5ac
    v_mov_b32 v91, 0x3727c5ac
    v_fmac_f32 v90, 0x3b000000, v88
    v_fmac_f32 v91, 0x3b000000, v89
    v_rsq_f32 v90, v90
    v_rsq_f32 v91, v91
    v_mul_f32 v72, v72, v90
    v_mul_f32 v80, v80, v91
    v_mul_f32 v73, v73, v90
    v_mul_f32 v81, v81, v91
    v_mul_f32 v74, v74, v90
    v_mul_f32 v82, v82, v91
    v_mul_f32 v75, v75, v90
    v_mul_f32 v83, v83, v91
    v_mul_f32 v76, v76, v90
    v_mul_f32 v84, v84, v91
    v_mul_f32 v77, v77, v90
    v_mul_f32 v85, v85, v91
    v_mul_f32 v78, v78, v90
    v_mul_f32 v86, v86, v91
    v_mul_f32 v79, v79, v90
    v_mul_f32 v87, v87, v91
    v_cvt_pk_f16_f32 v92, v72, v73
    v_cvt_pk_f16_f32 v93, v74, v75
    v_cvt_pk_f16_f32 v94, v76, v77
    v_cvt_pk_f16_f32 v95, v78, v79
    v_cvt_pk_f16_f32 v96, v80, v81
    v_cvt_pk_f16_f32 v97, v82, v83
    v_cvt_pk_f16_f32 v98, v84, v85
    v_cvt_pk_f16_f32 v99, v86, v87
    s_lshl_b32 s46, s28, 5
    s_add_u32 s46, s46, 139264
    v_lshlrev_b32 v236, 7, v1
    v_add_u32 v236, s46, v236
    ds_write_b128 v236, v[92:95]
    ds_write_b128 v236, v[96:99] offset:16
    s_mov_b32 s44, 0x05040100
    s_mov_b32 s45, 0x07060302
    v_mov_b32 v228, 0
    v_mov_b32 v229, 0
    v_mov_b32 v230, 0
    v_mov_b32 v231, 0
    v_mov_b32 v232, 0
    v_mov_b32 v233, 0
    v_mov_b32 v234, 0
    v_mov_b32 v235, 0
    s_waitcnt vmcnt(6)
    v_perm_b32 v236, v116, v112, s44
    v_perm_b32 v237, v116, v112, s45
    v_dot2c_f32_bf16 v228, v236, v224
    v_dot2c_f32_bf16 v229, v237, v224
    v_perm_b32 v238, v117, v113, s44
    v_perm_b32 v239, v117, v113, s45
    v_dot2c_f32_bf16 v230, v238, v224
    v_dot2c_f32_bf16 v231, v239, v224
    v_perm_b32 v236, v118, v114, s44
    v_perm_b32 v237, v118, v114, s45
    v_dot2c_f32_bf16 v232, v236, v224
    v_dot2c_f32_bf16 v233, v237, v224
    v_perm_b32 v238, v119, v115, s44
    v_perm_b32 v239, v119, v115, s45
    v_dot2c_f32_bf16 v234, v238, v224
    v_dot2c_f32_bf16 v235, v239, v224
    s_waitcnt vmcnt(4)
    v_perm_b32 v236, v124, v120, s44
    v_perm_b32 v237, v124, v120, s45
    v_dot2c_f32_bf16 v228, v236, v225
    v_dot2c_f32_bf16 v229, v237, v225
    v_perm_b32 v238, v125, v121, s44
    v_perm_b32 v239, v125, v121, s45
    v_dot2c_f32_bf16 v230, v238, v225
    v_dot2c_f32_bf16 v231, v239, v225
    v_perm_b32 v236, v126, v122, s44
    v_perm_b32 v237, v126, v122, s45
    v_dot2c_f32_bf16 v232, v236, v225
    v_dot2c_f32_bf16 v233, v237, v225
    v_perm_b32 v238, v127, v123, s44
    v_perm_b32 v239, v127, v123, s45
    v_dot2c_f32_bf16 v234, v238, v225
    v_dot2c_f32_bf16 v235, v239, v225
    s_waitcnt vmcnt(2)
    v_perm_b32 v236, v132, v128, s44
    v_perm_b32 v237, v132, v128, s45
    v_dot2c_f32_bf16 v228, v236, v226
    v_dot2c_f32_bf16 v229, v237, v226
    v_perm_b32 v238, v133, v129, s44
    v_perm_b32 v239, v133, v129, s45
    v_dot2c_f32_bf16 v230, v238, v226
    v_dot2c_f32_bf16 v231, v239, v226
    v_perm_b32 v236, v134, v130, s44
    v_perm_b32 v237, v134, v130, s45
    v_dot2c_f32_bf16 v232, v236, v226
    v_dot2c_f32_bf16 v233, v237, v226
    v_perm_b32 v238, v135, v131, s44
    v_perm_b32 v239, v135, v131, s45
    v_dot2c_f32_bf16 v234, v238, v226
    v_dot2c_f32_bf16 v235, v239, v226
    s_waitcnt vmcnt(0)
    v_perm_b32 v236, v140, v136, s44
    v_perm_b32 v237, v140, v136, s45
    v_dot2c_f32_bf16 v228, v236, v227
    v_dot2c_f32_bf16 v229, v237, v227
    v_perm_b32 v238, v141, v137, s44
    v_perm_b32 v239, v141, v137, s45
    v_dot2c_f32_bf16 v230, v238, v227
    v_dot2c_f32_bf16 v231, v239, v227
    v_perm_b32 v236, v142, v138, s44
    v_perm_b32 v237, v142, v138, s45
    v_dot2c_f32_bf16 v232, v236, v227
    v_dot2c_f32_bf16 v233, v237, v227
    v_perm_b32 v238, v143, v139, s44
    v_perm_b32 v239, v143, v139, s45
    v_dot2c_f32_bf16 v234, v238, v227
    v_dot2c_f32_bf16 v235, v239, v227
    s_nop 3
    ds_write_b128 v243, v[228:231]
    ds_write_b128 v243, v[232:235] offset:16
    s_waitcnt lgkmcnt(0)
    s_barrier
    v_lshlrev_b32 v236, 4, v0
    v_add_u32 v236, 139264, v236
    ds_read_b128 v[92:95], v236
    ds_read_b128 v[96:99], v236 offset:4096
    ds_read_b32 v144, v244 offset:0
    ds_read_b32 v145, v244 offset:128
    ds_read_b32 v146, v244 offset:256
    ds_read_b32 v147, v244 offset:384
    ds_read_b32 v148, v244 offset:512
    ds_read_b32 v149, v244 offset:640
    ds_read_b32 v150, v244 offset:768
    ds_read_b32 v151, v244 offset:896
    s_lshr_b32 s46, s36, 2
    s_lshl_b32 s46, s46, 15
    s_and_b32 s47, s36, 3
    s_lshl_b32 s47, s47, 7
    s_add_u32 s46, s46, s47
    s_add_u32 s47, s46, 16384
    s_waitcnt lgkmcnt(9)
    buffer_store_dwordx4 v[92:95], v242, s[16:19], s46 offen sc1
    s_waitcnt lgkmcnt(8)
    buffer_store_dwordx4 v[96:99], v242, s[16:19], s47 offen sc1
    s_cmp_ge_u32 s35, 16
    s_cselect_b32 s37, 0x3f800000, 0
    s_mov_b32 s38, 0x3e0293ee
    s_waitcnt lgkmcnt(3)
    v_add_f32 v144, v144, v148
    s_waitcnt lgkmcnt(2)
    v_add_f32 v145, v145, v149
    s_waitcnt lgkmcnt(1)
    v_add_f32 v146, v146, v150
    s_waitcnt lgkmcnt(0)
    v_add_f32 v147, v147, v151
    v_add_f32 v144, v144, v146
    v_add_f32 v145, v145, v147
    v_add_f32 v144, v144, v145
    s_nop 1
    v_add_f32_dpp v144, v144, v144 row_ror:8 row_mask:0xf bank_mask:0xf
    v_mov_b32 v145, v144
    s_nop 1
    v_permlane16_swap_b32 v144, v145
    v_add_f32 v144, v144, v145
    v_mov_b32 v145, v144
    s_nop 1
    v_permlane32_swap_b32 v144, v145
    v_add_f32 v144, v144, v145
    v_cvt_pk_bf16_f32 v144, v144, v144
    v_lshlrev_b32 v144, 16, v144
    v_add_f32 v144, s37, v144
    v_cvt_pk_bf16_f32 v144, v144, v144
    v_lshlrev_b32 v144, 16, v144
    v_mul_f32 v144, s38, v144
    s_lshl_b32 s46, s35, 7
    s_lshl_b32 s47, s28, 5
    s_add_u32 s46, s46, s47
    v_lshlrev_b32 v145, 2, v1
    s_mov_b64 exec, 0xff
    buffer_store_dword v144, v145, s[24:27], s46 offen sc1
    s_mov_b64 exec, -1
    s_waitcnt vmcnt(0) lgkmcnt(0)
    s_barrier
    s_add_u32 s31, s31, 1
    s_cmp_lt_u32 s31, 32
    s_cbranch_scc1 L_mg_fbl
    v_mov_b32 v64, 0
    v_mov_b32 v65, 0
    v_mov_b32 v66, 0
    v_mov_b32 v67, 0
    v_mov_b32 v68, 0
    v_mov_b32 v69, 0
    v_mov_b32 v70, 0
    v_mov_b32 v71, 0
    v_mov_b32 v72, 0
    v_mov_b32 v73, 0
    v_mov_b32 v74, 0
    v_mov_b32 v75, 0
    v_mov_b32 v76, 0
    v_mov_b32 v77, 0
    v_mov_b32 v78, 0
    v_mov_b32 v79, 0
    v_mov_b32 v80, 0
    v_mov_b32 v81, 0
    v_mov_b32 v82, 0
    v_mov_b32 v83, 0
    v_mov_b32 v84, 0
    v_mov_b32 v85, 0
    v_mov_b32 v86, 0
    v_mov_b32 v87, 0
    v_mov_b32 v88, 0
    v_mov_b32 v89, 0
    v_mov_b32 v90, 0
    v_mov_b32 v91, 0
    v_mov_b32 v92, 0
    v_mov_b32 v93, 0
    v_mov_b32 v94, 0
    v_mov_b32 v95, 0
    v_mov_b32 v96, 0
    v_mov_b32 v97, 0
    v_mov_b32 v98, 0
    v_mov_b32 v99, 0
    v_mov_b32 v100, 0
    v_mov_b32 v101, 0
    v_mov_b32 v102, 0
    v_mov_b32 v103, 0
    v_mov_b32 v104, 0
    v_mov_b32 v105, 0
    v_mov_b32 v106, 0
    v_mov_b32 v107, 0
    v_mov_b32 v108, 0
    v_mov_b32 v109, 0
    v_mov_b32 v110, 0
    v_mov_b32 v111, 0
    v_mov_b32 v112, 0
    v_mov_b32 v113, 0
    v_mov_b32 v114, 0
    v_mov_b32 v115, 0
    v_mov_b32 v116, 0
    v_mov_b32 v117, 0
    v_mov_b32 v118, 0
    v_mov_b32 v119, 0
    v_mov_b32 v120, 0
    v_mov_b32 v121, 0
    v_mov_b32 v122, 0
    v_mov_b32 v123, 0
    v_mov_b32 v124, 0
    v_mov_b32 v125, 0
    v_mov_b32 v126, 0
    v_mov_b32 v127, 0
    v_mov_b32 v128, 0
    v_mov_b32 v129, 0
    v_mov_b32 v130, 0
    v_mov_b32 v131, 0
    v_mov_b32 v132, 0
    v_mov_b32 v133, 0
    v_mov_b32 v134, 0
    v_mov_b32 v135, 0
    v_mov_b32 v136, 0
    v_mov_b32 v137, 0
    v_mov_b32 v138, 0
    v_mov_b32 v139, 0
    v_mov_b32 v140, 0
    v_mov_b32 v141, 0
    v_mov_b32 v142, 0
    v_mov_b32 v143, 0
    v_mov_b32 v144, 0
    v_mov_b32 v145, 0
    v_mov_b32 v146, 0
    v_mov_b32 v147, 0
    v_mov_b32 v148, 0
    v_mov_b32 v149, 0
    v_mov_b32 v150, 0
    v_mov_b32 v151, 0
    v_mov_b32 v152, 0
    v_mov_b32 v153, 0
    v_mov_b32 v154, 0
    v_mov_b32 v155, 0
    v_mov_b32 v156, 0
    v_mov_b32 v157, 0
    v_mov_b32 v158, 0
    v_mov_b32 v159, 0
    v_mov_b32 v160, 0
    v_mov_b32 v161, 0
    v_mov_b32 v162, 0
    v_mov_b32 v163, 0
    v_mov_b32 v164, 0
    v_mov_b32 v165, 0
    v_mov_b32 v166, 0
    v_mov_b32 v167, 0
    v_mov_b32 v168, 0
    v_mov_b32 v169, 0
    v_mov_b32 v170, 0
    v_mov_b32 v171, 0
    v_mov_b32 v172, 0
    v_mov_b32 v173, 0
    v_mov_b32 v174, 0
    v_mov_b32 v175, 0
    v_mov_b32 v176, 0
    v_mov_b32 v177, 0
    v_mov_b32 v178, 0
    v_mov_b32 v179, 0
    v_mov_b32 v180, 0
    v_mov_b32 v181, 0
    v_mov_b32 v182, 0
    v_mov_b32 v183, 0
    v_mov_b32 v184, 0
    v_mov_b32 v185, 0
    v_mov_b32 v186, 0
    v_mov_b32 v187, 0
    v_mov_b32 v188, 0
    v_mov_b32 v189, 0
    v_mov_b32 v190, 0
    v_mov_b32 v191, 0
    v_mov_b32 v24, 0
    v_mov_b32 v25, 137504
    ds_write_b32 v25, v24
    s_waitcnt lgkmcnt(0)
    s_barrier
    s_waitcnt vmcnt(0) lgkmcnt(0)
    s_nop 15
    s_nop 3
    s_branch L_mg_go
L_k2_end:
    s_endpgm
.text
.globl ada_tail_kernel
.p2align 8
.type ada_tail_kernel,@function
ada_tail_kernel:
    s_cmp_ge_u32 s2, 256
    s_cbranch_scc1 L_k6_end
    s_load_dwordx2 s[50:51], s[0:1], 104
    s_load_dwordx2 s[52:53], s[0:1], 0
    s_load_dwordx2 s[54:55], s[0:1], 88
    v_lshrrev_b32 v2, 6, v0
    v_and_b32 v1, 63, v0
    v_readfirstlane_b32 s32, v2
    s_and_b32 s40, s2, 7
    s_lshr_b32 s41, s2, 3
    s_lshl_b32 s33, s40, 2
    s_lshr_b32 s34, s41, 3
    s_add_u32 s33, s33, s34
    s_and_b32 s34, s41, 7
    v_lshlrev_b32 v4, 4, v1
    s_lshl_b32 s35, s32, 14
    s_mul_i32 s36, s32, 131072
    s_mul_i32 s42, s34, 524288
    s_add_u32 s42, s42, 0x2000000
    s_mul_i32 s37, s32, 65536
    s_mul_i32 s40, s33, 524288
    s_add_u32 s40, s40, 0x400000
    s_add_u32 s41, s40, 262144
    s_bitcmp1_b32 s32, 0
    s_cselect_b32 s47, s41, s40
    s_cselect_b32 s41, s40, s41
    s_mov_b32 s40, s47
    s_lshr_b32 s47, s32, 1
    s_lshl_b32 s47, s47, 10
    v_add_u32 v2, s47, v4
    s_xor_b32 s47, s47, 1024
    v_add_u32 v3, s47, v4
    s_waitcnt lgkmcnt(0)
    s_add_u32 s4, s50, s42
    s_addc_u32 s5, s51, 0
    s_mov_b32 s6, 0x80000
    s_mov_b32 s7, 0x00020000
    s_add_u32 s8, s50, s40
    s_addc_u32 s9, s51, 0
    s_mov_b32 s10, 0x40000
    s_mov_b32 s11, 0x00020000
    s_add_u32 s12, s50, s41
    s_addc_u32 s13, s51, 0
    s_mov_b32 s14, 0x40000
    s_mov_b32 s15, 0x00020000
    buffer_load_dwordx4 a[0:3], v2, s[4:7], s36 offen
    buffer_load_dwordx4 v[128:131], v4, s[8:11], s37 offen
    buffer_load_dwordx4 a[4:7], v3, s[4:7], s36 offen
    buffer_load_dwordx4 v[132:135], v4, s[12:15], s37 offen
    s_add_u32 s36, s36, 2048
    s_add_u32 s37, s37, 1024
    buffer_load_dwordx4 a[8:11], v2, s[4:7], s36 offen
    buffer_load_dwordx4 v[136:139], v4, s[8:11], s37 offen
    buffer_load_dwordx4 a[12:15], v3, s[4:7], s36 offen
    buffer_load_dwordx4 v[140:143], v4, s[12:15], s37 offen
    s_add_u32 s36, s36, 2048
    s_add_u32 s37, s37, 1024
    buffer_load_dwordx4 a[16:19], v2, s[4:7], s36 offen
    buffer_load_dwordx4 v[144:147], v4, s[8:11], s37 offen
    buffer_load_dwordx4 a[20:23], v3, s[4:7], s36 offen
    buffer_load_dwordx4 v[148:151], v4, s[12:15], s37 offen
    s_add_u32 s36, s36, 2048
    s_add_u32 s37, s37, 1024
    buffer_load_dwordx4 a[24:27], v2, s[4:7], s36 offen
    buffer_load_dwordx4 v[152:155], v4, s[8:11], s37 offen
    buffer_load_dwordx4 a[28:31], v3, s[4:7], s36 offen
    buffer_load_dwordx4 v[156:159], v4, s[12:15], s37 offen
    s_add_u32 s36, s36, 2048
    s_add_u32 s37, s37, 1024
    buffer_load_dwordx4 a[32:35], v2, s[4:7], s36 offen
    buffer_load_dwordx4 v[160:163], v4, s[8:11], s37 offen
    buffer_load_dwordx4 a[36:39], v3, s[4:7], s36 offen
    buffer_load_dwordx4 v[164:167], v4, s[12:15], s37 offen
    s_add_u32 s36, s36, 2048
    s_add_u32 s37, s37, 1024
    buffer_load_dwordx4 a[40:43], v2, s[4:7], s36 offen
    buffer_load_dwordx4 v[168:171], v4, s[8:11], s37 offen
    buffer_load_dwordx4 a[44:47], v3, s[4:7], s36 offen
    buffer_load_dwordx4 v[172:175], v4, s[12:15], s37 offen
    s_add_u32 s36, s36, 2048
    s_add_u32 s37, s37, 1024
    buffer_load_dwordx4 a[48:51], v2, s[4:7], s36 offen
    buffer_load_dwordx4 v[176:179], v4, s[8:11], s37 offen
    buffer_load_dwordx4 a[52:55], v3, s[4:7], s36 offen
    buffer_load_dwordx4 v[180:183], v4, s[12:15], s37 offen
    s_add_u32 s36, s36, 2048
    s_add_u32 s37, s37, 1024
    s_add_u32 s56, s50, 0x20000
    s_addc_u32 s57, s51, 0
    s_load_dwordx2 s[64:65], s[56:57], 0
    s_lshr_b32 s42, s32, 1
    s_and_b32 s43, s32, 1
    s_lshl_b32 s44, s33, 1
    s_add_u32 s44, s44, s43
    s_lshl_b32 s45, s34, 1
    s_add_u32 s45, s45, s42
    v_and_b32 v52, 31, v1
    v_lshrrev_b32 v53, 5, v1
    v_lshlrev_b32 v7, 10, v52
    v_lshl_add_u32 v7, v53, 4, v7
    s_lshl_b32 s70, s44, 15
    s_lshl_b32 s47, s45, 6
    s_add_u32 s70, s70, s47
    s_lshl_b32 s39, s44, 15
    s_lshl_b32 s47, s45, 11
    s_add_u32 s39, s39, s47
    s_add_u32 s16, s50, 0x1400000
    s_addc_u32 s17, s51, 0
    s_mov_b32 s18, 0x200000
    s_mov_b32 s19, 0x00020000
    s_mov_b32 s24, s52
    s_mov_b32 s25, s53
    s_mov_b32 s26, 0x200000
    s_mov_b32 s27, 0x00020000
    s_add_u32 s20, s50, 0x1000
    s_addc_u32 s21, s51, 0
    s_mov_b32 s22, 0x800
    s_mov_b32 s23, 0x00020000
    buffer_load_dwordx4 v[8:11], v7, s[24:27], s70 offen offset:0
    buffer_load_dwordx4 v[12:15], v7, s[24:27], s70 offen offset:32
    s_add_u32 s28, s50, 0x1800000
    s_addc_u32 s29, s51, 0
    s_mov_b32 s30, 0x40000
    s_mov_b32 s31, 0x00020000
    v_lshlrev_b32 v5, 5, v53
    s_lshl_b32 s71, s45, 7
    buffer_load_dwordx4 v[16:19], v5, s[20:23], s71 offen offset:0
    buffer_load_dwordx4 v[20:23], v5, s[20:23], s71 offen offset:16
    buffer_load_dwordx4 v[24:27], v5, s[20:23], s71 offen offset:64
    buffer_load_dwordx4 v[28:31], v5, s[20:23], s71 offen offset:80
    s_add_u32 s60, s50, 0x28000
    s_addc_u32 s61, s51, 0
    s_mov_b32 s62, 0x10000
    s_mov_b32 s63, 0x00020000
    s_lshl_b32 s67, s2, 7
    s_mul_i32 s66, s34, 1016
    s_sub_u32 s66, s67, s66
    v_mov_b32 v64, 0
    v_mov_b32 v65, 0
    v_mov_b32 v66, 0
    v_mov_b32 v67, 0
    v_mov_b32 v68, 0
    v_mov_b32 v69, 0
    v_mov_b32 v70, 0
    v_mov_b32 v71, 0
    v_mov_b32 v72, 0
    v_mov_b32 v73, 0
    v_mov_b32 v74, 0
    v_mov_b32 v75, 0
    v_mov_b32 v76, 0
    v_mov_b32 v77, 0
    v_mov_b32 v78, 0
    v_mov_b32 v79, 0
    v_mov_b32 v80, 0
    v_mov_b32 v81, 0
    v_mov_b32 v82, 0
    v_mov_b32 v83, 0
    v_mov_b32 v84, 0
    v_mov_b32 v85, 0
    v_mov_b32 v86, 0
    v_mov_b32 v87, 0
    v_mov_b32 v88, 0
    v_mov_b32 v89, 0
    v_mov_b32 v90, 0
    v_mov_b32 v91, 0
    v_mov_b32 v92, 0
    v_mov_b32 v93, 0
    v_mov_b32 v94, 0
    v_mov_b32 v95, 0
    v_mov_b32 v96, 0
    v_mov_b32 v97, 0
    v_mov_b32 v98, 0
    v_mov_b32 v99, 0
    v_mov_b32 v100, 0
    v_mov_b32 v101, 0
    v_mov_b32 v102, 0
    v_mov_b32 v103, 0
    v_mov_b32 v104, 0
    v_mov_b32 v105, 0
    v_mov_b32 v106, 0
    v_mov_b32 v107, 0
    v_mov_b32 v108, 0
    v_mov_b32 v109, 0
    v_mov_b32 v110, 0
    v_mov_b32 v111, 0
    v_mov_b32 v112, 0
    v_mov_b32 v113, 0
    v_mov_b32 v114, 0
    v_mov_b32 v115, 0
    v_mov_b32 v116, 0
    v_mov_b32 v117, 0
    v_mov_b32 v118, 0
    v_mov_b32 v119, 0
    v_mov_b32 v120, 0
    v_mov_b32 v121, 0
    v_mov_b32 v122, 0
    v_mov_b32 v123, 0
    v_mov_b32 v124, 0
    v_mov_b32 v125, 0
    v_mov_b32 v126, 0
    v_mov_b32 v127, 0
    s_waitcnt vmcnt(30)
    v_mfma_f32_32x32x16_bf16 v[64:79], a[0:3], v[128:131], v[64:79]
    buffer_load_dwordx4 a[56:59], v2, s[4:7], s36 offen
    buffer_load_dwordx4 v[184:187], v4, s[8:11], s37 offen
    v_mfma_f32_32x32x16_bf16 v[80:95], a[0:3], v[132:135], v[80:95]
    buffer_load_dwordx4 a[60:63], v3, s[4:7], s36 offen
    buffer_load_dwordx4 v[188:191], v4, s[12:15], s37 offen
    s_add_u32 s36, s36, 2048
    s_add_u32 s37, s37, 1024
    v_mfma_f32_32x32x16_bf16 v[96:111], a[4:7], v[128:131], v[96:111]
    v_mfma_f32_32x32x16_bf16 v[112:127], a[4:7], v[132:135], v[112:127]
    s_waitcnt vmcnt(30)
    s_mov_b32 s38, 7
L_k6_loop:
    v_mfma_f32_32x32x16_bf16 v[64:79], a[8:11], v[136:139], v[64:79]
    buffer_load_dwordx4 a[0:3], v2, s[4:7], s36 offen
    buffer_load_dwordx4 v[128:131], v4, s[8:11], s37 offen
    v_mfma_f32_32x32x16_bf16 v[80:95], a[8:11], v[140:143], v[80:95]
    buffer_load_dwordx4 a[4:7], v3, s[4:7], s36 offen
    buffer_load_dwordx4 v[132:135], v4, s[12:15], s37 offen
    s_add_u32 s36, s36, 2048
    s_add_u32 s37, s37, 1024
    v_mfma_f32_32x32x16_bf16 v[96:111], a[12:15], v[136:139], v[96:111]
    v_mfma_f32_32x32x16_bf16 v[112:127], a[12:15], v[140:143], v[112:127]
    s_waitcnt vmcnt(24)
    v_mfma_f32_32x32x16_bf16 v[64:79], a[16:19], v[144:147], v[64:79]
    buffer_load_dwordx4 a[8:11], v2, s[4:7], s36 offen
    buffer_load_dwordx4 v[136:139], v4, s[8:11], s37 offen
    v_mfma_f32_32x32x16_bf16 v[80:95], a[16:19], v[148:151], v[80:95]
    buffer_load_dwordx4 a[12:15], v3, s[4:7], s36 offen
    buffer_load_dwordx4 v[140:143], v4, s[12:15], s37 offen
    s_add_u32 s36, s36, 2048
    s_add_u32 s37, s37, 1024
    v_mfma_f32_32x32x16_bf16 v[96:111], a[20:23], v[144:147], v[96:111]
    v_mfma_f32_32x32x16_bf16 v[112:127], a[20:23], v[148:151], v[112:127]
    s_waitcnt vmcnt(24)
    v_mfma_f32_32x32x16_bf16 v[64:79], a[24:27], v[152:155], v[64:79]
    buffer_load_dwordx4 a[16:19], v2, s[4:7], s36 offen
    buffer_load_dwordx4 v[144:147], v4, s[8:11], s37 offen
    v_mfma_f32_32x32x16_bf16 v[80:95], a[24:27], v[156:159], v[80:95]
    buffer_load_dwordx4 a[20:23], v3, s[4:7], s36 offen
    buffer_load_dwordx4 v[148:151], v4, s[12:15], s37 offen
    s_add_u32 s36, s36, 2048
    s_add_u32 s37, s37, 1024
    v_mfma_f32_32x32x16_bf16 v[96:111], a[28:31], v[152:155], v[96:111]
    v_mfma_f32_32x32x16_bf16 v[112:127], a[28:31], v[156:159], v[112:127]
    s_waitcnt vmcnt(24)
    v_mfma_f32_32x32x16_bf16 v[64:79], a[32:35], v[160:163], v[64:79]
    buffer_load_dwordx4 a[24:27], v2, s[4:7], s36 offen
    buffer_load_dwordx4 v[152:155], v4, s[8:11], s37 offen
    v_mfma_f32_32x32x16_bf16 v[80:95], a[32:35], v[164:167], v[80:95]
    buffer_load_dwordx4 a[28:31], v3, s[4:7], s36 offen
    buffer_load_dwordx4 v[156:159], v4, s[12:15], s37 offen
    s_add_u32 s36, s36, 2048
    s_add_u32 s37, s37, 1024
    v_mfma_f32_32x32x16_bf16 v[96:111], a[36:39], v[160:163], v[96:111]
    v_mfma_f32_32x32x16_bf16 v[112:127], a[36:39], v[164:167], v[112:127]
    s_waitcnt vmcnt(24)
    v_mfma_f32_32x32x16_bf16 v[64:79], a[40:43], v[168:171], v[64:79]
    buffer_load_dwordx4 a[32:35], v2, s[4:7], s36 offen
    buffer_load_dwordx4 v[160:163], v4, s[8:11], s37 offen
    v_mfma_f32_32x32x16_bf16 v[80:95], a[40:43], v[172:175], v[80:95]
    buffer_load_dwordx4 a[36:39], v3, s[4:7], s36 offen
    buffer_load_dwordx4 v[164:167], v4, s[12:15], s37 offen
    s_add_u32 s36, s36, 2048
    s_add_u32 s37, s37, 1024
    v_mfma_f32_32x32x16_bf16 v[96:111], a[44:47], v[168:171], v[96:111]
    v_mfma_f32_32x32x16_bf16 v[112:127], a[44:47], v[172:175], v[112:127]
    s_waitcnt vmcnt(24)
    v_mfma_f32_32x32x16_bf16 v[64:79], a[48:51], v[176:179], v[64:79]
    buffer_load_dwordx4 a[40:43], v2, s[4:7], s36 offen
    buffer_load_dwordx4 v[168:171], v4, s[8:11], s37 offen
    v_mfma_f32_32x32x16_bf16 v[80:95], a[48:51], v[180:183], v[80:95]
    buffer_load_dwordx4 a[44:47], v3, s[4:7], s36 offen
    buffer_load_dwordx4 v[172:175], v4, s[12:15], s37 offen
    s_add_u32 s36, s36, 2048
    s_add_u32 s37, s37, 1024
    v_mfma_f32_32x32x16_bf16 v[96:111], a[52:55], v[176:179], v[96:111]
    v_mfma_f32_32x32x16_bf16 v[112:127], a[52:55], v[180:183], v[112:127]
    s_waitcnt vmcnt(24)
    v_mfma_f32_32x32x16_bf16 v[64:79], a[56:59], v[184:187], v[64:79]
    buffer_load_dwordx4 a[48:51], v2, s[4:7], s36 offen
    buffer_load_dwordx4 v[176:179], v4, s[8:11], s37 offen
    v_mfma_f32_32x32x16_bf16 v[80:95], a[56:59], v[188:191], v[80:95]
    buffer_load_dwordx4 a[52:55], v3, s[4:7], s36 offen
    buffer_load_dwordx4 v[180:183], v4, s[12:15], s37 offen
    s_add_u32 s36, s36, 2048
    s_add_u32 s37, s37, 1024
    v_mfma_f32_32x32x16_bf16 v[96:111], a[60:63], v[184:187], v[96:111]
    v_mfma_f32_32x32x16_bf16 v[112:127], a[60:63], v[188:191], v[112:127]
    s_waitcnt vmcnt(24)
    v_mfma_f32_32x32x16_bf16 v[64:79], a[0:3], v[128:131], v[64:79]
    buffer_load_dwordx4 a[56:59], v2, s[4:7], s36 offen
    buffer_load_dwordx4 v[184:187], v4, s[8:11], s37 offen
    v_mfma_f32_32x32x16_bf16 v[80:95], a[0:3], v[132:135], v[80:95]
    buffer_load_dwordx4 a[60:63], v3, s[4:7], s36 offen
    buffer_load_dwordx4 v[188:191], v4, s[12:15], s37 offen
    s_add_u32 s36, s36, 2048
    s_add_u32 s37, s37, 1024
    v_mfma_f32_32x32x16_bf16 v[96:111], a[4:7], v[128:131], v[96:111]
    v_mfma_f32_32x32x16_bf16 v[112:127], a[4:7], v[132:135], v[112:127]
    s_waitcnt vmcnt(24)
    s_sub_u32 s38, s38, 1
    s_cmp_lg_u32 s38, 0
    s_cbranch_scc1 L_k6_loop
    v_mfma_f32_32x32x16_bf16 v[64:79], a[8:11], v[136:139], v[64:79]
    v_mfma_f32_32x32x16_bf16 v[80:95], a[8:11], v[140:143], v[80:95]
    v_mfma_f32_32x32x16_bf16 v[96:111], a[12:15], v[136:139], v[96:111]
    v_mfma_f32_32x32x16_bf16 v[112:127], a[12:15], v[140:143], v[112:127]
    s_waitcnt vmcnt(20)
    v_mfma_f32_32x32x16_bf16 v[64:79], a[16:19], v[144:147], v[64:79]
    v_mfma_f32_32x32x16_bf16 v[80:95], a[16:19], v[148:151], v[80:95]
    v_mfma_f32_32x32x16_bf16 v[96:111], a[20:23], v[144:147], v[96:111]
    v_mfma_f32_32x32x16_bf16 v[112:127], a[20:23], v[148:151], v[112:127]
    s_waitcnt vmcnt(16)
    v_mfma_f32_32x32x16_bf16 v[64:79], a[24:27], v[152:155], v[64:79]
    v_mfma_f32_32x32x16_bf16 v[80:95], a[24:27], v[156:159], v[80:95]
    v_mfma_f32_32x32x16_bf16 v[96:111], a[28:31], v[152:155], v[96:111]
    v_mfma_f32_32x32x16_bf16 v[112:127], a[28:31], v[156:159], v[112:127]
    s_waitcnt vmcnt(12)
    v_mfma_f32_32x32x16_bf16 v[64:79], a[32:35], v[160:163], v[64:79]
    v_mfma_f32_32x32x16_bf16 v[80:95], a[32:35], v[164:167], v[80:95]
    v_mfma_f32_32x32x16_bf16 v[96:111], a[36:39], v[160:163], v[96:111]
    v_mfma_f32_32x32x16_bf16 v[112:127], a[36:39], v[164:167], v[112:127]
    s_waitcnt vmcnt(8)
    v_mfma_f32_32x32x16_bf16 v[64:79], a[40:43], v[168:171], v[64:79]
    v_mfma_f32_32x32x16_bf16 v[80:95], a[40:43], v[172:175], v[80:95]
    v_mfma_f32_32x32x16_bf16 v[96:111], a[44:47], v[168:171], v[96:111]
    v_mfma_f32_32x32x16_bf16 v[112:127], a[44:47], v[172:175], v[112:127]
    s_waitcnt vmcnt(4)
    v_mfma_f32_32x32x16_bf16 v[64:79], a[48:51], v[176:179], v[64:79]
    v_mfma_f32_32x32x16_bf16 v[80:95], a[48:51], v[180:183], v[80:95]
    v_mfma_f32_32x32x16_bf16 v[96:111], a[52:55], v[176:179], v[96:111]
    v_mfma_f32_32x32x16_bf16 v[112:127], a[52:55], v[180:183], v[112:127]
    s_waitcnt vmcnt(0)
    v_mfma_f32_32x32x16_bf16 v[64:79], a[56:59], v[184:187], v[64:79]
    v_mfma_f32_32x32x16_bf16 v[80:95], a[56:59], v[188:191], v[80:95]
    v_mfma_f32_32x32x16_bf16 v[96:111], a[60:63], v[184:187], v[96:111]
    v_mfma_f32_32x32x16_bf16 v[112:127], a[60:63], v[188:191], v[112:127]
    s_lshl_b32 s37, s34, 2
    s_add_u32 s37, s37, s32
    s_add_u32 s20, s50, 0x1800
    s_addc_u32 s21, s51, 0
    s_mov_b32 s22, 0x1000
    s_mov_b32 s23, 0x00020000
    s_add_u32 s4, s50, 0x2558000
    s_addc_u32 s5, s51, 0
    s_mov_b32 s6, 0x2b0000
    s_mov_b32 s7, 0x00020000
    s_lshl_b32 s46, s32, 10
    s_add_u32 m0, s46, 65536
    s_nop 0
    buffer_load_dwordx4 v4, s[20:23], s46 offen lds
    v_add_u32 v2, 32768, v4
    v_add_u32 v3, 65536, v4
    s_mul_i32 s36, s37, 98304
    s_add_u32 s72, s36, 0
    buffer_load_dwordx4 a[0:3], v4, s[4:7], s72 offen offset:0
    v_add_u32 v48, s35, v4
    ds_write_b128 v48, v[80:83] offset:4096
    ds_write_b128 v48, v[84:87] offset:5120
    ds_write_b128 v48, v[88:91] offset:6144
    buffer_load_dwordx4 a[4:7], v4, s[4:7], s72 offen offset:1024
    ds_write_b128 v48, v[92:95] offset:7168
    ds_write_b128 v48, v[96:99] offset:8192
    ds_write_b128 v48, v[100:103] offset:9216
    ds_write_b128 v48, v[104:107] offset:10240
    ds_write_b128 v48, v[108:111] offset:11264
    buffer_load_dwordx4 a[8:11], v4, s[4:7], s72 offen offset:2048
    ds_write_b128 v48, v[112:115] offset:12288
    ds_write_b128 v48, v[116:119] offset:13312
    ds_write_b128 v48, v[120:123] offset:14336
    ds_write_b128 v48, v[124:127] offset:15360
    buffer_load_dwordx4 a[12:15], v4, s[4:7], s72 offen offset:3072
    s_xor_b32 s47, s32, 1
    s_lshl_b32 s47, s47, 14
    v_add_u32 v49, s47, v4
    s_xor_b32 s47, s32, 2
    s_lshl_b32 s47, s47, 14
    s_add_u32 s72, s36, 4096
    buffer_load_dwordx4 a[16:19], v4, s[4:7], s72 offen offset:0
    v_add_u32 v50, s47, v4
    s_xor_b32 s47, s32, 3
    s_lshl_b32 s47, s47, 14
    v_add_u32 v51, s47, v4
    buffer_load_dwordx4 a[20:23], v4, s[4:7], s72 offen offset:1024
    s_waitcnt lgkmcnt(0)
    s_barrier
    ds_read_b128 v[80:83], v49 offset:4096
    ds_read_b128 v[84:87], v49 offset:5120
    ds_read_b128 v[88:91], v49 offset:6144
    buffer_load_dwordx4 a[24:27], v4, s[4:7], s72 offen offset:2048
    ds_read_b128 v[92:95], v49 offset:7168
    ds_read_b128 v[96:99], v50 offset:8192
    ds_read_b128 v[100:103], v50 offset:9216
    ds_read_b128 v[104:107], v50 offset:10240
    buffer_load_dwordx4 a[28:31], v4, s[4:7], s72 offen offset:3072
    ds_read_b128 v[108:111], v50 offset:11264
    ds_read_b128 v[112:115], v51 offset:12288
    ds_read_b128 v[116:119], v51 offset:13312
    ds_read_b128 v[120:123], v51 offset:14336
    ds_read_b128 v[124:127], v51 offset:15360
    s_add_u32 s72, s36, 8192
    buffer_load_dwordx4 a[32:35], v4, s[4:7], s72 offen offset:0
    s_waitcnt lgkmcnt(11)
    v_pk_add_f32 v[64:65], v[64:65], v[80:81]
    s_waitcnt lgkmcnt(3)
    v_pk_add_f32 v[96:97], v[96:97], v[112:113]
    v_pk_add_f32 v[66:67], v[66:67], v[82:83]
    v_pk_add_f32 v[98:99], v[98:99], v[114:115]
    v_pk_add_f32 v[68:69], v[68:69], v[84:85]
    buffer_load_dwordx4 a[36:39], v4, s[4:7], s72 offen offset:1024
    s_waitcnt lgkmcnt(2)
    v_pk_add_f32 v[100:101], v[100:101], v[116:117]
    v_pk_add_f32 v[70:71], v[70:71], v[86:87]
    v_pk_add_f32 v[102:103], v[102:103], v[118:119]
    v_pk_add_f32 v[72:73], v[72:73], v[88:89]
    buffer_load_dwordx4 a[40:43], v4, s[4:7], s72 offen offset:2048
    s_waitcnt lgkmcnt(1)
    v_pk_add_f32 v[104:105], v[104:105], v[120:121]
    v_pk_add_f32 v[74:75], v[74:75], v[90:91]
    v_pk_add_f32 v[106:107], v[106:107], v[122:123]
    v_pk_add_f32 v[76:77], v[76:77], v[92:93]
    s_waitcnt lgkmcnt(0)
    v_pk_add_f32 v[108:109], v[108:109], v[124:125]
    buffer_load_dwordx4 a[44:47], v4, s[4:7], s72 offen offset:3072
    v_pk_add_f32 v[78:79], v[78:79], v[94:95]
    v_pk_add_f32 v[110:111], v[110:111], v[126:127]
    v_pk_add_f32 v[64:65], v[64:65], v[96:97]
    v_pk_add_f32 v[66:67], v[66:67], v[98:99]
    s_add_u32 s72, s36, 12288
    buffer_load_dwordx4 a[48:51], v4, s[4:7], s72 offen offset:0
    v_pk_add_f32 v[68:69], v[68:69], v[100:101]
    v_pk_add_f32 v[70:71], v[70:71], v[102:103]
    v_pk_add_f32 v[72:73], v[72:73], v[104:105]
    v_pk_add_f32 v[74:75], v[74:75], v[106:107]
    v_pk_add_f32 v[76:77], v[76:77], v[108:109]
    buffer_load_dwordx4 a[52:55], v4, s[4:7], s72 offen offset:1024
    v_pk_add_f32 v[78:79], v[78:79], v[110:111]
    v_lshlrev_b32 v80, 16, v8
    v_and_b32 v81, 0xffff0000, v8
    v_lshlrev_b32 v82, 16, v9
    buffer_load_dwordx4 a[56:59], v4, s[4:7], s72 offen offset:2048
    v_and_b32 v83, 0xffff0000, v9
    v_lshlrev_b32 v84, 16, v10
    v_and_b32 v85, 0xffff0000, v10
    v_lshlrev_b32 v86, 16, v11
    v_and_b32 v87, 0xffff0000, v11
    buffer_load_dwordx4 a[60:63], v4, s[4:7], s72 offen offset:3072
    v_lshlrev_b32 v88, 16, v12
    v_and_b32 v89, 0xffff0000, v12
    v_lshlrev_b32 v90, 16, v13
    v_and_b32 v91, 0xffff0000, v13
    s_add_u32 s72, s36, 16384
    buffer_load_dwordx4 a[64:67], v4, s[4:7], s72 offen offset:0
    v_lshlrev_b32 v92, 16, v14
    v_and_b32 v93, 0xffff0000, v14
    v_lshlrev_b32 v94, 16, v15
    v_and_b32 v95, 0xffff0000, v15
    v_pk_fma_f32 v[64:65], v[64:65], v[16:17], v[80:81]
    buffer_load_dwordx4 a[68:71], v4, s[4:7], s72 offen offset:1024
    v_pk_fma_f32 v[66:67], v[66:67], v[18:19], v[82:83]
    v_pk_fma_f32 v[68:69], v[68:69], v[20:21], v[84:85]
    v_pk_fma_f32 v[70:71], v[70:71], v[22:23], v[86:87]
    v_pk_fma_f32 v[72:73], v[72:73], v[24:25], v[88:89]
    v_pk_fma_f32 v[74:75], v[74:75], v[26:27], v[90:91]
    v_pk_fma_f32 v[76:77], v[76:77], v[28:29], v[92:93]
    v_pk_fma_f32 v[78:79], v[78:79], v[30:31], v[94:95]
    v_cvt_pk_bf16_f32 v96, v64, v65
    v_cvt_pk_bf16_f32 v97, v66, v67
    v_cvt_pk_bf16_f32 v98, v68, v69
    v_cvt_pk_bf16_f32 v99, v70, v71
    v_cvt_pk_bf16_f32 v100, v72, v73
    v_cvt_pk_bf16_f32 v101, v74, v75
    v_cvt_pk_bf16_f32 v102, v76, v77
    v_cvt_pk_bf16_f32 v103, v78, v79
    buffer_store_dwordx4 v[96:99], v4, s[16:19], s39 offen offset:0 sc1
    buffer_store_dwordx4 v[100:103], v4, s[16:19], s39 offen offset:1024 sc1
    v_lshlrev_b32 v64, 16, v96
    v_and_b32 v65, 0xffff0000, v96
    v_lshlrev_b32 v66, 16, v97
    v_and_b32 v67, 0xffff0000, v97
    v_lshlrev_b32 v68, 16, v98
    v_and_b32 v69, 0xffff0000, v98
    v_lshlrev_b32 v70, 16, v99
    v_and_b32 v71, 0xffff0000, v99
    v_lshlrev_b32 v72, 16, v100
    v_and_b32 v73, 0xffff0000, v100
    v_lshlrev_b32 v74, 16, v101
    v_and_b32 v75, 0xffff0000, v101
    v_lshlrev_b32 v76, 16, v102
    v_and_b32 v77, 0xffff0000, v102
    v_lshlrev_b32 v78, 16, v103
    v_and_b32 v79, 0xffff0000, v103
    v_add_f32 v112, v64, v72
    v_add_f32 v113, v65, v73
    v_add_f32 v114, v66, v74
    v_add_f32 v115, v67, v75
    v_add_f32 v116, v68, v76
    v_add_f32 v117, v69, v77
    v_add_f32 v118, v70, v78
    v_add_f32 v119, v71, v79
    v_add_f32 v112, v112, v116
    v_add_f32 v113, v113, v117
    v_add_f32 v114, v114, v118
    v_add_f32 v115, v115, v119
    v_add_f32 v112, v112, v114
    v_add_f32 v113, v113, v115
    v_add_f32 v112, v112, v113
    v_mov_b32 v113, v112
    s_nop 1
    v_permlane32_swap_b32 v112, v113
    v_add_f32 v112, v112, v113
    v_mul_f32 v48, 0x3d000000, v112
    v_sub_f32 v64, v64, v48
    v_sub_f32 v65, v65, v48
    v_sub_f32 v66, v66, v48
    v_sub_f32 v67, v67, v48
    v_sub_f32 v68, v68, v48
    v_sub_f32 v69, v69, v48
    v_sub_f32 v70, v70, v48
    v_sub_f32 v71, v71, v48
    v_sub_f32 v72, v72, v48
    v_sub_f32 v73, v73, v48
    v_sub_f32 v74, v74, v48
    v_sub_f32 v75, v75, v48
    v_sub_f32 v76, v76, v48
    v_sub_f32 v77, v77, v48
    v_sub_f32 v78, v78, v48
    v_sub_f32 v79, v79, v48
    v_mul_f32 v112, v64, v64
    v_mul_f32 v113, v65, v65
    v_mul_f32 v114, v66, v66
    v_mul_f32 v115, v67, v67
    v_mul_f32 v116, v68, v68
    v_mul_f32 v117, v69, v69
    v_mul_f32 v118, v70, v70
    v_mul_f32 v119, v71, v71
    v_fmac_f32 v112, v72, v72
    v_fmac_f32 v113, v73, v73
    v_fmac_f32 v114, v74, v74
    v_fmac_f32 v115, v75, v75
    v_fmac_f32 v116, v76, v76
    v_fmac_f32 v117, v77, v77
    v_fmac_f32 v118, v78, v78
    v_fmac_f32 v119, v79, v79
    v_add_f32 v112, v112, v116
    v_add_f32 v113, v113, v117
    v_add_f32 v114, v114, v118
    v_add_f32 v115, v115, v119
    v_add_f32 v112, v112, v114
    v_add_f32 v113, v113, v115
    v_add_f32 v112, v112, v113
    v_mov_b32 v113, v112
    s_nop 1
    v_permlane32_swap_b32 v112, v113
    v_add_f32 v49, v112, v113
    v_and_b32 v50, 31, v1
    s_lshl_b32 s47, s44, 12
    v_lshlrev_b32 v50, 4, v50
    s_bfe_u32 s41, s45, 0x20001
    s_lshl_b32 s41, s41, 10
    s_add_u32 s47, s47, s41
    s_lshr_b32 s41, s45, 3
    s_lshl_b32 s41, s41, 9
    s_add_u32 s47, s47, s41
    s_and_b32 s41, s45, 1
    s_lshl_b32 s41, s41, 3
    s_add_u32 s47, s47, s41
    s_mov_b32 exec_hi, 0
    buffer_store_dwordx2 v[48:49], v50, s[28:31], s47 offen sc1
    s_mov_b64 exec, -1
    buffer_load_dwordx4 a[72:75], v4, s[4:7], s72 offen offset:2048
    buffer_load_dwordx4 a[76:79], v4, s[4:7], s72 offen offset:3072
    s_add_u32 s72, s36, 20480
    buffer_load_dwordx4 a[80:83], v4, s[4:7], s72 offen offset:0
    buffer_load_dwordx4 a[84:87], v4, s[4:7], s72 offen offset:1024
    buffer_load_dwordx4 a[88:91], v4, s[4:7], s72 offen offset:2048
    buffer_load_dwordx4 a[92:95], v4, s[4:7], s72 offen offset:3072
    s_add_u32 s72, s36, 24576
    buffer_load_dwordx4 a[96:99], v4, s[4:7], s72 offen offset:0
    buffer_load_dwordx4 a[100:103], v4, s[4:7], s72 offen offset:1024
    buffer_load_dwordx4 a[104:107], v4, s[4:7], s72 offen offset:2048
    buffer_load_dwordx4 a[108:111], v4, s[4:7], s72 offen offset:3072
    s_add_u32 s72, s36, 28672
    buffer_load_dwordx4 a[112:115], v4, s[4:7], s72 offen offset:0
    buffer_load_dwordx4 a[116:119], v4, s[4:7], s72 offen offset:1024
    s_waitcnt vmcnt(12)
    s_barrier
    s_cmp_lg_u32 s32, 0
    s_cbranch_scc1 L_ts0_pub
    v_lshlrev_b32 v251, 10, v1
    v_mov_b32 v252, s64
    v_mov_b32 v253, s65
    s_add_u32 s68, s66, 0
    s_mov_b64 exec, 0xff
    buffer_store_dwordx2 v[252:253], v251, s[60:63], s68 offen sc1
    s_mov_b64 exec, -1
L_ts0_pub:
    buffer_load_dwordx4 a[120:123], v4, s[4:7], s72 offen offset:2048
    buffer_load_dwordx4 a[124:127], v4, s[4:7], s72 offen offset:3072
    s_add_u32 s72, s36, 0
    buffer_load_dwordx4 a[128:131], v2, s[4:7], s72 offen offset:0
    buffer_load_dwordx4 a[132:135], v2, s[4:7], s72 offen offset:1024
    buffer_load_dwordx4 a[136:139], v2, s[4:7], s72 offen offset:2048
    buffer_load_dwordx4 a[140:143], v2, s[4:7], s72 offen offset:3072
    s_add_u32 s72, s36, 4096
    buffer_load_dwordx4 a[144:147], v2, s[4:7], s72 offen offset:0
    buffer_load_dwordx4 a[148:151], v2, s[4:7], s72 offen offset:1024
    buffer_load_dwordx4 a[152:155], v2, s[4:7], s72 offen offset:2048
    buffer_load_dwordx4 a[156:159], v2, s[4:7], s72 offen offset:3072
    s_add_u32 s72, s36, 8192
    buffer_load_dwordx4 a[160:163], v2, s[4:7], s72 offen offset:0
    buffer_load_dwordx4 a[164:167], v2, s[4:7], s72 offen offset:1024
    buffer_load_dwordx4 a[168:171], v2, s[4:7], s72 offen offset:2048
    buffer_load_dwordx4 a[172:175], v2, s[4:7], s72 offen offset:3072
    s_add_u32 s72, s36, 12288
    buffer_load_dwordx4 a[176:179], v2, s[4:7], s72 offen offset:0
    buffer_load_dwordx4 a[180:183], v2, s[4:7], s72 offen offset:1024
    buffer_load_dwordx4 a[184:187], v2, s[4:7], s72 offen offset:2048
    buffer_load_dwordx4 a[188:191], v2, s[4:7], s72 offen offset:3072
    v_lshrrev_b32 v12, 5, v1
    v_and_b32 v13, 31, v1
    s_lshl_b32 s40, s33, 16
    s_lshl_b32 s41, s32, 13
    s_add_u32 s40, s40, s41
    s_add_u32 s41, s40, 4096
    s_add_u32 s42, s40, 32768
    s_add_u32 s43, s42, 4096
    v_lshlrev_b32 v14, 7, v13
    v_lshl_add_u32 v14, v12, 6, v14
    s_lshl_b32 s44, s33, 13
    s_add_u32 s45, s44, 4096
    s_lshl_b32 s46, s32, 9
    v_lshlrev_b32 v15, 5, v12
    v_add_u32 v15, s46, v15
    v_add_u32 v15, 65536, v15
    s_lshl_b32 s46, s32, 13
    v_add_u32 v16, s46, v4
    v_add_u32 v17, 32768, v4
    s_cmp_lg_u32 s32, 0
    s_cbranch_scc1 L_ts0_seen
    v_lshlrev_b32 v251, 3, v1
    s_add_u32 s68, s67, 0
    s_mov_b32 s69, 65536
    s_mov_b64 exec, 0xff
L_ts0_poll:
    buffer_load_dwordx2 v[254:255], v251, s[60:63], s68 offen sc1
    s_waitcnt vmcnt(0)
    v_cmp_eq_u64 vcc, s[64:65], v[254:255]
    s_nop 4
    s_cmp_eq_u32 vcc_lo, 0xff
    s_cbranch_scc1 L_ts0_ok
    s_sub_u32 s69, s69, 1
    s_cmp_lg_u32 s69, 0
    s_cbranch_scc1 L_ts0_poll
L_ts0_ok:
    s_mov_b64 exec, -1
L_ts0_seen:
    s_barrier
    buffer_load_dwordx4 v[128:131], v4, s[28:31], s44 offen offset:0 sc1
    buffer_load_dwordx4 v[132:135], v4, s[28:31], s44 offen offset:1024 sc1
    buffer_load_dwordx4 v[136:139], v4, s[28:31], s44 offen offset:2048 sc1
    buffer_load_dwordx4 v[140:143], v4, s[28:31], s44 offen offset:3072 sc1
    buffer_load_dwordx4 v[144:147], v4, s[28:31], s45 offen offset:0 sc1
    buffer_load_dwordx4 v[148:151], v4, s[28:31], s45 offen offset:1024 sc1
    buffer_load_dwordx4 v[152:155], v4, s[28:31], s45 offen offset:2048 sc1
    buffer_load_dwordx4 v[156:159], v4, s[28:31], s45 offen offset:3072 sc1
    buffer_load_dwordx4 v[64:67], v4, s[16:19], s40 offen offset:0 sc1
    buffer_load_dwordx4 v[68:71], v4, s[16:19], s42 offen offset:0 sc1
    buffer_load_dwordx4 v[72:75], v4, s[16:19], s40 offen offset:1024 sc1
    buffer_load_dwordx4 v[76:79], v4, s[16:19], s42 offen offset:1024 sc1
    buffer_load_dwordx4 v[80:83], v4, s[16:19], s40 offen offset:2048 sc1
    buffer_load_dwordx4 v[84:87], v4, s[16:19], s42 offen offset:2048 sc1
    buffer_load_dwordx4 v[88:91], v4, s[16:19], s40 offen offset:3072 sc1
    buffer_load_dwordx4 v[92:95], v4, s[16:19], s42 offen offset:3072 sc1
    buffer_load_dwordx4 v[96:99], v4, s[16:19], s41 offen offset:0 sc1
    buffer_load_dwordx4 v[100:103], v4, s[16:19], s43 offen offset:0 sc1
    buffer_load_dwordx4 v[104:107], v4, s[16:19], s41 offen offset:1024 sc1
    buffer_load_dwordx4 v[108:111], v4, s[16:19], s43 offen offset:1024 sc1
    buffer_load_dwordx4 v[112:115], v4, s[16:19], s41 offen offset:2048 sc1
    buffer_load_dwordx4 v[116:119], v4, s[16:19], s43 offen offset:2048 sc1
    buffer_load_dwordx4 v[120:123], v4, s[16:19], s41 offen offset:3072 sc1
    buffer_load_dwordx4 v[124:127], v4, s[16:19], s43 offen offset:3072 sc1
    ds_read_b128 v[160:163], v15 offset:2048
    ds_read_b128 v[164:167], v15 offset:2064
    ds_read_b128 v[168:171], v15 offset:0
    ds_read_b128 v[172:175], v15 offset:16
    s_waitcnt vmcnt(23)
    v_add_f32 v28, v128, v130
    s_waitcnt vmcnt(22)
    v_add_f32 v29, v132, v134
    s_waitcnt vmcnt(21)
    v_add_f32 v30, v136, v138
    s_waitcnt vmcnt(20)
    v_add_f32 v31, v140, v142
    v_add_f32 v28, v28, v29
    v_add_f32 v30, v30, v31
    v_add_f32 v28, v28, v30
    v_mov_b32 v29, v28
    s_nop 1
    v_permlane32_swap_b32 v28, v29
    v_add_f32 v28, v28, v29
    v_mul_f32 v28, 0x3d800000, v28
    v_sub_f32 v128, v128, v28
    v_sub_f32 v130, v130, v28
    v_sub_f32 v132, v132, v28
    v_sub_f32 v134, v134, v28
    v_sub_f32 v136, v136, v28
    v_sub_f32 v138, v138, v28
    v_sub_f32 v140, v140, v28
    v_sub_f32 v142, v142, v28
    v_mul_f32 v29, v128, v128
    v_fmac_f32 v29, v130, v130
    v_fmac_f32 v29, v132, v132
    v_fmac_f32 v29, v134, v134
    v_fmac_f32 v29, v136, v136
    v_fmac_f32 v29, v138, v138
    v_fmac_f32 v29, v140, v140
    v_fmac_f32 v29, v142, v142
    v_add_f32 v30, v129, v131
    v_add_f32 v30, v30, v133
    v_add_f32 v30, v30, v135
    v_add_f32 v30, v30, v137
    v_add_f32 v30, v30, v139
    v_add_f32 v30, v30, v141
    v_add_f32 v30, v30, v143
    v_fmac_f32 v30, 0x42000000, v29
    v_mov_b32 v29, v30
    s_nop 1
    v_permlane32_swap_b32 v30, v29
    v_add_f32 v30, v30, v29
    v_mov_b32 v29, 0x3727c5ac
    v_fmac_f32 v29, 0x3b000000, v30
    v_rsq_f32 v22, v29
    s_nop 0
    v_mul_f32 v20, v28, v22
    v_sub_f32 v20, 0, v20
    s_waitcnt vmcnt(19)
    v_add_f32 v28, v144, v146
    s_waitcnt vmcnt(18)
    v_add_f32 v29, v148, v150
    s_waitcnt vmcnt(17)
    v_add_f32 v30, v152, v154
    s_waitcnt vmcnt(16)
    v_add_f32 v31, v156, v158
    v_add_f32 v28, v28, v29
    v_add_f32 v30, v30, v31
    v_add_f32 v28, v28, v30
    v_mov_b32 v29, v28
    s_nop 1
    v_permlane32_swap_b32 v28, v29
    v_add_f32 v28, v28, v29
    v_mul_f32 v28, 0x3d800000, v28
    v_sub_f32 v144, v144, v28
    v_sub_f32 v146, v146, v28
    v_sub_f32 v148, v148, v28
    v_sub_f32 v150, v150, v28
    v_sub_f32 v152, v152, v28
    v_sub_f32 v154, v154, v28
    v_sub_f32 v156, v156, v28
    v_sub_f32 v158, v158, v28
    v_mul_f32 v29, v144, v144
    v_fmac_f32 v29, v146, v146
    v_fmac_f32 v29, v148, v148
    v_fmac_f32 v29, v150, v150
    v_fmac_f32 v29, v152, v152
    v_fmac_f32 v29, v154, v154
    v_fmac_f32 v29, v156, v156
    v_fmac_f32 v29, v158, v158
    v_add_f32 v30, v145, v147
    v_add_f32 v30, v30, v149
    v_add_f32 v30, v30, v151
    v_add_f32 v30, v30, v153
    v_add_f32 v30, v30, v155
    v_add_f32 v30, v30, v157
    v_add_f32 v30, v30, v159
    v_fmac_f32 v30, 0x42000000, v29
    v_mov_b32 v29, v30
    s_nop 1
    v_permlane32_swap_b32 v30, v29
    v_add_f32 v30, v30, v29
    v_mov_b32 v29, 0x3727c5ac
    v_fmac_f32 v29, 0x3b000000, v30
    v_rsq_f32 v26, v29
    s_nop 0
    v_mul_f32 v24, v28, v26
    v_sub_f32 v24, 0, v24
    ds_read_b128 v[176:179], v15 offset:2112
    ds_read_b128 v[180:183], v15 offset:2128
    ds_read_b128 v[184:187], v15 offset:64
    ds_read_b128 v[188:191], v15 offset:80
    s_waitcnt vmcnt(15)
    v_lshlrev_b32 v192, 16, v64
    v_and_b32 v193, 0xffff0000, v64
    v_lshlrev_b32 v194, 16, v65
    v_and_b32 v195, 0xffff0000, v65
    v_lshlrev_b32 v196, 16, v66
    v_and_b32 v197, 0xffff0000, v66
    v_lshlrev_b32 v198, 16, v67
    v_and_b32 v199, 0xffff0000, v67
    v_pk_fma_f32 v[192:193], v[192:193], v[22:23], v[20:21] op_sel_hi:[1,0,0]
    v_pk_fma_f32 v[194:195], v[194:195], v[22:23], v[20:21] op_sel_hi:[1,0,0]
    v_pk_fma_f32 v[196:197], v[196:197], v[22:23], v[20:21] op_sel_hi:[1,0,0]
    v_pk_fma_f32 v[198:199], v[198:199], v[22:23], v[20:21] op_sel_hi:[1,0,0]
    s_waitcnt lgkmcnt(5)
    v_pk_fma_f32 v[192:193], v[192:193], v[160:161], v[168:169]
    v_pk_fma_f32 v[194:195], v[194:195], v[162:163], v[170:171]
    s_waitcnt lgkmcnt(4)
    v_pk_fma_f32 v[196:197], v[196:197], v[164:165], v[172:173]
    v_pk_fma_f32 v[198:199], v[198:199], v[166:167], v[174:175]
    v_cvt_pk_bf16_f32 v64, v192, v193
    v_cvt_pk_bf16_f32 v65, v194, v195
    v_cvt_pk_bf16_f32 v66, v196, v197
    v_cvt_pk_bf16_f32 v67, v198, v199
    ds_write_b128 v16, v[64:67] offset:0
    s_waitcnt vmcnt(14)
    v_lshlrev_b32 v200, 16, v68
    v_and_b32 v201, 0xffff0000, v68
    v_lshlrev_b32 v202, 16, v69
    v_and_b32 v203, 0xffff0000, v69
    v_lshlrev_b32 v204, 16, v70
    v_and_b32 v205, 0xffff0000, v70
    v_lshlrev_b32 v206, 16, v71
    v_and_b32 v207, 0xffff0000, v71
    v_pk_fma_f32 v[200:201], v[200:201], v[26:27], v[24:25] op_sel_hi:[1,0,0]
    v_pk_fma_f32 v[202:203], v[202:203], v[26:27], v[24:25] op_sel_hi:[1,0,0]
    v_pk_fma_f32 v[204:205], v[204:205], v[26:27], v[24:25] op_sel_hi:[1,0,0]
    v_pk_fma_f32 v[206:207], v[206:207], v[26:27], v[24:25] op_sel_hi:[1,0,0]
    v_pk_fma_f32 v[200:201], v[200:201], v[160:161], v[168:169]
    v_pk_fma_f32 v[202:203], v[202:203], v[162:163], v[170:171]
    v_pk_fma_f32 v[204:205], v[204:205], v[164:165], v[172:173]
    v_pk_fma_f32 v[206:207], v[206:207], v[166:167], v[174:175]
    v_cvt_pk_bf16_f32 v68, v200, v201
    v_cvt_pk_bf16_f32 v69, v202, v203
    v_cvt_pk_bf16_f32 v70, v204, v205
    v_cvt_pk_bf16_f32 v71, v206, v207
    ds_write_b128 v16, v[68:71] offset:32768
    ds_read_b128 v[160:163], v15 offset:2176
    ds_read_b128 v[164:167], v15 offset:2192
    ds_read_b128 v[168:171], v15 offset:128
    ds_read_b128 v[172:175], v15 offset:144
    s_waitcnt vmcnt(13)
    v_lshlrev_b32 v192, 16, v72
    v_and_b32 v193, 0xffff0000, v72
    v_lshlrev_b32 v194, 16, v73
    v_and_b32 v195, 0xffff0000, v73
    v_lshlrev_b32 v196, 16, v74
    v_and_b32 v197, 0xffff0000, v74
    v_lshlrev_b32 v198, 16, v75
    v_and_b32 v199, 0xffff0000, v75
    v_pk_fma_f32 v[192:193], v[192:193], v[22:23], v[20:21] op_sel_hi:[1,0,0]
    v_pk_fma_f32 v[194:195], v[194:195], v[22:23], v[20:21] op_sel_hi:[1,0,0]
    v_pk_fma_f32 v[196:197], v[196:197], v[22:23], v[20:21] op_sel_hi:[1,0,0]
    v_pk_fma_f32 v[198:199], v[198:199], v[22:23], v[20:21] op_sel_hi:[1,0,0]
    s_waitcnt lgkmcnt(7)
    v_pk_fma_f32 v[192:193], v[192:193], v[176:177], v[184:185]
    v_pk_fma_f32 v[194:195], v[194:195], v[178:179], v[186:187]
    s_waitcnt lgkmcnt(6)
    v_pk_fma_f32 v[196:197], v[196:197], v[180:181], v[188:189]
    v_pk_fma_f32 v[198:199], v[198:199], v[182:183], v[190:191]
    v_cvt_pk_bf16_f32 v72, v192, v193
    v_cvt_pk_bf16_f32 v73, v194, v195
    v_cvt_pk_bf16_f32 v74, v196, v197
    v_cvt_pk_bf16_f32 v75, v198, v199
    ds_write_b128 v16, v[72:75] offset:1024
    s_waitcnt vmcnt(12)
    v_lshlrev_b32 v200, 16, v76
    v_and_b32 v201, 0xffff0000, v76
    v_lshlrev_b32 v202, 16, v77
    v_and_b32 v203, 0xffff0000, v77
    v_lshlrev_b32 v204, 16, v78
    v_and_b32 v205, 0xffff0000, v78
    v_lshlrev_b32 v206, 16, v79
    v_and_b32 v207, 0xffff0000, v79
    v_pk_fma_f32 v[200:201], v[200:201], v[26:27], v[24:25] op_sel_hi:[1,0,0]
    v_pk_fma_f32 v[202:203], v[202:203], v[26:27], v[24:25] op_sel_hi:[1,0,0]
    v_pk_fma_f32 v[204:205], v[204:205], v[26:27], v[24:25] op_sel_hi:[1,0,0]
    v_pk_fma_f32 v[206:207], v[206:207], v[26:27], v[24:25] op_sel_hi:[1,0,0]
    v_pk_fma_f32 v[200:201], v[200:201], v[176:177], v[184:185]
    v_pk_fma_f32 v[202:203], v[202:203], v[178:179], v[186:187]
    v_pk_fma_f32 v[204:205], v[204:205], v[180:181], v[188:189]
    v_pk_fma_f32 v[206:207], v[206:207], v[182:183], v[190:191]
    v_cvt_pk_bf16_f32 v76, v200, v201
    v_cvt_pk_bf16_f32 v77, v202, v203
    v_cvt_pk_bf16_f32 v78, v204, v205
    v_cvt_pk_bf16_f32 v79, v206, v207
    ds_write_b128 v16, v[76:79] offset:33792
    s_add_u32 s72, s36, 16384
    buffer_load_dwordx4 a[192:195], v2, s[4:7], s72 offen offset:0
    buffer_load_dwordx4 a[196:199], v2, s[4:7], s72 offen offset:1024
    buffer_load_dwordx4 a[200:203], v2, s[4:7], s72 offen offset:2048
    ds_read_b128 v[176:179], v15 offset:2240
    ds_read_b128 v[180:183], v15 offset:2256
    ds_read_b128 v[184:187], v15 offset:192
    ds_read_b128 v[188:191], v15 offset:208
    s_waitcnt vmcnt(14)
    v_lshlrev_b32 v192, 16, v80
    v_and_b32 v193, 0xffff0000, v80
    v_lshlrev_b32 v194, 16, v81
    v_and_b32 v195, 0xffff0000, v81
    v_lshlrev_b32 v196, 16, v82
    v_and_b32 v197, 0xffff0000, v82
    v_lshlrev_b32 v198, 16, v83
    v_and_b32 v199, 0xffff0000, v83
    v_pk_fma_f32 v[192:193], v[192:193], v[22:23], v[20:21] op_sel_hi:[1,0,0]
    v_pk_fma_f32 v[194:195], v[194:195], v[22:23], v[20:21] op_sel_hi:[1,0,0]
    v_pk_fma_f32 v[196:197], v[196:197], v[22:23], v[20:21] op_sel_hi:[1,0,0]
    v_pk_fma_f32 v[198:199], v[198:199], v[22:23], v[20:21] op_sel_hi:[1,0,0]
    s_waitcnt lgkmcnt(7)
    v_pk_fma_f32 v[192:193], v[192:193], v[160:161], v[168:169]
    v_pk_fma_f32 v[194:195], v[194:195], v[162:163], v[170:171]
    s_waitcnt lgkmcnt(6)
    v_pk_fma_f32 v[196:197], v[196:197], v[164:165], v[172:173]
    v_pk_fma_f32 v[198:199], v[198:199], v[166:167], v[174:175]
    v_cvt_pk_bf16_f32 v80, v192, v193
    v_cvt_pk_bf16_f32 v81, v194, v195
    v_cvt_pk_bf16_f32 v82, v196, v197
    v_cvt_pk_bf16_f32 v83, v198, v199
    ds_write_b128 v16, v[80:83] offset:2048
    s_waitcnt vmcnt(13)
    v_lshlrev_b32 v200, 16, v84
    v_and_b32 v201, 0xffff0000, v84
    v_lshlrev_b32 v202, 16, v85
    v_and_b32 v203, 0xffff0000, v85
    v_lshlrev_b32 v204, 16, v86
    v_and_b32 v205, 0xffff0000, v86
    v_lshlrev_b32 v206, 16, v87
    v_and_b32 v207, 0xffff0000, v87
    v_pk_fma_f32 v[200:201], v[200:201], v[26:27], v[24:25] op_sel_hi:[1,0,0]
    v_pk_fma_f32 v[202:203], v[202:203], v[26:27], v[24:25] op_sel_hi:[1,0,0]
    v_pk_fma_f32 v[204:205], v[204:205], v[26:27], v[24:25] op_sel_hi:[1,0,0]
    v_pk_fma_f32 v[206:207], v[206:207], v[26:27], v[24:25] op_sel_hi:[1,0,0]
    v_pk_fma_f32 v[200:201], v[200:201], v[160:161], v[168:169]
    v_pk_fma_f32 v[202:203], v[202:203], v[162:163], v[170:171]
    v_pk_fma_f32 v[204:205], v[204:205], v[164:165], v[172:173]
    v_pk_fma_f32 v[206:207], v[206:207], v[166:167], v[174:175]
    v_cvt_pk_bf16_f32 v84, v200, v201
    v_cvt_pk_bf16_f32 v85, v202, v203
    v_cvt_pk_bf16_f32 v86, v204, v205
    v_cvt_pk_bf16_f32 v87, v206, v207
    ds_write_b128 v16, v[84:87] offset:34816
    ds_read_b128 v[160:163], v15 offset:2304
    ds_read_b128 v[164:167], v15 offset:2320
    ds_read_b128 v[168:171], v15 offset:256
    ds_read_b128 v[172:175], v15 offset:272
    s_waitcnt vmcnt(12)
    v_lshlrev_b32 v192, 16, v88
    v_and_b32 v193, 0xffff0000, v88
    v_lshlrev_b32 v194, 16, v89
    v_and_b32 v195, 0xffff0000, v89
    v_lshlrev_b32 v196, 16, v90
    v_and_b32 v197, 0xffff0000, v90
    v_lshlrev_b32 v198, 16, v91
    v_and_b32 v199, 0xffff0000, v91
    v_pk_fma_f32 v[192:193], v[192:193], v[22:23], v[20:21] op_sel_hi:[1,0,0]
    v_pk_fma_f32 v[194:195], v[194:195], v[22:23], v[20:21] op_sel_hi:[1,0,0]
    v_pk_fma_f32 v[196:197], v[196:197], v[22:23], v[20:21] op_sel_hi:[1,0,0]
    v_pk_fma_f32 v[198:199], v[198:199], v[22:23], v[20:21] op_sel_hi:[1,0,0]
    s_waitcnt lgkmcnt(7)
    v_pk_fma_f32 v[192:193], v[192:193], v[176:177], v[184:185]
    v_pk_fma_f32 v[194:195], v[194:195], v[178:179], v[186:187]
    s_waitcnt lgkmcnt(6)
    v_pk_fma_f32 v[196:197], v[196:197], v[180:181], v[188:189]
    v_pk_fma_f32 v[198:199], v[198:199], v[182:183], v[190:191]
    v_cvt_pk_bf16_f32 v88, v192, v193
    v_cvt_pk_bf16_f32 v89, v194, v195
    v_cvt_pk_bf16_f32 v90, v196, v197
    v_cvt_pk_bf16_f32 v91, v198, v199
    ds_write_b128 v16, v[88:91] offset:3072
    buffer_load_dwordx4 a[204:207], v2, s[4:7], s72 offen offset:3072
    s_add_u32 s72, s36, 20480
    buffer_load_dwordx4 a[208:211], v2, s[4:7], s72 offen offset:0
    buffer_load_dwordx4 a[212:215], v2, s[4:7], s72 offen offset:1024
    s_waitcnt vmcnt(14)
    v_lshlrev_b32 v200, 16, v92
    v_and_b32 v201, 0xffff0000, v92
    v_lshlrev_b32 v202, 16, v93
    v_and_b32 v203, 0xffff0000, v93
    v_lshlrev_b32 v204, 16, v94
    v_and_b32 v205, 0xffff0000, v94
    v_lshlrev_b32 v206, 16, v95
    v_and_b32 v207, 0xffff0000, v95
    v_pk_fma_f32 v[200:201], v[200:201], v[26:27], v[24:25] op_sel_hi:[1,0,0]
    v_pk_fma_f32 v[202:203], v[202:203], v[26:27], v[24:25] op_sel_hi:[1,0,0]
    v_pk_fma_f32 v[204:205], v[204:205], v[26:27], v[24:25] op_sel_hi:[1,0,0]
    v_pk_fma_f32 v[206:207], v[206:207], v[26:27], v[24:25] op_sel_hi:[1,0,0]
    v_pk_fma_f32 v[200:201], v[200:201], v[176:177], v[184:185]
    v_pk_fma_f32 v[202:203], v[202:203], v[178:179], v[186:187]
    v_pk_fma_f32 v[204:205], v[204:205], v[180:181], v[188:189]
    v_pk_fma_f32 v[206:207], v[206:207], v[182:183], v[190:191]
    v_cvt_pk_bf16_f32 v92, v200, v201
    v_cvt_pk_bf16_f32 v93, v202, v203
    v_cvt_pk_bf16_f32 v94, v204, v205
    v_cvt_pk_bf16_f32 v95, v206, v207
    ds_write_b128 v16, v[92:95] offset:35840
    ds_read_b128 v[176:179], v15 offset:2368
    ds_read_b128 v[180:183], v15 offset:2384
    ds_read_b128 v[184:187], v15 offset:320
    ds_read_b128 v[188:191], v15 offset:336
    s_waitcnt vmcnt(13)
    v_lshlrev_b32 v192, 16, v96
    v_and_b32 v193, 0xffff0000, v96
    v_lshlrev_b32 v194, 16, v97
    v_and_b32 v195, 0xffff0000, v97
    v_lshlrev_b32 v196, 16, v98
    v_and_b32 v197, 0xffff0000, v98
    v_lshlrev_b32 v198, 16, v99
    v_and_b32 v199, 0xffff0000, v99
    v_pk_fma_f32 v[192:193], v[192:193], v[22:23], v[20:21] op_sel_hi:[1,0,0]
    v_pk_fma_f32 v[194:195], v[194:195], v[22:23], v[20:21] op_sel_hi:[1,0,0]
    v_pk_fma_f32 v[196:197], v[196:197], v[22:23], v[20:21] op_sel_hi:[1,0,0]
    v_pk_fma_f32 v[198:199], v[198:199], v[22:23], v[20:21] op_sel_hi:[1,0,0]
    s_waitcnt lgkmcnt(7)
    v_pk_fma_f32 v[192:193], v[192:193], v[160:161], v[168:169]
    v_pk_fma_f32 v[194:195], v[194:195], v[162:163], v[170:171]
    s_waitcnt lgkmcnt(6)
    v_pk_fma_f32 v[196:197], v[196:197], v[164:165], v[172:173]
    v_pk_fma_f32 v[198:199], v[198:199], v[166:167], v[174:175]
    v_cvt_pk_bf16_f32 v96, v192, v193
    v_cvt_pk_bf16_f32 v97, v194, v195
    v_cvt_pk_bf16_f32 v98, v196, v197
    v_cvt_pk_bf16_f32 v99, v198, v199
    ds_write_b128 v16, v[96:99] offset:4096
    s_waitcnt vmcnt(12)
    v_lshlrev_b32 v200, 16, v100
    v_and_b32 v201, 0xffff0000, v100
    v_lshlrev_b32 v202, 16, v101
    v_and_b32 v203, 0xffff0000, v101
    v_lshlrev_b32 v204, 16, v102
    v_and_b32 v205, 0xffff0000, v102
    v_lshlrev_b32 v206, 16, v103
    v_and_b32 v207, 0xffff0000, v103
    v_pk_fma_f32 v[200:201], v[200:201], v[26:27], v[24:25] op_sel_hi:[1,0,0]
    v_pk_fma_f32 v[202:203], v[202:203], v[26:27], v[24:25] op_sel_hi:[1,0,0]
    v_pk_fma_f32 v[204:205], v[204:205], v[26:27], v[24:25] op_sel_hi:[1,0,0]
    v_pk_fma_f32 v[206:207], v[206:207], v[26:27], v[24:25] op_sel_hi:[1,0,0]
    v_pk_fma_f32 v[200:201], v[200:201], v[160:161], v[168:169]
    v_pk_fma_f32 v[202:203], v[202:203], v[162:163], v[170:171]
    v_pk_fma_f32 v[204:205], v[204:205], v[164:165], v[172:173]
    v_pk_fma_f32 v[206:207], v[206:207], v[166:167], v[174:175]
    v_cvt_pk_bf16_f32 v100, v200, v201
    v_cvt_pk_bf16_f32 v101, v202, v203
    v_cvt_pk_bf16_f32 v102, v204, v205
    v_cvt_pk_bf16_f32 v103, v206, v207
    ds_write_b128 v16, v[100:103] offset:36864
    buffer_load_dwordx4 a[216:219], v2, s[4:7], s72 offen offset:2048
    buffer_load_dwordx4 a[220:223], v2, s[4:7], s72 offen offset:3072
    s_add_u32 s72, s36, 24576
    buffer_load_dwordx4 a[224:227], v2, s[4:7], s72 offen offset:0
    ds_read_b128 v[160:163], v15 offset:2432
    ds_read_b128 v[164:167], v15 offset:2448
    ds_read_b128 v[168:171], v15 offset:384
    ds_read_b128 v[172:175], v15 offset:400
    s_waitcnt vmcnt(14)
    v_lshlrev_b32 v192, 16, v104
    v_and_b32 v193, 0xffff0000, v104
    v_lshlrev_b32 v194, 16, v105
    v_and_b32 v195, 0xffff0000, v105
    v_lshlrev_b32 v196, 16, v106
    v_and_b32 v197, 0xffff0000, v106
    v_lshlrev_b32 v198, 16, v107
    v_and_b32 v199, 0xffff0000, v107
    v_pk_fma_f32 v[192:193], v[192:193], v[22:23], v[20:21] op_sel_hi:[1,0,0]
    v_pk_fma_f32 v[194:195], v[194:195], v[22:23], v[20:21] op_sel_hi:[1,0,0]
    v_pk_fma_f32 v[196:197], v[196:197], v[22:23], v[20:21] op_sel_hi:[1,0,0]
    v_pk_fma_f32 v[198:199], v[198:199], v[22:23], v[20:21] op_sel_hi:[1,0,0]
    s_waitcnt lgkmcnt(7)
    v_pk_fma_f32 v[192:193], v[192:193], v[176:177], v[184:185]
    v_pk_fma_f32 v[194:195], v[194:195], v[178:179], v[186:187]
    s_waitcnt lgkmcnt(6)
    v_pk_fma_f32 v[196:197], v[196:197], v[180:181], v[188:189]
    v_pk_fma_f32 v[198:199], v[198:199], v[182:183], v[190:191]
    v_cvt_pk_bf16_f32 v104, v192, v193
    v_cvt_pk_bf16_f32 v105, v194, v195
    v_cvt_pk_bf16_f32 v106, v196, v197
    v_cvt_pk_bf16_f32 v107, v198, v199
    ds_write_b128 v16, v[104:107] offset:5120
    s_waitcnt vmcnt(13)
    v_lshlrev_b32 v200, 16, v108
    v_and_b32 v201, 0xffff0000, v108
    v_lshlrev_b32 v202, 16, v109
    v_and_b32 v203, 0xffff0000, v109
    v_lshlrev_b32 v204, 16, v110
    v_and_b32 v205, 0xffff0000, v110
    v_lshlrev_b32 v206, 16, v111
    v_and_b32 v207, 0xffff0000, v111
    v_pk_fma_f32 v[200:201], v[200:201], v[26:27], v[24:25] op_sel_hi:[1,0,0]
    v_pk_fma_f32 v[202:203], v[202:203], v[26:27], v[24:25] op_sel_hi:[1,0,0]
    v_pk_fma_f32 v[204:205], v[204:205], v[26:27], v[24:25] op_sel_hi:[1,0,0]
    v_pk_fma_f32 v[206:207], v[206:207], v[26:27], v[24:25] op_sel_hi:[1,0,0]
    v_pk_fma_f32 v[200:201], v[200:201], v[176:177], v[184:185]
    v_pk_fma_f32 v[202:203], v[202:203], v[178:179], v[186:187]
    v_pk_fma_f32 v[204:205], v[204:205], v[180:181], v[188:189]
    v_pk_fma_f32 v[206:207], v[206:207], v[182:183], v[190:191]
    v_cvt_pk_bf16_f32 v108, v200, v201
    v_cvt_pk_bf16_f32 v109, v202, v203
    v_cvt_pk_bf16_f32 v110, v204, v205
    v_cvt_pk_bf16_f32 v111, v206, v207
    ds_write_b128 v16, v[108:111] offset:37888
    ds_read_b128 v[176:179], v15 offset:2496
    ds_read_b128 v[180:183], v15 offset:2512
    ds_read_b128 v[184:187], v15 offset:448
    ds_read_b128 v[188:191], v15 offset:464
    s_waitcnt vmcnt(12)
    v_lshlrev_b32 v192, 16, v112
    v_and_b32 v193, 0xffff0000, v112
    v_lshlrev_b32 v194, 16, v113
    v_and_b32 v195, 0xffff0000, v113
    v_lshlrev_b32 v196, 16, v114
    v_and_b32 v197, 0xffff0000, v114
    v_lshlrev_b32 v198, 16, v115
    v_and_b32 v199, 0xffff0000, v115
    v_pk_fma_f32 v[192:193], v[192:193], v[22:23], v[20:21] op_sel_hi:[1,0,0]
    v_pk_fma_f32 v[194:195], v[194:195], v[22:23], v[20:21] op_sel_hi:[1,0,0]
    v_pk_fma_f32 v[196:197], v[196:197], v[22:23], v[20:21] op_sel_hi:[1,0,0]
    v_pk_fma_f32 v[198:199], v[198:199], v[22:23], v[20:21] op_sel_hi:[1,0,0]
    s_waitcnt lgkmcnt(7)
    v_pk_fma_f32 v[192:193], v[192:193], v[160:161], v[168:169]
    v_pk_fma_f32 v[194:195], v[194:195], v[162:163], v[170:171]
    s_waitcnt lgkmcnt(6)
    v_pk_fma_f32 v[196:197], v[196:197], v[164:165], v[172:173]
    v_pk_fma_f32 v[198:199], v[198:199], v[166:167], v[174:175]
    v_cvt_pk_bf16_f32 v112, v192, v193
    v_cvt_pk_bf16_f32 v113, v194, v195
    v_cvt_pk_bf16_f32 v114, v196, v197
    v_cvt_pk_bf16_f32 v115, v198, v199
    ds_write_b128 v16, v[112:115] offset:6144
    buffer_load_dwordx4 a[228:231], v2, s[4:7], s72 offen offset:1024
    buffer_load_dwordx4 a[232:235], v2, s[4:7], s72 offen offset:2048
    buffer_load_dwordx4 a[236:239], v2, s[4:7], s72 offen offset:3072
    s_waitcnt vmcnt(14)
    v_lshlrev_b32 v200, 16, v116
    v_and_b32 v201, 0xffff0000, v116
    v_lshlrev_b32 v202, 16, v117
    v_and_b32 v203, 0xffff0000, v117
    v_lshlrev_b32 v204, 16, v118
    v_and_b32 v205, 0xffff0000, v118
    v_lshlrev_b32 v206, 16, v119
    v_and_b32 v207, 0xffff0000, v119
    v_pk_fma_f32 v[200:201], v[200:201], v[26:27], v[24:25] op_sel_hi:[1,0,0]
    v_pk_fma_f32 v[202:203], v[202:203], v[26:27], v[24:25] op_sel_hi:[1,0,0]
    v_pk_fma_f32 v[204:205], v[204:205], v[26:27], v[24:25] op_sel_hi:[1,0,0]
    v_pk_fma_f32 v[206:207], v[206:207], v[26:27], v[24:25] op_sel_hi:[1,0,0]
    v_pk_fma_f32 v[200:201], v[200:201], v[160:161], v[168:169]
    v_pk_fma_f32 v[202:203], v[202:203], v[162:163], v[170:171]
    v_pk_fma_f32 v[204:205], v[204:205], v[164:165], v[172:173]
    v_pk_fma_f32 v[206:207], v[206:207], v[166:167], v[174:175]
    v_cvt_pk_bf16_f32 v116, v200, v201
    v_cvt_pk_bf16_f32 v117, v202, v203
    v_cvt_pk_bf16_f32 v118, v204, v205
    v_cvt_pk_bf16_f32 v119, v206, v207
    ds_write_b128 v16, v[116:119] offset:38912
    s_waitcnt vmcnt(13)
    v_lshlrev_b32 v192, 16, v120
    v_and_b32 v193, 0xffff0000, v120
    v_lshlrev_b32 v194, 16, v121
    v_and_b32 v195, 0xffff0000, v121
    v_lshlrev_b32 v196, 16, v122
    v_and_b32 v197, 0xffff0000, v122
    v_lshlrev_b32 v198, 16, v123
    v_and_b32 v199, 0xffff0000, v123
    v_pk_fma_f32 v[192:193], v[192:193], v[22:23], v[20:21] op_sel_hi:[1,0,0]
    v_pk_fma_f32 v[194:195], v[194:195], v[22:23], v[20:21] op_sel_hi:[1,0,0]
    v_pk_fma_f32 v[196:197], v[196:197], v[22:23], v[20:21] op_sel_hi:[1,0,0]
    v_pk_fma_f32 v[198:199], v[198:199], v[22:23], v[20:21] op_sel_hi:[1,0,0]
    s_waitcnt lgkmcnt(3)
    v_pk_fma_f32 v[192:193], v[192:193], v[176:177], v[184:185]
    v_pk_fma_f32 v[194:195], v[194:195], v[178:179], v[186:187]
    s_waitcnt lgkmcnt(2)
    v_pk_fma_f32 v[196:197], v[196:197], v[180:181], v[188:189]
    v_pk_fma_f32 v[198:199], v[198:199], v[182:183], v[190:191]
    v_cvt_pk_bf16_f32 v120, v192, v193
    v_cvt_pk_bf16_f32 v121, v194, v195
    v_cvt_pk_bf16_f32 v122, v196, v197
    v_cvt_pk_bf16_f32 v123, v198, v199
    ds_write_b128 v16, v[120:123] offset:7168
    s_waitcnt vmcnt(12)
    v_lshlrev_b32 v200, 16, v124
    v_and_b32 v201, 0xffff0000, v124
    v_lshlrev_b32 v202, 16, v125
    v_and_b32 v203, 0xffff0000, v125
    v_lshlrev_b32 v204, 16, v126
    v_and_b32 v205, 0xffff0000, v126
    v_lshlrev_b32 v206, 16, v127
    v_and_b32 v207, 0xffff0000, v127
    v_pk_fma_f32 v[200:201], v[200:201], v[26:27], v[24:25] op_sel_hi:[1,0,0]
    v_pk_fma_f32 v[202:203], v[202:203], v[26:27], v[24:25] op_sel_hi:[1,0,0]
    v_pk_fma_f32 v[204:205], v[204:205], v[26:27], v[24:25] op_sel_hi:[1,0,0]
    v_pk_fma_f32 v[206:207], v[206:207], v[26:27], v[24:25] op_sel_hi:[1,0,0]
    v_pk_fma_f32 v[200:201], v[200:201], v[176:177], v[184:185]
    v_pk_fma_f32 v[202:203], v[202:203], v[178:179], v[186:187]
    v_pk_fma_f32 v[204:205], v[204:205], v[180:181], v[188:189]
    v_pk_fma_f32 v[206:207], v[206:207], v[182:183], v[190:191]
    v_cvt_pk_bf16_f32 v124, v200, v201
    v_cvt_pk_bf16_f32 v125, v202, v203
    v_cvt_pk_bf16_f32 v126, v204, v205
    v_cvt_pk_bf16_f32 v127, v206, v207
    ds_write_b128 v16, v[124:127] offset:39936
    s_add_u32 s72, s36, 28672
    buffer_load_dwordx4 a[240:243], v2, s[4:7], s72 offen offset:0
    buffer_load_dwordx4 a[244:247], v2, s[4:7], s72 offen offset:1024
    buffer_load_dwordx4 a[248:251], v2, s[4:7], s72 offen offset:2048
    s_waitcnt lgkmcnt(0)
    s_barrier
    s_cmp_ge_u32 s37, 29
    s_cbranch_scc1 L_k6_nomm
    s_mul_i32 s40, s33, 176128
    s_add_u32 s40, s40, 0x1a00000
    s_add_u32 s41, s40, 88064
    s_add_u32 s12, s50, s40
    s_addc_u32 s13, s51, 0
    s_mov_b32 s14, 0x15800
    s_mov_b32 s15, 0x00020000
    s_add_u32 s16, s50, s41
    s_addc_u32 s17, s51, 0
    s_mov_b32 s18, 0x15800
    s_mov_b32 s19, 0x00020000
    s_mul_i32 s42, s37, 3072
    s_mov_b32 s43, 0xc0135761
    v_mov_b32 v6, 0xbdd2d3e8
    s_mul_i32 s46, s34, 176128
    s_add_u32 s46, s46, 0x2400000
    s_add_u32 s76, s50, s46
    s_addc_u32 s77, s51, 0
    s_mov_b32 s78, 0x2b000
    s_mov_b32 s79, 0x00020000
    s_mul_i32 s75, s32, 45056
    s_add_u32 s28, s50, 0x1400000
    s_addc_u32 s29, s51, 0
    s_mov_b32 s30, 0x200000
    s_mov_b32 s31, 0x00020000
    s_add_u32 s20, s50, 0x2800
    s_addc_u32 s21, s51, 0
    s_mov_b32 s22, 0x800
    s_mov_b32 s23, 0x00020000
    s_lshr_b32 s47, s32, 1
    s_lshl_b32 s47, s47, 10
    v_add_u32 v18, s47, v4
    s_xor_b32 s47, s47, 1024
    v_add_u32 v19, s47, v4
    ds_read_b128 v[96:99], v4 offset:0
    ds_read_b128 v[100:103], v17 offset:0
    ds_read_b128 v[104:107], v4 offset:1024
    ds_read_b128 v[108:111], v17 offset:1024
    ds_read_b128 v[112:115], v4 offset:2048
    ds_read_b128 v[116:119], v17 offset:2048
    s_waitcnt lgkmcnt(5)
    v_mfma_f32_32x32x16_bf16 v[128:143], a[0:3], v[96:99], 0
    ds_read_b128 v[120:123], v4 offset:3072
    ds_read_b128 v[124:127], v17 offset:3072
    s_waitcnt lgkmcnt(6)
    v_mfma_f32_32x32x16_bf16 v[144:159], a[0:3], v[100:103], 0
    s_waitcnt lgkmcnt(5)
    v_mfma_f32_32x32x16_bf16 v[128:143], a[4:7], v[104:107], v[128:143]
    ds_read_b128 v[96:99], v4 offset:4096
    ds_read_b128 v[100:103], v17 offset:4096
    s_waitcnt lgkmcnt(6)
    v_mfma_f32_32x32x16_bf16 v[144:159], a[4:7], v[108:111], v[144:159]
    s_add_u32 s80, s36, 28672
    buffer_load_dwordx4 a[0:3], v2, s[4:7], s80 offen offset:3072
    s_waitcnt lgkmcnt(5)
    v_mfma_f32_32x32x16_bf16 v[128:143], a[8:11], v[112:115], v[128:143]
    ds_read_b128 v[104:107], v4 offset:5120
    ds_read_b128 v[108:111], v17 offset:5120
    s_waitcnt lgkmcnt(6)
    v_mfma_f32_32x32x16_bf16 v[144:159], a[8:11], v[116:119], v[144:159]
    s_waitcnt lgkmcnt(5)
    v_mfma_f32_32x32x16_bf16 v[128:143], a[12:15], v[120:123], v[128:143]
    ds_read_b128 v[112:115], v4 offset:6144
    ds_read_b128 v[116:119], v17 offset:6144
    s_waitcnt lgkmcnt(6)
    v_mfma_f32_32x32x16_bf16 v[144:159], a[12:15], v[124:127], v[144:159]
    s_add_u32 s80, s36, 0
    buffer_load_dwordx4 a[4:7], v3, s[4:7], s80 offen offset:0
    s_waitcnt lgkmcnt(5)
    v_mfma_f32_32x32x16_bf16 v[128:143], a[16:19], v[96:99], v[128:143]
    ds_read_b128 v[120:123], v4 offset:7168
    ds_read_b128 v[124:127], v17 offset:7168
    s_waitcnt lgkmcnt(6)
    v_mfma_f32_32x32x16_bf16 v[144:159], a[16:19], v[100:103], v[144:159]
    s_waitcnt lgkmcnt(5)
    v_mfma_f32_32x32x16_bf16 v[128:143], a[20:23], v[104:107], v[128:143]
    ds_read_b128 v[96:99], v4 offset:8192
    ds_read_b128 v[100:103], v17 offset:8192
    s_waitcnt lgkmcnt(6)
    v_mfma_f32_32x32x16_bf16 v[144:159], a[20:23], v[108:111], v[144:159]
    buffer_load_dwordx4 a[8:11], v3, s[4:7], s80 offen offset:1024
    s_waitcnt lgkmcnt(5)
    v_mfma_f32_32x32x16_bf16 v[128:143], a[24:27], v[112:115], v[128:143]
    ds_read_b128 v[104:107], v4 offset:9216
    ds_read_b128 v[108:111], v17 offset:9216
    s_waitcnt lgkmcnt(6)
    v_mfma_f32_32x32x16_bf16 v[144:159], a[24:27], v[116:119], v[144:159]
    s_waitcnt lgkmcnt(5)
    v_mfma_f32_32x32x16_bf16 v[128:143], a[28:31], v[120:123], v[128:143]
    ds_read_b128 v[112:115], v4 offset:10240
    ds_read_b128 v[116:119], v17 offset:10240
    s_waitcnt lgkmcnt(6)
    v_mfma_f32_32x32x16_bf16 v[144:159], a[28:31], v[124:127], v[144:159]
    buffer_load_dwordx4 a[12:15], v3, s[4:7], s80 offen offset:2048
    s_waitcnt lgkmcnt(5)
    v_mfma_f32_32x32x16_bf16 v[128:143], a[32:35], v[96:99], v[128:143]
    ds_read_b128 v[120:123], v4 offset:11264
    ds_read_b128 v[124:127], v17 offset:11264
    s_waitcnt lgkmcnt(6)
    v_mfma_f32_32x32x16_bf16 v[144:159], a[32:35], v[100:103], v[144:159]
    s_waitcnt lgkmcnt(5)
    v_mfma_f32_32x32x16_bf16 v[128:143], a[36:39], v[104:107], v[128:143]
    ds_read_b128 v[96:99], v4 offset:12288
    ds_read_b128 v[100:103], v17 offset:12288
    s_waitcnt lgkmcnt(6)
    v_mfma_f32_32x32x16_bf16 v[144:159], a[36:39], v[108:111], v[144:159]
    buffer_load_dwordx4 a[16:19], v3, s[4:7], s80 offen offset:3072
    s_waitcnt lgkmcnt(5)
    v_mfma_f32_32x32x16_bf16 v[128:143], a[40:43], v[112:115], v[128:143]
    ds_read_b128 v[104:107], v4 offset:13312
    ds_read_b128 v[108:111], v17 offset:13312
    s_waitcnt lgkmcnt(6)
    v_mfma_f32_32x32x16_bf16 v[144:159], a[40:43], v[116:119], v[144:159]
    s_waitcnt lgkmcnt(5)
    v_mfma_f32_32x32x16_bf16 v[128:143], a[44:47], v[120:123], v[128:143]
    ds_read_b128 v[112:115], v4 offset:14336
    ds_read_b128 v[116:119], v17 offset:14336
    s_waitcnt lgkmcnt(6)
    v_mfma_f32_32x32x16_bf16 v[144:159], a[44:47], v[124:127], v[144:159]
    s_add_u32 s80, s36, 4096
    buffer_load_dwordx4 a[20:23], v3, s[4:7], s80 offen offset:0
    s_waitcnt lgkmcnt(5)
    v_mfma_f32_32x32x16_bf16 v[128:143], a[48:51], v[96:99], v[128:143]
    ds_read_b128 v[120:123], v4 offset:15360
    ds_read_b128 v[124:127], v17 offset:15360
    s_waitcnt lgkmcnt(6)
    v_mfma_f32_32x32x16_bf16 v[144:159], a[48:51], v[100:103], v[144:159]
    s_waitcnt lgkmcnt(5)
    v_mfma_f32_32x32x16_bf16 v[128:143], a[52:55], v[104:107], v[128:143]
    ds_read_b128 v[96:99], v4 offset:16384
    ds_read_b128 v[100:103], v17 offset:16384
    s_waitcnt lgkmcnt(6)
    v_mfma_f32_32x32x16_bf16 v[144:159], a[52:55], v[108:111], v[144:159]
    buffer_load_dwordx4 a[24:27], v3, s[4:7], s80 offen offset:1024
    s_waitcnt lgkmcnt(5)
    v_mfma_f32_32x32x16_bf16 v[128:143], a[56:59], v[112:115], v[128:143]
    ds_read_b128 v[104:107], v4 offset:17408
    ds_read_b128 v[108:111], v17 offset:17408
    s_waitcnt lgkmcnt(6)
    v_mfma_f32_32x32x16_bf16 v[144:159], a[56:59], v[116:119], v[144:159]
    s_waitcnt lgkmcnt(5)
    v_mfma_f32_32x32x16_bf16 v[128:143], a[60:63], v[120:123], v[128:143]
    ds_read_b128 v[112:115], v4 offset:18432
    ds_read_b128 v[116:119], v17 offset:18432
    s_waitcnt lgkmcnt(6)
    v_mfma_f32_32x32x16_bf16 v[144:159], a[60:63], v[124:127], v[144:159]
    buffer_load_dwordx4 a[28:31], v3, s[4:7], s80 offen offset:2048
    s_waitcnt lgkmcnt(5)
    v_mfma_f32_32x32x16_bf16 v[128:143], a[64:67], v[96:99], v[128:143]
    ds_read_b128 v[120:123], v4 offset:19456
    ds_read_b128 v[124:127], v17 offset:19456
    s_waitcnt lgkmcnt(6)
    v_mfma_f32_32x32x16_bf16 v[144:159], a[64:67], v[100:103], v[144:159]
    s_waitcnt lgkmcnt(5)
    v_mfma_f32_32x32x16_bf16 v[128:143], a[68:71], v[104:107], v[128:143]
    ds_read_b128 v[96:99], v4 offset:20480
    ds_read_b128 v[100:103], v17 offset:20480
    s_waitcnt lgkmcnt(6)
    v_mfma_f32_32x32x16_bf16 v[144:159], a[68:71], v[108:111], v[144:159]
    buffer_load_dwordx4 a[32:35], v3, s[4:7], s80 offen offset:3072
    s_waitcnt lgkmcnt(5)
    v_mfma_f32_32x32x16_bf16 v[128:143], a[72:75], v[112:115], v[128:143]
    ds_read_b128 v[104:107], v4 offset:21504
    ds_read_b128 v[108:111], v17 offset:21504
    s_waitcnt lgkmcnt(6)
    v_mfma_f32_32x32x16_bf16 v[144:159], a[72:75], v[116:119], v[144:159]
    s_waitcnt lgkmcnt(5)
    v_mfma_f32_32x32x16_bf16 v[128:143], a[76:79], v[120:123], v[128:143]
    ds_read_b128 v[112:115], v4 offset:22528
    ds_read_b128 v[116:119], v17 offset:22528
    s_waitcnt lgkmcnt(6)
    v_mfma_f32_32x32x16_bf16 v[144:159], a[76:79], v[124:127], v[144:159]
    s_add_u32 s80, s36, 8192
    buffer_load_dwordx4 a[36:39], v3, s[4:7], s80 offen offset:0
    s_waitcnt lgkmcnt(5)
    v_mfma_f32_32x32x16_bf16 v[128:143], a[80:83], v[96:99], v[128:143]
    ds_read_b128 v[120:123], v4 offset:23552
    ds_read_b128 v[124:127], v17 offset:23552
    s_waitcnt lgkmcnt(6)
    v_mfma_f32_32x32x16_bf16 v[144:159], a[80:83], v[100:103], v[144:159]
    s_waitcnt lgkmcnt(5)
    v_mfma_f32_32x32x16_bf16 v[128:143], a[84:87], v[104:107], v[128:143]
    ds_read_b128 v[96:99], v4 offset:24576
    ds_read_b128 v[100:103], v17 offset:24576
    s_waitcnt lgkmcnt(6)
    v_mfma_f32_32x32x16_bf16 v[144:159], a[84:87], v[108:111], v[144:159]
    buffer_load_dwordx4 a[40:43], v3, s[4:7], s80 offen offset:1024
    s_waitcnt lgkmcnt(5)
    v_mfma_f32_32x32x16_bf16 v[128:143], a[88:91], v[112:115], v[128:143]
    ds_read_b128 v[104:107], v4 offset:25600
    ds_read_b128 v[108:111], v17 offset:25600
    s_waitcnt lgkmcnt(6)
    v_mfma_f32_32x32x16_bf16 v[144:159], a[88:91], v[116:119], v[144:159]
    s_waitcnt lgkmcnt(5)
    v_mfma_f32_32x32x16_bf16 v[128:143], a[92:95], v[120:123], v[128:143]
    ds_read_b128 v[112:115], v4 offset:26624
    ds_read_b128 v[116:119], v17 offset:26624
    s_waitcnt lgkmcnt(6)
    v_mfma_f32_32x32x16_bf16 v[144:159], a[92:95], v[124:127], v[144:159]
    buffer_load_dwordx4 a[44:47], v3, s[4:7], s80 offen offset:2048
    s_waitcnt lgkmcnt(5)
    v_mfma_f32_32x32x16_bf16 v[128:143], a[96:99], v[96:99], v[128:143]
    ds_read_b128 v[120:123], v4 offset:27648
    ds_read_b128 v[124:127], v17 offset:27648
    s_waitcnt lgkmcnt(6)
    v_mfma_f32_32x32x16_bf16 v[144:159], a[96:99], v[100:103], v[144:159]
    s_waitcnt lgkmcnt(5)
    v_mfma_f32_32x32x16_bf16 v[128:143], a[100:103], v[104:107], v[128:143]
    ds_read_b128 v[96:99], v4 offset:28672
    ds_read_b128 v[100:103], v17 offset:28672
    s_waitcnt lgkmcnt(6)
    v_mfma_f32_32x32x16_bf16 v[144:159], a[100:103], v[108:111], v[144:159]
    buffer_load_dwordx4 a[48:51], v3, s[4:7], s80 offen offset:3072
    s_waitcnt lgkmcnt(5)
    v_mfma_f32_32x32x16_bf16 v[128:143], a[104:107], v[112:115], v[128:143]
    ds_read_b128 v[104:107], v4 offset:29696
    ds_read_b128 v[108:111], v17 offset:29696
    s_waitcnt lgkmcnt(6)
    v_mfma_f32_32x32x16_bf16 v[144:159], a[104:107], v[116:119], v[144:159]
    s_waitcnt lgkmcnt(5)
    v_mfma_f32_32x32x16_bf16 v[128:143], a[108:111], v[120:123], v[128:143]
    ds_read_b128 v[112:115], v4 offset:30720
    ds_read_b128 v[116:119], v17 offset:30720
    s_waitcnt lgkmcnt(6)
    v_mfma_f32_32x32x16_bf16 v[144:159], a[108:111], v[124:127], v[144:159]
    s_add_u32 s80, s36, 12288
    buffer_load_dwordx4 a[52:55], v3, s[4:7], s80 offen offset:0
    s_waitcnt lgkmcnt(5)
    v_mfma_f32_32x32x16_bf16 v[128:143], a[112:115], v[96:99], v[128:143]
    ds_read_b128 v[120:123], v4 offset:31744
    ds_read_b128 v[124:127], v17 offset:31744
    s_waitcnt lgkmcnt(6)
    v_mfma_f32_32x32x16_bf16 v[144:159], a[112:115], v[100:103], v[144:159]
    s_waitcnt lgkmcnt(5)
    v_mfma_f32_32x32x16_bf16 v[128:143], a[116:119], v[104:107], v[128:143]
    ds_read_b128 v[96:99], v4 offset:0
    ds_read_b128 v[100:103], v17 offset:0
    s_waitcnt lgkmcnt(6)
    v_mfma_f32_32x32x16_bf16 v[144:159], a[116:119], v[108:111], v[144:159]
    buffer_load_dwordx4 a[56:59], v3, s[4:7], s80 offen offset:1024
    s_waitcnt lgkmcnt(5)
    v_mfma_f32_32x32x16_bf16 v[128:143], a[120:123], v[112:115], v[128:143]
    ds_read_b128 v[104:107], v4 offset:1024
    ds_read_b128 v[108:111], v17 offset:1024
    s_waitcnt lgkmcnt(6)
    v_mfma_f32_32x32x16_bf16 v[144:159], a[120:123], v[116:119], v[144:159]
    s_waitcnt lgkmcnt(5)
    v_mfma_f32_32x32x16_bf16 v[128:143], a[124:127], v[120:123], v[128:143]
    ds_read_b128 v[112:115], v4 offset:2048
    ds_read_b128 v[116:119], v17 offset:2048
    s_waitcnt lgkmcnt(6)
    v_mfma_f32_32x32x16_bf16 v[144:159], a[124:127], v[124:127], v[144:159]
    buffer_load_dwordx4 a[60:63], v3, s[4:7], s80 offen offset:2048
    s_waitcnt lgkmcnt(5)
    v_mfma_f32_32x32x16_bf16 v[160:175], a[128:131], v[96:99], 0
    ds_read_b128 v[120:123], v4 offset:3072
    ds_read_b128 v[124:127], v17 offset:3072
    s_waitcnt lgkmcnt(6)
    v_mfma_f32_32x32x16_bf16 v[176:191], a[128:131], v[100:103], 0
    s_waitcnt lgkmcnt(5)
    v_mfma_f32_32x32x16_bf16 v[160:175], a[132:135], v[104:107], v[160:175]
    ds_read_b128 v[96:99], v4 offset:4096
    ds_read_b128 v[100:103], v17 offset:4096
    v_mul_f32 v64, v128, v128
    v_mul_f32 v65, v129, v129
    v_mul_f32 v66, v130, v130
    s_waitcnt lgkmcnt(6)
    v_mfma_f32_32x32x16_bf16 v[176:191], a[132:135], v[108:111], v[176:191]
    buffer_load_dwordx4 a[64:67], v3, s[4:7], s80 offen offset:3072
    v_mul_f32 v67, v131, v131
    v_mul_f32 v68, v132, v132
    v_mul_f32 v69, v133, v133
    s_waitcnt lgkmcnt(5)
    v_mfma_f32_32x32x16_bf16 v[160:175], a[136:139], v[112:115], v[160:175]
    ds_read_b128 v[104:107], v4 offset:5120
    ds_read_b128 v[108:111], v17 offset:5120
    v_mul_f32 v70, v134, v134
    v_mul_f32 v71, v135, v135
    v_fma_f32 v64, v64, v6, s43
    s_waitcnt lgkmcnt(6)
    v_mfma_f32_32x32x16_bf16 v[176:191], a[136:139], v[116:119], v[176:191]
    s_add_u32 s73, s75, 0
    buffer_load_dwordx4 a[132:135], v18, s[76:79], s73 offen offset:0
    v_fma_f32 v65, v65, v6, s43
    v_fma_f32 v66, v66, v6, s43
    v_fma_f32 v67, v67, v6, s43
    s_waitcnt lgkmcnt(5)
    v_mfma_f32_32x32x16_bf16 v[160:175], a[140:143], v[120:123], v[160:175]
    ds_read_b128 v[112:115], v4 offset:6144
    ds_read_b128 v[116:119], v17 offset:6144
    v_fma_f32 v68, v68, v6, s43
    v_fma_f32 v69, v69, v6, s43
    v_fma_f32 v70, v70, v6, s43
    s_waitcnt lgkmcnt(6)
    v_mfma_f32_32x32x16_bf16 v[176:191], a[140:143], v[124:127], v[176:191]
    s_add_u32 s80, s36, 16384
    buffer_load_dwordx4 a[68:71], v3, s[4:7], s80 offen offset:0
    v_fma_f32 v71, v71, v6, s43
    v_mul_f32 v64, v64, v128
    s_waitcnt lgkmcnt(5)
    v_mfma_f32_32x32x16_bf16 v[160:175], a[144:147], v[96:99], v[160:175]
    ds_read_b128 v[120:123], v4 offset:7168
    ds_read_b128 v[124:127], v17 offset:7168
    v_mul_f32 v65, v65, v129
    v_mul_f32 v66, v66, v130
    v_mul_f32 v67, v67, v131
    s_waitcnt lgkmcnt(6)
    v_mfma_f32_32x32x16_bf16 v[176:191], a[144:147], v[100:103], v[176:191]
    buffer_load_dwordx4 a[136:139], v19, s[76:79], s73 offen offset:0
    v_mul_f32 v68, v68, v132
    v_mul_f32 v69, v69, v133
    v_mul_f32 v70, v70, v134
    s_waitcnt lgkmcnt(5)
    v_mfma_f32_32x32x16_bf16 v[160:175], a[148:151], v[104:107], v[160:175]
    ds_read_b128 v[96:99], v4 offset:8192
    ds_read_b128 v[100:103], v17 offset:8192
    v_mul_f32 v71, v71, v135
    v_exp_f32 v64, v64
    s_waitcnt lgkmcnt(6)
    v_mfma_f32_32x32x16_bf16 v[176:191], a[148:151], v[108:111], v[176:191]
    buffer_load_dwordx4 a[72:75], v3, s[4:7], s80 offen offset:1024
    v_exp_f32 v65, v65
    v_exp_f32 v66, v66
    s_waitcnt lgkmcnt(5)
    v_mfma_f32_32x32x16_bf16 v[160:175], a[152:155], v[112:115], v[160:175]
    ds_read_b128 v[104:107], v4 offset:9216
    ds_read_b128 v[108:111], v17 offset:9216
    v_exp_f32 v67, v67
    s_waitcnt lgkmcnt(6)
    v_mfma_f32_32x32x16_bf16 v[176:191], a[152:155], v[116:119], v[176:191]
    buffer_load_dwordx4 a[140:143], v18, s[76:79], s73 offen offset:2048
    v_exp_f32 v68, v68
    s_waitcnt lgkmcnt(5)
    v_mfma_f32_32x32x16_bf16 v[160:175], a[156:159], v[120:123], v[160:175]
    ds_read_b128 v[112:115], v4 offset:10240
    ds_read_b128 v[116:119], v17 offset:10240
    v_exp_f32 v69, v69
    v_exp_f32 v70, v70
    s_waitcnt lgkmcnt(6)
    v_mfma_f32_32x32x16_bf16 v[176:191], a[156:159], v[124:127], v[176:191]
    buffer_load_dwordx4 a[76:79], v3, s[4:7], s80 offen offset:2048
    v_exp_f32 v71, v71
    s_waitcnt lgkmcnt(5)
    v_mfma_f32_32x32x16_bf16 v[160:175], a[160:163], v[96:99], v[160:175]
    ds_read_b128 v[120:123], v4 offset:11264
    ds_read_b128 v[124:127], v17 offset:11264
    v_mul_f32 v128, v128, v136
    v_mul_f32 v129, v129, v137
    v_mul_f32 v130, v130, v138
    s_waitcnt lgkmcnt(6)
    v_mfma_f32_32x32x16_bf16 v[176:191], a[160:163], v[100:103], v[176:191]
    buffer_load_dwordx4 a[144:147], v19, s[76:79], s73 offen offset:2048
    v_mul_f32 v131, v131, v139
    v_mul_f32 v132, v132, v140
    v_mul_f32 v133, v133, v141
    s_waitcnt lgkmcnt(5)
    v_mfma_f32_32x32x16_bf16 v[160:175], a[164:167], v[104:107], v[160:175]
    ds_read_b128 v[96:99], v4 offset:12288
    ds_read_b128 v[100:103], v17 offset:12288
    v_mul_f32 v134, v134, v142
    v_mul_f32 v135, v135, v143
    v_add_f32 v64, 1.0, v64
    s_waitcnt lgkmcnt(6)
    v_mfma_f32_32x32x16_bf16 v[176:191], a[164:167], v[108:111], v[176:191]
    buffer_load_dwordx4 a[80:83], v3, s[4:7], s80 offen offset:3072
    v_add_f32 v65, 1.0, v65
    v_add_f32 v66, 1.0, v66
    s_waitcnt lgkmcnt(5)
    v_mfma_f32_32x32x16_bf16 v[160:175], a[168:171], v[112:115], v[160:175]
    ds_read_b128 v[104:107], v4 offset:13312
    ds_read_b128 v[108:111], v17 offset:13312
    v_add_f32 v67, 1.0, v67
    v_add_f32 v68, 1.0, v68
    v_add_f32 v69, 1.0, v69
    s_waitcnt lgkmcnt(6)
    v_mfma_f32_32x32x16_bf16 v[176:191], a[168:171], v[116:119], v[176:191]
    s_add_u32 s73, s75, 4096
    buffer_load_dwordx4 a[148:151], v18, s[76:79], s73 offen offset:0
    v_add_f32 v70, 1.0, v70
    v_add_f32 v71, 1.0, v71
    v_rcp_f32 v64, v64
    s_waitcnt lgkmcnt(5)
    v_mfma_f32_32x32x16_bf16 v[160:175], a[172:175], v[120:123], v[160:175]
    ds_read_b128 v[112:115], v4 offset:14336
    ds_read_b128 v[116:119], v17 offset:14336
    v_rcp_f32 v65, v65
    s_waitcnt lgkmcnt(6)
    v_mfma_f32_32x32x16_bf16 v[176:191], a[172:175], v[124:127], v[176:191]
    s_add_u32 s80, s36, 20480
    buffer_load_dwordx4 a[84:87], v3, s[4:7], s80 offen offset:0
    v_rcp_f32 v66, v66
    v_rcp_f32 v67, v67
    s_waitcnt lgkmcnt(5)
    v_mfma_f32_32x32x16_bf16 v[160:175], a[176:179], v[96:99], v[160:175]
    ds_read_b128 v[120:123], v4 offset:15360
    ds_read_b128 v[124:127], v17 offset:15360
    v_rcp_f32 v68, v68
    s_waitcnt lgkmcnt(6)
    v_mfma_f32_32x32x16_bf16 v[176:191], a[176:179], v[100:103], v[176:191]
    buffer_load_dwordx4 a[152:155], v19, s[76:79], s73 offen offset:0
    v_rcp_f32 v69, v69
    s_waitcnt lgkmcnt(5)
    v_mfma_f32_32x32x16_bf16 v[160:175], a[180:183], v[104:107], v[160:175]
    ds_read_b128 v[96:99], v4 offset:16384
    ds_read_b128 v[100:103], v17 offset:16384
    v_rcp_f32 v70, v70
    v_rcp_f32 v71, v71
    s_waitcnt lgkmcnt(6)
    v_mfma_f32_32x32x16_bf16 v[176:191], a[180:183], v[108:111], v[176:191]
    buffer_load_dwordx4 a[88:91], v3, s[4:7], s80 offen offset:1024
    v_mul_f32 v128, v128, v64
    v_mul_f32 v129, v129, v65
    s_waitcnt lgkmcnt(5)
    v_mfma_f32_32x32x16_bf16 v[160:175], a[184:187], v[112:115], v[160:175]
    ds_read_b128 v[104:107], v4 offset:17408
    ds_read_b128 v[108:111], v17 offset:17408
    v_mul_f32 v130, v130, v66
    v_mul_f32 v131, v131, v67
    v_mul_f32 v132, v132, v68
    s_waitcnt lgkmcnt(6)
    v_mfma_f32_32x32x16_bf16 v[176:191], a[184:187], v[116:119], v[176:191]
    buffer_load_dwordx4 a[156:159], v18, s[76:79], s73 offen offset:2048
    v_mul_f32 v133, v133, v69
    v_mul_f32 v134, v134, v70
    v_mul_f32 v135, v135, v71
    s_waitcnt lgkmcnt(5)
    v_mfma_f32_32x32x16_bf16 v[160:175], a[188:191], v[120:123], v[160:175]
    ds_read_b128 v[112:115], v4 offset:18432
    ds_read_b128 v[116:119], v17 offset:18432
    v_cvt_pk_bf16_f32 v72, v128, v129
    v_cvt_pk_bf16_f32 v73, v130, v131
    v_cvt_pk_bf16_f32 v74, v132, v133
    s_waitcnt lgkmcnt(6)
    v_mfma_f32_32x32x16_bf16 v[176:191], a[188:191], v[124:127], v[176:191]
    buffer_load_dwordx4 a[92:95], v3, s[4:7], s80 offen offset:2048
    v_cvt_pk_bf16_f32 v75, v134, v135
    buffer_store_dwordx4 v[72:75], v4, s[12:15], s42 offen offset:0 sc1
    s_waitcnt vmcnt(46) lgkmcnt(5)
    v_mfma_f32_32x32x16_bf16 v[160:175], a[192:195], v[96:99], v[160:175]
    ds_read_b128 v[120:123], v4 offset:19456
    ds_read_b128 v[124:127], v17 offset:19456
    v_mul_f32 v80, v144, v144
    v_mul_f32 v81, v145, v145
    v_mul_f32 v82, v146, v146
    s_waitcnt lgkmcnt(6)
    v_mfma_f32_32x32x16_bf16 v[176:191], a[192:195], v[100:103], v[176:191]
    buffer_load_dwordx4 a[160:163], v19, s[76:79], s73 offen offset:2048
    v_mul_f32 v83, v147, v147
    v_mul_f32 v84, v148, v148
    v_mul_f32 v85, v149, v149
    s_waitcnt vmcnt(46) lgkmcnt(5)
    v_mfma_f32_32x32x16_bf16 v[160:175], a[196:199], v[104:107], v[160:175]
    ds_read_b128 v[96:99], v4 offset:20480
    ds_read_b128 v[100:103], v17 offset:20480
    v_mul_f32 v86, v150, v150
    v_mul_f32 v87, v151, v151
    v_fma_f32 v80, v80, v6, s43
    s_waitcnt lgkmcnt(6)
    v_mfma_f32_32x32x16_bf16 v[176:191], a[196:199], v[108:111], v[176:191]
    buffer_load_dwordx4 a[96:99], v3, s[4:7], s80 offen offset:3072
    v_fma_f32 v81, v81, v6, s43
    v_fma_f32 v82, v82, v6, s43
    v_fma_f32 v83, v83, v6, s43
    s_waitcnt vmcnt(46) lgkmcnt(5)
    v_mfma_f32_32x32x16_bf16 v[160:175], a[200:203], v[112:115], v[160:175]
    ds_read_b128 v[104:107], v4 offset:21504
    ds_read_b128 v[108:111], v17 offset:21504
    v_fma_f32 v84, v84, v6, s43
    v_fma_f32 v85, v85, v6, s43
    v_fma_f32 v86, v86, v6, s43
    s_waitcnt lgkmcnt(6)
    v_mfma_f32_32x32x16_bf16 v[176:191], a[200:203], v[116:119], v[176:191]
    s_add_u32 s73, s75, 8192
    buffer_load_dwordx4 a[164:167], v18, s[76:79], s73 offen offset:0
    v_fma_f32 v87, v87, v6, s43
    v_mul_f32 v80, v80, v144
    s_waitcnt vmcnt(46) lgkmcnt(5)
    v_mfma_f32_32x32x16_bf16 v[160:175], a[204:207], v[120:123], v[160:175]
    ds_read_b128 v[112:115], v4 offset:22528
    ds_read_b128 v[116:119], v17 offset:22528
    v_mul_f32 v81, v81, v145
    v_mul_f32 v82, v82, v146
    v_mul_f32 v83, v83, v147
    s_waitcnt lgkmcnt(6)
    v_mfma_f32_32x32x16_bf16 v[176:191], a[204:207], v[124:127], v[176:191]
    s_add_u32 s80, s36, 24576
    buffer_load_dwordx4 a[100:103], v3, s[4:7], s80 offen offset:0
    v_mul_f32 v84, v84, v148
    v_mul_f32 v85, v85, v149
    v_mul_f32 v86, v86, v150
    s_waitcnt vmcnt(46) lgkmcnt(5)
    v_mfma_f32_32x32x16_bf16 v[160:175], a[208:211], v[96:99], v[160:175]
    ds_read_b128 v[120:123], v4 offset:23552
    ds_read_b128 v[124:127], v17 offset:23552
    v_mul_f32 v87, v87, v151
    v_exp_f32 v80, v80
    s_waitcnt lgkmcnt(6)
    v_mfma_f32_32x32x16_bf16 v[176:191], a[208:211], v[100:103], v[176:191]
    buffer_load_dwordx4 a[168:171], v19, s[76:79], s73 offen offset:0
    v_exp_f32 v81, v81
    v_exp_f32 v82, v82
    s_waitcnt vmcnt(46) lgkmcnt(5)
    v_mfma_f32_32x32x16_bf16 v[160:175], a[212:215], v[104:107], v[160:175]
    ds_read_b128 v[96:99], v4 offset:24576
    ds_read_b128 v[100:103], v17 offset:24576
    v_exp_f32 v83, v83
    s_waitcnt lgkmcnt(6)
    v_mfma_f32_32x32x16_bf16 v[176:191], a[212:215], v[108:111], v[176:191]
    buffer_load_dwordx4 a[104:107], v3, s[4:7], s80 offen offset:1024
    v_exp_f32 v84, v84
    s_waitcnt vmcnt(46) lgkmcnt(5)
    v_mfma_f32_32x32x16_bf16 v[160:175], a[216:219], v[112:115], v[160:175]
    ds_read_b128 v[104:107], v4 offset:25600
    ds_read_b128 v[108:111], v17 offset:25600
    v_exp_f32 v85, v85
    v_exp_f32 v86, v86
    s_waitcnt lgkmcnt(6)
    v_mfma_f32_32x32x16_bf16 v[176:191], a[216:219], v[116:119], v[176:191]
    buffer_load_dwordx4 a[172:175], v18, s[76:79], s73 offen offset:2048
    v_exp_f32 v87, v87
    s_waitcnt vmcnt(46) lgkmcnt(5)
    v_mfma_f32_32x32x16_bf16 v[160:175], a[220:223], v[120:123], v[160:175]
    ds_read_b128 v[112:115], v4 offset:26624
    ds_read_b128 v[116:119], v17 offset:26624
    v_mul_f32 v144, v144, v152
    v_mul_f32 v145, v145, v153
    v_mul_f32 v146, v146, v154
    s_waitcnt lgkmcnt(6)
    v_mfma_f32_32x32x16_bf16 v[176:191], a[220:223], v[124:127], v[176:191]
    buffer_load_dwordx4 a[108:111], v3, s[4:7], s80 offen offset:2048
    v_mul_f32 v147, v147, v155
    v_mul_f32 v148, v148, v156
    v_mul_f32 v149, v149, v157
    s_waitcnt vmcnt(46) lgkmcnt(5)
    v_mfma_f32_32x32x16_bf16 v[160:175], a[224:227], v[96:99], v[160:175]
    ds_read_b128 v[120:123], v4 offset:27648
    ds_read_b128 v[124:127], v17 offset:27648
    v_mul_f32 v150, v150, v158
    v_mul_f32 v151, v151, v159
    v_add_f32 v80, 1.0, v80
    s_waitcnt lgkmcnt(6)
    v_mfma_f32_32x32x16_bf16 v[176:191], a[224:227], v[100:103], v[176:191]
    buffer_load_dwordx4 a[176:179], v19, s[76:79], s73 offen offset:2048
    v_add_f32 v81, 1.0, v81
    v_add_f32 v82, 1.0, v82
    s_waitcnt vmcnt(46) lgkmcnt(5)
    v_mfma_f32_32x32x16_bf16 v[160:175], a[228:231], v[104:107], v[160:175]
    ds_read_b128 v[96:99], v4 offset:28672
    ds_read_b128 v[100:103], v17 offset:28672
    v_add_f32 v83, 1.0, v83
    v_add_f32 v84, 1.0, v84
    v_add_f32 v85, 1.0, v85
    s_waitcnt lgkmcnt(6)
    v_mfma_f32_32x32x16_bf16 v[176:191], a[228:231], v[108:111], v[176:191]
    buffer_load_dwordx4 a[112:115], v3, s[4:7], s80 offen offset:3072
    v_add_f32 v86, 1.0, v86
    v_add_f32 v87, 1.0, v87
    v_rcp_f32 v80, v80
    s_waitcnt vmcnt(46) lgkmcnt(5)
    v_mfma_f32_32x32x16_bf16 v[160:175], a[232:235], v[112:115], v[160:175]
    ds_read_b128 v[104:107], v4 offset:29696
    ds_read_b128 v[108:111], v17 offset:29696
    v_rcp_f32 v81, v81
    s_waitcnt lgkmcnt(6)
    v_mfma_f32_32x32x16_bf16 v[176:191], a[232:235], v[116:119], v[176:191]
    s_add_u32 s73, s75, 12288
    buffer_load_dwordx4 a[180:183], v18, s[76:79], s73 offen offset:0
    v_rcp_f32 v82, v82
    v_rcp_f32 v83, v83
    s_waitcnt vmcnt(46) lgkmcnt(5)
    v_mfma_f32_32x32x16_bf16 v[160:175], a[236:239], v[120:123], v[160:175]
    ds_read_b128 v[112:115], v4 offset:30720
    ds_read_b128 v[116:119], v17 offset:30720
    v_rcp_f32 v84, v84
    s_waitcnt lgkmcnt(6)
    v_mfma_f32_32x32x16_bf16 v[176:191], a[236:239], v[124:127], v[176:191]
    s_add_u32 s80, s36, 28672
    buffer_load_dwordx4 a[116:119], v3, s[4:7], s80 offen offset:0
    v_rcp_f32 v85, v85
    s_waitcnt vmcnt(46) lgkmcnt(5)
    v_mfma_f32_32x32x16_bf16 v[160:175], a[240:243], v[96:99], v[160:175]
    ds_read_b128 v[120:123], v4 offset:31744
    ds_read_b128 v[124:127], v17 offset:31744
    v_rcp_f32 v86, v86
    v_rcp_f32 v87, v87
    s_waitcnt lgkmcnt(6)
    v_mfma_f32_32x32x16_bf16 v[176:191], a[240:243], v[100:103], v[176:191]
    buffer_load_dwordx4 a[184:187], v19, s[76:79], s73 offen offset:0
    v_mul_f32 v144, v144, v80
    v_mul_f32 v145, v145, v81
    s_waitcnt vmcnt(46) lgkmcnt(5)
    v_mfma_f32_32x32x16_bf16 v[160:175], a[244:247], v[104:107], v[160:175]
    ds_read_b128 v[96:99], v4 offset:0
    ds_read_b128 v[100:103], v17 offset:0
    v_mul_f32 v146, v146, v82
    v_mul_f32 v147, v147, v83
    v_mul_f32 v148, v148, v84
    s_waitcnt lgkmcnt(6)
    v_mfma_f32_32x32x16_bf16 v[176:191], a[244:247], v[108:111], v[176:191]
    buffer_load_dwordx4 a[120:123], v3, s[4:7], s80 offen offset:1024
    v_mul_f32 v149, v149, v85
    v_mul_f32 v150, v150, v86
    v_mul_f32 v151, v151, v87
    s_waitcnt vmcnt(46) lgkmcnt(5)
    v_mfma_f32_32x32x16_bf16 v[160:175], a[248:251], v[112:115], v[160:175]
    ds_read_b128 v[104:107], v4 offset:1024
    ds_read_b128 v[108:111], v17 offset:1024
    v_cvt_pk_bf16_f32 v88, v144, v145
    v_cvt_pk_bf16_f32 v89, v146, v147
    v_cvt_pk_bf16_f32 v90, v148, v149
    s_waitcnt lgkmcnt(6)
    v_mfma_f32_32x32x16_bf16 v[176:191], a[248:251], v[116:119], v[176:191]
    buffer_load_dwordx4 a[188:191], v18, s[76:79], s73 offen offset:2048
    v_cvt_pk_bf16_f32 v91, v150, v151
    buffer_store_dwordx4 v[88:91], v4, s[16:19], s42 offen offset:0 sc1
    s_waitcnt vmcnt(47) lgkmcnt(5)
    v_mfma_f32_32x32x16_bf16 v[160:175], a[0:3], v[120:123], v[160:175]
    ds_read_b128 v[112:115], v4 offset:2048
    ds_read_b128 v[116:119], v17 offset:2048
    s_waitcnt lgkmcnt(6)
    v_mfma_f32_32x32x16_bf16 v[176:191], a[0:3], v[124:127], v[176:191]
    buffer_load_dwordx4 a[124:127], v3, s[4:7], s80 offen offset:2048
    s_waitcnt vmcnt(47) lgkmcnt(5)
    v_mfma_f32_32x32x16_bf16 v[192:207], a[4:7], v[96:99], 0
    ds_read_b128 v[120:123], v4 offset:3072
    ds_read_b128 v[124:127], v17 offset:3072
    s_waitcnt lgkmcnt(6)
    v_mfma_f32_32x32x16_bf16 v[208:223], a[4:7], v[100:103], 0
    buffer_load_dwordx4 a[192:195], v19, s[76:79], s73 offen offset:2048
    s_waitcnt vmcnt(47) lgkmcnt(5)
    v_mfma_f32_32x32x16_bf16 v[192:207], a[8:11], v[104:107], v[192:207]
    ds_read_b128 v[96:99], v4 offset:4096
    ds_read_b128 v[100:103], v17 offset:4096
    v_mul_f32 v64, v160, v160
    v_mul_f32 v65, v161, v161
    v_mul_f32 v66, v162, v162
    s_waitcnt lgkmcnt(6)
    v_mfma_f32_32x32x16_bf16 v[208:223], a[8:11], v[108:111], v[208:223]
    buffer_load_dwordx4 a[128:131], v3, s[4:7], s80 offen offset:3072
    v_mul_f32 v67, v163, v163
    v_mul_f32 v68, v164, v164
    v_mul_f32 v69, v165, v165
    s_waitcnt vmcnt(47) lgkmcnt(5)
    v_mfma_f32_32x32x16_bf16 v[192:207], a[12:15], v[112:115], v[192:207]
    ds_read_b128 v[104:107], v4 offset:5120
    ds_read_b128 v[108:111], v17 offset:5120
    v_mul_f32 v70, v166, v166
    v_mul_f32 v71, v167, v167
    v_fma_f32 v64, v64, v6, s43
    s_waitcnt lgkmcnt(6)
    v_mfma_f32_32x32x16_bf16 v[208:223], a[12:15], v[116:119], v[208:223]
    s_add_u32 s73, s75, 16384
    buffer_load_dwordx4 a[196:199], v18, s[76:79], s73 offen offset:0
    v_fma_f32 v65, v65, v6, s43
    v_fma_f32 v66, v66, v6, s43
    v_fma_f32 v67, v67, v6, s43
    s_waitcnt vmcnt(47) lgkmcnt(5)
    v_mfma_f32_32x32x16_bf16 v[192:207], a[16:19], v[120:123], v[192:207]
    ds_read_b128 v[112:115], v4 offset:6144
    ds_read_b128 v[116:119], v17 offset:6144
    v_fma_f32 v68, v68, v6, s43
    v_fma_f32 v69, v69, v6, s43
    v_fma_f32 v70, v70, v6, s43
    s_waitcnt lgkmcnt(6)
    v_mfma_f32_32x32x16_bf16 v[208:223], a[16:19], v[124:127], v[208:223]
    s_add_u32 s74, s75, 28672
    buffer_load_dwordx4 a[0:3], v18, s[76:79], s74 offen offset:2048
    v_fma_f32 v71, v71, v6, s43
    v_mul_f32 v64, v64, v160
    s_waitcnt vmcnt(47) lgkmcnt(5)
    v_mfma_f32_32x32x16_bf16 v[192:207], a[20:23], v[96:99], v[192:207]
    ds_read_b128 v[120:123], v4 offset:7168
    ds_read_b128 v[124:127], v17 offset:7168
    v_mul_f32 v65, v65, v161
    v_mul_f32 v66, v66, v162
    v_mul_f32 v67, v67, v163
    s_waitcnt lgkmcnt(6)
    v_mfma_f32_32x32x16_bf16 v[208:223], a[20:23], v[100:103], v[208:223]
    buffer_load_dwordx4 a[200:203], v19, s[76:79], s73 offen offset:0
    v_mul_f32 v68, v68, v164
    v_mul_f32 v69, v69, v165
    v_mul_f32 v70, v70, v166
    s_waitcnt vmcnt(47) lgkmcnt(5)
    v_mfma_f32_32x32x16_bf16 v[192:207], a[24:27], v[104:107], v[192:207]
    ds_read_b128 v[96:99], v4 offset:8192
    ds_read_b128 v[100:103], v17 offset:8192
    v_mul_f32 v71, v71, v167
    v_exp_f32 v64, v64
    s_waitcnt lgkmcnt(6)
    v_mfma_f32_32x32x16_bf16 v[208:223], a[24:27], v[108:111], v[208:223]
    buffer_load_dwordx4 a[4:7], v19, s[76:79], s74 offen offset:2048
    v_exp_f32 v65, v65
    v_exp_f32 v66, v66
    s_waitcnt vmcnt(47) lgkmcnt(5)
    v_mfma_f32_32x32x16_bf16 v[192:207], a[28:31], v[112:115], v[192:207]
    ds_read_b128 v[104:107], v4 offset:9216
    ds_read_b128 v[108:111], v17 offset:9216
    v_exp_f32 v67, v67
    s_waitcnt lgkmcnt(6)
    v_mfma_f32_32x32x16_bf16 v[208:223], a[28:31], v[116:119], v[208:223]
    buffer_load_dwordx4 a[204:207], v18, s[76:79], s73 offen offset:2048
    v_exp_f32 v68, v68
    s_waitcnt vmcnt(47) lgkmcnt(5)
    v_mfma_f32_32x32x16_bf16 v[192:207], a[32:35], v[120:123], v[192:207]
    ds_read_b128 v[112:115], v4 offset:10240
    ds_read_b128 v[116:119], v17 offset:10240
    v_exp_f32 v69, v69
    v_exp_f32 v70, v70
    s_waitcnt lgkmcnt(6)
    v_mfma_f32_32x32x16_bf16 v[208:223], a[32:35], v[124:127], v[208:223]
    s_add_u32 s74, s75, 32768
    buffer_load_dwordx4 a[8:11], v18, s[76:79], s74 offen offset:0
    v_exp_f32 v71, v71
    s_waitcnt vmcnt(47) lgkmcnt(5)
    v_mfma_f32_32x32x16_bf16 v[192:207], a[36:39], v[96:99], v[192:207]
    ds_read_b128 v[120:123], v4 offset:11264
    ds_read_b128 v[124:127], v17 offset:11264
    v_mul_f32 v160, v160, v168
    v_mul_f32 v161, v161, v169
    v_mul_f32 v162, v162, v170
    s_waitcnt lgkmcnt(6)
    v_mfma_f32_32x32x16_bf16 v[208:223], a[36:39], v[100:103], v[208:223]
    buffer_load_dwordx4 a[208:211], v19, s[76:79], s73 offen offset:2048
    v_mul_f32 v163, v163, v171
    v_mul_f32 v164, v164, v172
    v_mul_f32 v165, v165, v173
    s_waitcnt vmcnt(47) lgkmcnt(5)
    v_mfma_f32_32x32x16_bf16 v[192:207], a[40:43], v[104:107], v[192:207]
    ds_read_b128 v[96:99], v4 offset:12288
    ds_read_b128 v[100:103], v17 offset:12288
    v_mul_f32 v166, v166, v174
    v_mul_f32 v167, v167, v175
    v_add_f32 v64, 1.0, v64
    s_waitcnt lgkmcnt(6)
    v_mfma_f32_32x32x16_bf16 v[208:223], a[40:43], v[108:111], v[208:223]
    buffer_load_dwordx4 a[12:15], v19, s[76:79], s74 offen offset:0
    v_add_f32 v65, 1.0, v65
    v_add_f32 v66, 1.0, v66
    s_waitcnt vmcnt(47) lgkmcnt(5)
    v_mfma_f32_32x32x16_bf16 v[192:207], a[44:47], v[112:115], v[192:207]
    ds_read_b128 v[104:107], v4 offset:13312
    ds_read_b128 v[108:111], v17 offset:13312
    v_add_f32 v67, 1.0, v67
    v_add_f32 v68, 1.0, v68
    v_add_f32 v69, 1.0, v69
    s_waitcnt lgkmcnt(6)
    v_mfma_f32_32x32x16_bf16 v[208:223], a[44:47], v[116:119], v[208:223]
    s_add_u32 s73, s75, 20480
    buffer_load_dwordx4 a[212:215], v18, s[76:79], s73 offen offset:0
    v_add_f32 v70, 1.0, v70
    v_add_f32 v71, 1.0, v71
    v_rcp_f32 v64, v64
    s_waitcnt vmcnt(47) lgkmcnt(5)
    v_mfma_f32_32x32x16_bf16 v[192:207], a[48:51], v[120:123], v[192:207]
    ds_read_b128 v[112:115], v4 offset:14336
    ds_read_b128 v[116:119], v17 offset:14336
    v_rcp_f32 v65, v65
    s_waitcnt lgkmcnt(6)
    v_mfma_f32_32x32x16_bf16 v[208:223], a[48:51], v[124:127], v[208:223]
    buffer_load_dwordx4 a[16:19], v18, s[76:79], s74 offen offset:2048
    v_rcp_f32 v66, v66
    v_rcp_f32 v67, v67
    s_waitcnt vmcnt(47) lgkmcnt(5)
    v_mfma_f32_32x32x16_bf16 v[192:207], a[52:55], v[96:99], v[192:207]
    ds_read_b128 v[120:123], v4 offset:15360
    ds_read_b128 v[124:127], v17 offset:15360
    v_rcp_f32 v68, v68
    s_waitcnt lgkmcnt(6)
    v_mfma_f32_32x32x16_bf16 v[208:223], a[52:55], v[100:103], v[208:223]
    buffer_load_dwordx4 a[216:219], v19, s[76:79], s73 offen offset:0
    v_rcp_f32 v69, v69
    s_waitcnt vmcnt(47) lgkmcnt(5)
    v_mfma_f32_32x32x16_bf16 v[192:207], a[56:59], v[104:107], v[192:207]
    ds_read_b128 v[96:99], v4 offset:16384
    ds_read_b128 v[100:103], v17 offset:16384
    v_rcp_f32 v70, v70
    v_rcp_f32 v71, v71
    s_waitcnt lgkmcnt(6)
    v_mfma_f32_32x32x16_bf16 v[208:223], a[56:59], v[108:111], v[208:223]
    buffer_load_dwordx4 a[20:23], v19, s[76:79], s74 offen offset:2048
    v_mul_f32 v160, v160, v64
    v_mul_f32 v161, v161, v65
    s_waitcnt vmcnt(47) lgkmcnt(5)
    v_mfma_f32_32x32x16_bf16 v[192:207], a[60:63], v[112:115], v[192:207]
    ds_read_b128 v[104:107], v4 offset:17408
    ds_read_b128 v[108:111], v17 offset:17408
    v_mul_f32 v162, v162, v66
    v_mul_f32 v163, v163, v67
    v_mul_f32 v164, v164, v68
    s_waitcnt lgkmcnt(6)
    v_mfma_f32_32x32x16_bf16 v[208:223], a[60:63], v[116:119], v[208:223]
    buffer_load_dwordx4 a[220:223], v18, s[76:79], s73 offen offset:2048
    v_mul_f32 v165, v165, v69
    v_mul_f32 v166, v166, v70
    v_mul_f32 v167, v167, v71
    s_waitcnt vmcnt(47) lgkmcnt(5)
    v_mfma_f32_32x32x16_bf16 v[192:207], a[64:67], v[120:123], v[192:207]
    ds_read_b128 v[112:115], v4 offset:18432
    ds_read_b128 v[116:119], v17 offset:18432
    v_cvt_pk_bf16_f32 v72, v160, v161
    v_cvt_pk_bf16_f32 v73, v162, v163
    v_cvt_pk_bf16_f32 v74, v164, v165
    s_waitcnt lgkmcnt(6)
    v_mfma_f32_32x32x16_bf16 v[208:223], a[64:67], v[124:127], v[208:223]
    s_add_u32 s74, s75, 36864
    buffer_load_dwordx4 a[24:27], v18, s[76:79], s74 offen offset:0
    v_cvt_pk_bf16_f32 v75, v166, v167
    buffer_store_dwordx4 v[72:75], v4, s[12:15], s42 offen offset:1024 sc1
    s_waitcnt vmcnt(47) lgkmcnt(5)
    v_mfma_f32_32x32x16_bf16 v[192:207], a[68:71], v[96:99], v[192:207]
    ds_read_b128 v[120:123], v4 offset:19456
    ds_read_b128 v[124:127], v17 offset:19456
    v_mul_f32 v80, v176, v176
    v_mul_f32 v81, v177, v177
    v_mul_f32 v82, v178, v178
    s_waitcnt lgkmcnt(6)
    v_mfma_f32_32x32x16_bf16 v[208:223], a[68:71], v[100:103], v[208:223]
    buffer_load_dwordx4 a[224:227], v19, s[76:79], s73 offen offset:2048
    v_mul_f32 v83, v179, v179
    v_mul_f32 v84, v180, v180
    v_mul_f32 v85, v181, v181
    s_waitcnt vmcnt(46) lgkmcnt(5)
    v_mfma_f32_32x32x16_bf16 v[192:207], a[72:75], v[104:107], v[192:207]
    ds_read_b128 v[96:99], v4 offset:20480
    ds_read_b128 v[100:103], v17 offset:20480
    v_mul_f32 v86, v182, v182
    v_mul_f32 v87, v183, v183
    v_fma_f32 v80, v80, v6, s43
    s_waitcnt lgkmcnt(6)
    v_mfma_f32_32x32x16_bf16 v[208:223], a[72:75], v[108:111], v[208:223]
    buffer_load_dwordx4 a[28:31], v19, s[76:79], s74 offen offset:0
    v_fma_f32 v81, v81, v6, s43
    v_fma_f32 v82, v82, v6, s43
    v_fma_f32 v83, v83, v6, s43
    s_waitcnt vmcnt(45) lgkmcnt(5)
    v_mfma_f32_32x32x16_bf16 v[192:207], a[76:79], v[112:115], v[192:207]
    ds_read_b128 v[104:107], v4 offset:21504
    ds_read_b128 v[108:111], v17 offset:21504
    v_fma_f32 v84, v84, v6, s43
    v_fma_f32 v85, v85, v6, s43
    v_fma_f32 v86, v86, v6, s43
    s_waitcnt lgkmcnt(6)
    v_mfma_f32_32x32x16_bf16 v[208:223], a[76:79], v[116:119], v[208:223]
    s_add_u32 s73, s75, 24576
    buffer_load_dwordx4 a[228:231], v18, s[76:79], s73 offen offset:0
    v_fma_f32 v87, v87, v6, s43
    v_mul_f32 v80, v80, v176
    s_waitcnt vmcnt(44) lgkmcnt(5)
    v_mfma_f32_32x32x16_bf16 v[192:207], a[80:83], v[120:123], v[192:207]
    ds_read_b128 v[112:115], v4 offset:22528
    ds_read_b128 v[116:119], v17 offset:22528
    v_mul_f32 v81, v81, v177
    v_mul_f32 v82, v82, v178
    v_mul_f32 v83, v83, v179
    s_waitcnt lgkmcnt(6)
    v_mfma_f32_32x32x16_bf16 v[208:223], a[80:83], v[124:127], v[208:223]
    buffer_load_dwordx4 a[32:35], v18, s[76:79], s74 offen offset:2048
    v_mul_f32 v84, v84, v180
    v_mul_f32 v85, v85, v181
    v_mul_f32 v86, v86, v182
    s_waitcnt vmcnt(43) lgkmcnt(5)
    v_mfma_f32_32x32x16_bf16 v[192:207], a[84:87], v[96:99], v[192:207]
    ds_read_b128 v[120:123], v4 offset:23552
    ds_read_b128 v[124:127], v17 offset:23552
    v_mul_f32 v87, v87, v183
    v_exp_f32 v80, v80
    s_waitcnt lgkmcnt(6)
    v_mfma_f32_32x32x16_bf16 v[208:223], a[84:87], v[100:103], v[208:223]
    buffer_load_dwordx4 a[232:235], v19, s[76:79], s73 offen offset:0
    v_exp_f32 v81, v81
    v_exp_f32 v82, v82
    s_waitcnt vmcnt(42) lgkmcnt(5)
    v_mfma_f32_32x32x16_bf16 v[192:207], a[88:91], v[104:107], v[192:207]
    ds_read_b128 v[96:99], v4 offset:24576
    ds_read_b128 v[100:103], v17 offset:24576
    v_exp_f32 v83, v83
    s_waitcnt lgkmcnt(6)
    v_mfma_f32_32x32x16_bf16 v[208:223], a[88:91], v[108:111], v[208:223]
    buffer_load_dwordx4 a[36:39], v19, s[76:79], s74 offen offset:2048
    v_exp_f32 v84, v84
    s_waitcnt vmcnt(41) lgkmcnt(5)
    v_mfma_f32_32x32x16_bf16 v[192:207], a[92:95], v[112:115], v[192:207]
    ds_read_b128 v[104:107], v4 offset:25600
    ds_read_b128 v[108:111], v17 offset:25600
    v_exp_f32 v85, v85
    v_exp_f32 v86, v86
    s_waitcnt lgkmcnt(6)
    v_mfma_f32_32x32x16_bf16 v[208:223], a[92:95], v[116:119], v[208:223]
    buffer_load_dwordx4 a[236:239], v18, s[76:79], s73 offen offset:2048
    v_exp_f32 v87, v87
    s_waitcnt vmcnt(39) lgkmcnt(5)
    v_mfma_f32_32x32x16_bf16 v[192:207], a[96:99], v[120:123], v[192:207]
    ds_read_b128 v[112:115], v4 offset:26624
    ds_read_b128 v[116:119], v17 offset:26624
    v_mul_f32 v176, v176, v184
    v_mul_f32 v177, v177, v185
    v_mul_f32 v178, v178, v186
    s_waitcnt lgkmcnt(6)
    v_mfma_f32_32x32x16_bf16 v[208:223], a[96:99], v[124:127], v[208:223]
    s_add_u32 s74, s75, 40960
    buffer_load_dwordx4 a[40:43], v18, s[76:79], s74 offen offset:0
    v_mul_f32 v179, v179, v187
    v_mul_f32 v180, v180, v188
    v_mul_f32 v181, v181, v189
    s_waitcnt vmcnt(38) lgkmcnt(5)
    v_mfma_f32_32x32x16_bf16 v[192:207], a[100:103], v[96:99], v[192:207]
    ds_read_b128 v[120:123], v4 offset:27648
    ds_read_b128 v[124:127], v17 offset:27648
    v_mul_f32 v182, v182, v190
    v_mul_f32 v183, v183, v191
    v_add_f32 v80, 1.0, v80
    s_waitcnt lgkmcnt(6)
    v_mfma_f32_32x32x16_bf16 v[208:223], a[100:103], v[100:103], v[208:223]
    buffer_load_dwordx4 a[240:243], v19, s[76:79], s73 offen offset:2048
    v_add_f32 v81, 1.0, v81
    v_add_f32 v82, 1.0, v82
    s_waitcnt vmcnt(37) lgkmcnt(5)
    v_mfma_f32_32x32x16_bf16 v[192:207], a[104:107], v[104:107], v[192:207]
    ds_read_b128 v[96:99], v4 offset:28672
    ds_read_b128 v[100:103], v17 offset:28672
    v_add_f32 v83, 1.0, v83
    v_add_f32 v84, 1.0, v84
    v_add_f32 v85, 1.0, v85
    s_waitcnt lgkmcnt(6)
    v_mfma_f32_32x32x16_bf16 v[208:223], a[104:107], v[108:111], v[208:223]
    buffer_load_dwordx4 a[44:47], v19, s[76:79], s74 offen offset:0
    v_add_f32 v86, 1.0, v86
    v_add_f32 v87, 1.0, v87
    v_rcp_f32 v80, v80
    s_waitcnt vmcnt(36) lgkmcnt(5)
    v_mfma_f32_32x32x16_bf16 v[192:207], a[108:111], v[112:115], v[192:207]
    ds_read_b128 v[104:107], v4 offset:29696
    ds_read_b128 v[108:111], v17 offset:29696
    v_rcp_f32 v81, v81
    s_waitcnt lgkmcnt(6)
    v_mfma_f32_32x32x16_bf16 v[208:223], a[108:111], v[116:119], v[208:223]
    s_add_u32 s73, s75, 28672
    buffer_load_dwordx4 a[244:247], v18, s[76:79], s73 offen offset:0
    v_rcp_f32 v82, v82
    v_rcp_f32 v83, v83
    s_waitcnt vmcnt(35) lgkmcnt(5)
    v_mfma_f32_32x32x16_bf16 v[192:207], a[112:115], v[120:123], v[192:207]
    ds_read_b128 v[112:115], v4 offset:30720
    ds_read_b128 v[116:119], v17 offset:30720
    v_rcp_f32 v84, v84
    s_waitcnt lgkmcnt(6)
    v_mfma_f32_32x32x16_bf16 v[208:223], a[112:115], v[124:127], v[208:223]
    buffer_load_dwordx4 a[48:51], v18, s[76:79], s74 offen offset:2048
    v_rcp_f32 v85, v85
    s_waitcnt vmcnt(34) lgkmcnt(5)
    v_mfma_f32_32x32x16_bf16 v[192:207], a[116:119], v[96:99], v[192:207]
    ds_read_b128 v[120:123], v4 offset:31744
    ds_read_b128 v[124:127], v17 offset:31744
    v_rcp_f32 v86, v86
    v_rcp_f32 v87, v87
    s_waitcnt lgkmcnt(6)
    v_mfma_f32_32x32x16_bf16 v[208:223], a[116:119], v[100:103], v[208:223]
    buffer_load_dwordx4 a[248:251], v19, s[76:79], s73 offen offset:0
    v_mul_f32 v176, v176, v80
    v_mul_f32 v177, v177, v81
    s_waitcnt vmcnt(33) lgkmcnt(5)
    v_mfma_f32_32x32x16_bf16 v[192:207], a[120:123], v[104:107], v[192:207]
    v_mul_f32 v178, v178, v82
    v_mul_f32 v179, v179, v83
    v_mul_f32 v180, v180, v84
    s_waitcnt lgkmcnt(4)
    v_mfma_f32_32x32x16_bf16 v[208:223], a[120:123], v[108:111], v[208:223]
    buffer_load_dwordx4 a[52:55], v19, s[76:79], s74 offen offset:2048
    v_mul_f32 v181, v181, v85
    v_mul_f32 v182, v182, v86
    v_mul_f32 v183, v183, v87
    s_waitcnt vmcnt(31) lgkmcnt(3)
    v_mfma_f32_32x32x16_bf16 v[192:207], a[124:127], v[112:115], v[192:207]
    v_cvt_pk_bf16_f32 v88, v176, v177
    v_cvt_pk_bf16_f32 v89, v178, v179
    v_cvt_pk_bf16_f32 v90, v180, v181
    s_waitcnt lgkmcnt(2)
    v_mfma_f32_32x32x16_bf16 v[208:223], a[124:127], v[116:119], v[208:223]
    v_cvt_pk_bf16_f32 v91, v182, v183
    buffer_store_dwordx4 v[88:91], v4, s[16:19], s42 offen offset:1024 sc1
    s_waitcnt vmcnt(30) lgkmcnt(1)
    v_mfma_f32_32x32x16_bf16 v[192:207], a[128:131], v[120:123], v[192:207]
    s_waitcnt lgkmcnt(0)
    v_mfma_f32_32x32x16_bf16 v[208:223], a[128:131], v[124:127], v[208:223]
    buffer_load_dwordx4 v[8:11], v4, s[28:31], s39 offen offset:0 sc1
    s_nop 8
    v_pk_mul_f32 v[64:65], v[192:193], v[192:193]
    v_pk_mul_f32 v[66:67], v[194:195], v[194:195]
    v_pk_mul_f32 v[68:69], v[196:197], v[196:197]
    v_pk_mul_f32 v[70:71], v[198:199], v[198:199]
    v_pk_fma_f32 v[64:65], v[64:65], v[6:7], s[42:43] op_sel:[0,0,1] op_sel_hi:[1,0,1]
    v_pk_fma_f32 v[66:67], v[66:67], v[6:7], s[42:43] op_sel:[0,0,1] op_sel_hi:[1,0,1]
    v_pk_fma_f32 v[68:69], v[68:69], v[6:7], s[42:43] op_sel:[0,0,1] op_sel_hi:[1,0,1]
    v_pk_fma_f32 v[70:71], v[70:71], v[6:7], s[42:43] op_sel:[0,0,1] op_sel_hi:[1,0,1]
    v_pk_mul_f32 v[64:65], v[64:65], v[192:193]
    v_pk_mul_f32 v[66:67], v[66:67], v[194:195]
    v_pk_mul_f32 v[68:69], v[68:69], v[196:197]
    v_pk_mul_f32 v[70:71], v[70:71], v[198:199]
    buffer_load_dwordx4 v[12:15], v4, s[28:31], s39 offen offset:1024 sc1
    v_exp_f32 v64, v64
    v_exp_f32 v65, v65
    v_exp_f32 v66, v66
    v_exp_f32 v67, v67
    v_exp_f32 v68, v68
    v_exp_f32 v69, v69
    v_exp_f32 v70, v70
    v_exp_f32 v71, v71
    v_pk_mul_f32 v[192:193], v[192:193], v[200:201]
    v_pk_mul_f32 v[194:195], v[194:195], v[202:203]
    v_pk_mul_f32 v[196:197], v[196:197], v[204:205]
    v_pk_mul_f32 v[198:199], v[198:199], v[206:207]
    buffer_load_dwordx4 v[16:19], v5, s[20:23], s71 offen offset:0
    v_pk_add_f32 v[64:65], v[64:65], 1.0 op_sel_hi:[1,0]
    v_pk_add_f32 v[66:67], v[66:67], 1.0 op_sel_hi:[1,0]
    v_pk_add_f32 v[68:69], v[68:69], 1.0 op_sel_hi:[1,0]
    v_pk_add_f32 v[70:71], v[70:71], 1.0 op_sel_hi:[1,0]
    v_rcp_f32 v64, v64
    v_rcp_f32 v65, v65
    v_rcp_f32 v66, v66
    v_rcp_f32 v67, v67
    v_rcp_f32 v68, v68
    v_rcp_f32 v69, v69
    v_rcp_f32 v70, v70
    v_rcp_f32 v71, v71
    buffer_load_dwordx4 v[20:23], v5, s[20:23], s71 offen offset:16
    v_pk_mul_f32 v[192:193], v[192:193], v[64:65]
    v_pk_mul_f32 v[194:195], v[194:195], v[66:67]
    v_pk_mul_f32 v[196:197], v[196:197], v[68:69]
    v_pk_mul_f32 v[198:199], v[198:199], v[70:71]
    v_cvt_pk_bf16_f32 v72, v192, v193
    v_cvt_pk_bf16_f32 v73, v194, v195
    v_cvt_pk_bf16_f32 v74, v196, v197
    v_cvt_pk_bf16_f32 v75, v198, v199
    buffer_store_dwordx4 v[72:75], v4, s[12:15], s42 offen offset:2048 sc1
    v_pk_mul_f32 v[80:81], v[208:209], v[208:209]
    v_pk_mul_f32 v[82:83], v[210:211], v[210:211]
    v_pk_mul_f32 v[84:85], v[212:213], v[212:213]
    buffer_load_dwordx4 v[24:27], v5, s[20:23], s71 offen offset:64
    v_pk_mul_f32 v[86:87], v[214:215], v[214:215]
    v_pk_fma_f32 v[80:81], v[80:81], v[6:7], s[42:43] op_sel:[0,0,1] op_sel_hi:[1,0,1]
    v_pk_fma_f32 v[82:83], v[82:83], v[6:7], s[42:43] op_sel:[0,0,1] op_sel_hi:[1,0,1]
    v_pk_fma_f32 v[84:85], v[84:85], v[6:7], s[42:43] op_sel:[0,0,1] op_sel_hi:[1,0,1]
    v_pk_fma_f32 v[86:87], v[86:87], v[6:7], s[42:43] op_sel:[0,0,1] op_sel_hi:[1,0,1]
    v_pk_mul_f32 v[80:81], v[80:81], v[208:209]
    v_pk_mul_f32 v[82:83], v[82:83], v[210:211]
    v_pk_mul_f32 v[84:85], v[84:85], v[212:213]
    v_pk_mul_f32 v[86:87], v[86:87], v[214:215]
    v_exp_f32 v80, v80
    v_exp_f32 v81, v81
    v_exp_f32 v82, v82
    buffer_load_dwordx4 v[28:31], v5, s[20:23], s71 offen offset:80
    v_exp_f32 v83, v83
    v_exp_f32 v84, v84
    v_exp_f32 v85, v85
    v_exp_f32 v86, v86
    v_exp_f32 v87, v87
    v_pk_mul_f32 v[208:209], v[208:209], v[216:217]
    v_pk_mul_f32 v[210:211], v[210:211], v[218:219]
    v_pk_mul_f32 v[212:213], v[212:213], v[220:221]
    v_pk_mul_f32 v[214:215], v[214:215], v[222:223]
    v_pk_add_f32 v[80:81], v[80:81], 1.0 op_sel_hi:[1,0]
    v_pk_add_f32 v[82:83], v[82:83], 1.0 op_sel_hi:[1,0]
    v_pk_add_f32 v[84:85], v[84:85], 1.0 op_sel_hi:[1,0]
    v_pk_add_f32 v[86:87], v[86:87], 1.0 op_sel_hi:[1,0]
    v_rcp_f32 v80, v80
    v_rcp_f32 v81, v81
    v_rcp_f32 v82, v82
    v_rcp_f32 v83, v83
    v_rcp_f32 v84, v84
    v_rcp_f32 v85, v85
    v_rcp_f32 v86, v86
    v_rcp_f32 v87, v87
    v_pk_mul_f32 v[208:209], v[208:209], v[80:81]
    v_pk_mul_f32 v[210:211], v[210:211], v[82:83]
    v_pk_mul_f32 v[212:213], v[212:213], v[84:85]
    v_pk_mul_f32 v[214:215], v[214:215], v[86:87]
    v_cvt_pk_bf16_f32 v88, v208, v209
    v_cvt_pk_bf16_f32 v89, v210, v211
    v_cvt_pk_bf16_f32 v90, v212, v213
    v_cvt_pk_bf16_f32 v91, v214, v215
    buffer_store_dwordx4 v[88:91], v4, s[16:19], s42 offen offset:2048 sc1
L_k6_noep:
    s_waitcnt vmcnt(0)
    s_barrier
    s_cmp_lg_u32 s32, 0
    s_cbranch_scc1 L_ts1_pub
    v_lshlrev_b32 v251, 10, v1
    v_mov_b32 v252, s64
    v_mov_b32 v253, s65
    s_add_u32 s68, s66, 32768
    s_mov_b64 exec, 0xff
    buffer_store_dwordx2 v[252:253], v251, s[60:63], s68 offen sc1
    s_mov_b64 exec, -1
L_ts1_pub:
    s_mul_i32 s40, s33, 176128
    s_add_u32 s40, s40, 0x1a00000
    s_add_u32 s41, s40, 88064
    s_bitcmp1_b32 s32, 0
    s_cselect_b32 s47, s41, s40
    s_cselect_b32 s41, s40, s41
    s_mov_b32 s40, s47
    s_add_u32 s8, s50, s40
    s_addc_u32 s9, s51, 0
    s_mov_b32 s10, 0x15800
    s_mov_b32 s11, 0x00020000
    s_add_u32 s12, s50, s41
    s_addc_u32 s13, s51, 0
    s_mov_b32 s14, 0x15800
    s_mov_b32 s15, 0x00020000
    s_mov_b32 s24, s54
    s_mov_b32 s25, s55
    s_mov_b32 s26, 0x200000
    s_mov_b32 s27, 0x00020000
    s_mul_i32 s37, s32, 22528
    v_mov_b32 v64, 0
    v_mov_b32 v65, 0
    v_mov_b32 v66, 0
    v_mov_b32 v67, 0
    v_mov_b32 v68, 0
    v_mov_b32 v69, 0
    v_mov_b32 v70, 0
    v_mov_b32 v71, 0
    v_mov_b32 v72, 0
    v_mov_b32 v73, 0
    v_mov_b32 v74, 0
    v_mov_b32 v75, 0
    v_mov_b32 v76, 0
    v_mov_b32 v77, 0
    v_mov_b32 v78, 0
    v_mov_b32 v79, 0
    v_mov_b32 v80, 0
    v_mov_b32 v81, 0
    v_mov_b32 v82, 0
    v_mov_b32 v83, 0
    v_mov_b32 v84, 0
    v_mov_b32 v85, 0
    v_mov_b32 v86, 0
    v_mov_b32 v87, 0
    v_mov_b32 v88, 0
    v_mov_b32 v89, 0
    v_mov_b32 v90, 0
    v_mov_b32 v91, 0
    v_mov_b32 v92, 0
    v_mov_b32 v93, 0
    v_mov_b32 v94, 0
    v_mov_b32 v95, 0
    v_mov_b32 v96, 0
    v_mov_b32 v97, 0
    v_mov_b32 v98, 0
    v_mov_b32 v99, 0
    v_mov_b32 v100, 0
    v_mov_b32 v101, 0
    v_mov_b32 v102, 0
    v_mov_b32 v103, 0
    v_mov_b32 v104, 0
    v_mov_b32 v105, 0
    v_mov_b32 v106, 0
    v_mov_b32 v107, 0
    v_mov_b32 v108, 0
    v_mov_b32 v109, 0
    v_mov_b32 v110, 0
    v_mov_b32 v111, 0
    v_mov_b32 v112, 0
    v_mov_b32 v113, 0
    v_mov_b32 v114, 0
    v_mov_b32 v115, 0
    v_mov_b32 v116, 0
    v_mov_b32 v117, 0
    v_mov_b32 v118, 0
    v_mov_b32 v119, 0
    v_mov_b32 v120, 0
    v_mov_b32 v121, 0
    v_mov_b32 v122, 0
    v_mov_b32 v123, 0
    v_mov_b32 v124, 0
    v_mov_b32 v125, 0
    v_mov_b32 v126, 0
    v_mov_b32 v127, 0
    s_cmp_lg_u32 s32, 0
    s_cbranch_scc1 L_ts1_seen
    v_lshlrev_b32 v251, 3, v1
    s_add_u32 s68, s67, 32768
    s_mov_b32 s69, 65536
    s_mov_b64 exec, 0xff
L_ts1_poll:
    buffer_load_dwordx2 v[254:255], v251, s[60:63], s68 offen sc1
    s_waitcnt vmcnt(0)
    v_cmp_eq_u64 vcc, s[64:65], v[254:255]
    s_nop 4
    s_cmp_eq_u32 vcc_lo, 0xff
    s_cbranch_scc1 L_ts1_ok
    s_sub_u32 s69, s69, 1
    s_cmp_lg_u32 s69, 0
    s_cbranch_scc1 L_ts1_poll
L_ts1_ok:
    s_mov_b64 exec, -1
L_ts1_seen:
    s_barrier
    buffer_load_dwordx4 v[128:131], v4, s[8:11], s37 offen offset:0 sc1
    buffer_load_dwordx4 v[132:135], v4, s[12:15], s37 offen offset:0 sc1
    buffer_load_dwordx4 v[136:139], v4, s[8:11], s37 offen offset:1024 sc1
    buffer_load_dwordx4 v[140:143], v4, s[12:15], s37 offen offset:1024 sc1
    buffer_load_dwordx4 v[144:147], v4, s[8:11], s37 offen offset:2048 sc1
    buffer_load_dwordx4 v[148:151], v4, s[12:15], s37 offen offset:2048 sc1
    buffer_load_dwordx4 v[152:155], v4, s[8:11], s37 offen offset:3072 sc1
    buffer_load_dwordx4 v[156:159], v4, s[12:15], s37 offen offset:3072 sc1
    s_add_u32 s37, s37, 4096
    buffer_load_dwordx4 v[160:163], v4, s[8:11], s37 offen offset:0 sc1
    buffer_load_dwordx4 v[164:167], v4, s[12:15], s37 offen offset:0 sc1
    buffer_load_dwordx4 v[168:171], v4, s[8:11], s37 offen offset:1024 sc1
    buffer_load_dwordx4 v[172:175], v4, s[12:15], s37 offen offset:1024 sc1
    buffer_load_dwordx4 v[176:179], v4, s[8:11], s37 offen offset:2048 sc1
    buffer_load_dwordx4 v[180:183], v4, s[12:15], s37 offen offset:2048 sc1
    buffer_load_dwordx4 v[184:187], v4, s[8:11], s37 offen offset:3072 sc1
    buffer_load_dwordx4 v[188:191], v4, s[12:15], s37 offen offset:3072 sc1
    s_add_u32 s37, s37, 4096
    buffer_load_dwordx4 v[192:195], v4, s[8:11], s37 offen offset:0 sc1
    buffer_load_dwordx4 v[196:199], v4, s[12:15], s37 offen offset:0 sc1
    buffer_load_dwordx4 v[200:203], v4, s[8:11], s37 offen offset:1024 sc1
    buffer_load_dwordx4 v[204:207], v4, s[12:15], s37 offen offset:1024 sc1
    buffer_load_dwordx4 v[208:211], v4, s[8:11], s37 offen offset:2048 sc1
    buffer_load_dwordx4 v[212:215], v4, s[12:15], s37 offen offset:2048 sc1
    buffer_load_dwordx4 v[216:219], v4, s[8:11], s37 offen offset:3072 sc1
    buffer_load_dwordx4 v[220:223], v4, s[12:15], s37 offen offset:3072 sc1
    s_add_u32 s37, s37, 4096
    buffer_load_dwordx4 v[224:227], v4, s[8:11], s37 offen offset:0 sc1
    buffer_load_dwordx4 v[228:231], v4, s[12:15], s37 offen offset:0 sc1
    buffer_load_dwordx4 v[232:235], v4, s[8:11], s37 offen offset:1024 sc1
    buffer_load_dwordx4 v[236:239], v4, s[12:15], s37 offen offset:1024 sc1
    buffer_load_dwordx4 a[56:59], v4, s[8:11], s37 offen offset:2048 sc1
    buffer_load_dwordx4 a[60:63], v4, s[12:15], s37 offen offset:2048 sc1
    buffer_load_dwordx4 a[64:67], v4, s[8:11], s37 offen offset:3072 sc1
    buffer_load_dwordx4 a[68:71], v4, s[12:15], s37 offen offset:3072 sc1
    s_add_u32 s37, s37, 4096
    buffer_load_dwordx4 a[72:75], v4, s[8:11], s37 offen offset:0 sc1
    buffer_load_dwordx4 a[76:79], v4, s[12:15], s37 offen offset:0 sc1
    buffer_load_dwordx4 a[80:83], v4, s[8:11], s37 offen offset:1024 sc1
    buffer_load_dwordx4 a[84:87], v4, s[12:15], s37 offen offset:1024 sc1
    buffer_load_dwordx4 a[88:91], v4, s[8:11], s37 offen offset:2048 sc1
    buffer_load_dwordx4 a[92:95], v4, s[12:15], s37 offen offset:2048 sc1
    buffer_load_dwordx4 a[96:99], v4, s[8:11], s37 offen offset:3072 sc1
    buffer_load_dwordx4 a[100:103], v4, s[12:15], s37 offen offset:3072 sc1
    s_add_u32 s37, s37, 4096
    buffer_load_dwordx4 a[104:107], v4, s[8:11], s37 offen offset:0 sc1
    buffer_load_dwordx4 a[108:111], v4, s[12:15], s37 offen offset:0 sc1
    buffer_load_dwordx4 a[112:115], v4, s[8:11], s37 offen offset:1024 sc1
    buffer_load_dwordx4 a[116:119], v4, s[12:15], s37 offen offset:1024 sc1
    s_waitcnt vmcnt(43)
    v_mfma_f32_32x32x16_bf16 v[64:79], a[132:135], v[128:131], v[64:79]
    s_waitcnt vmcnt(42)
    v_mfma_f32_32x32x16_bf16 v[80:95], a[132:135], v[132:135], v[80:95]
    v_mfma_f32_32x32x16_bf16 v[96:111], a[136:139], v[128:131], v[96:111]
    v_mfma_f32_32x32x16_bf16 v[112:127], a[136:139], v[132:135], v[112:127]
    s_waitcnt vmcnt(41)
    v_mfma_f32_32x32x16_bf16 v[64:79], a[140:143], v[136:139], v[64:79]
    s_waitcnt vmcnt(40)
    v_mfma_f32_32x32x16_bf16 v[80:95], a[140:143], v[140:143], v[80:95]
    v_mfma_f32_32x32x16_bf16 v[96:111], a[144:147], v[136:139], v[96:111]
    v_mfma_f32_32x32x16_bf16 v[112:127], a[144:147], v[140:143], v[112:127]
    s_waitcnt vmcnt(39)
    v_mfma_f32_32x32x16_bf16 v[64:79], a[148:151], v[144:147], v[64:79]
    s_waitcnt vmcnt(38)
    v_mfma_f32_32x32x16_bf16 v[80:95], a[148:151], v[148:151], v[80:95]
    v_mfma_f32_32x32x16_bf16 v[96:111], a[152:155], v[144:147], v[96:111]
    v_mfma_f32_32x32x16_bf16 v[112:127], a[152:155], v[148:151], v[112:127]
    s_waitcnt vmcnt(37)
    v_mfma_f32_32x32x16_bf16 v[64:79], a[156:159], v[152:155], v[64:79]
    s_waitcnt vmcnt(36)
    v_mfma_f32_32x32x16_bf16 v[80:95], a[156:159], v[156:159], v[80:95]
    v_mfma_f32_32x32x16_bf16 v[96:111], a[160:163], v[152:155], v[96:111]
    v_mfma_f32_32x32x16_bf16 v[112:127], a[160:163], v[156:159], v[112:127]
    s_waitcnt vmcnt(35)
    v_mfma_f32_32x32x16_bf16 v[64:79], a[164:167], v[160:163], v[64:79]
    s_waitcnt vmcnt(34)
    v_mfma_f32_32x32x16_bf16 v[80:95], a[164:167], v[164:167], v[80:95]
    v_mfma_f32_32x32x16_bf16 v[96:111], a[168:171], v[160:163], v[96:111]
    v_mfma_f32_32x32x16_bf16 v[112:127], a[168:171], v[164:167], v[112:127]
    s_waitcnt vmcnt(33)
    v_mfma_f32_32x32x16_bf16 v[64:79], a[172:175], v[168:171], v[64:79]
    s_waitcnt vmcnt(32)
    v_mfma_f32_32x32x16_bf16 v[80:95], a[172:175], v[172:175], v[80:95]
    v_mfma_f32_32x32x16_bf16 v[96:111], a[176:179], v[168:171], v[96:111]
    v_mfma_f32_32x32x16_bf16 v[112:127], a[176:179], v[172:175], v[112:127]
    s_waitcnt vmcnt(31)
    v_mfma_f32_32x32x16_bf16 v[64:79], a[180:183], v[176:179], v[64:79]
    s_waitcnt vmcnt(30)
    v_mfma_f32_32x32x16_bf16 v[80:95], a[180:183], v[180:183], v[80:95]
    v_mfma_f32_32x32x16_bf16 v[96:111], a[184:187], v[176:179], v[96:111]
    v_mfma_f32_32x32x16_bf16 v[112:127], a[184:187], v[180:183], v[112:127]
    s_waitcnt vmcnt(29)
    v_mfma_f32_32x32x16_bf16 v[64:79], a[188:191], v[184:187], v[64:79]
    s_waitcnt vmcnt(28)
    v_mfma_f32_32x32x16_bf16 v[80:95], a[188:191], v[188:191], v[80:95]
    v_mfma_f32_32x32x16_bf16 v[96:111], a[192:195], v[184:187], v[96:111]
    v_mfma_f32_32x32x16_bf16 v[112:127], a[192:195], v[188:191], v[112:127]
    s_waitcnt vmcnt(27)
    v_mfma_f32_32x32x16_bf16 v[64:79], a[196:199], v[192:195], v[64:79]
    s_waitcnt vmcnt(26)
    v_mfma_f32_32x32x16_bf16 v[80:95], a[196:199], v[196:199], v[80:95]
    v_mfma_f32_32x32x16_bf16 v[96:111], a[200:203], v[192:195], v[96:111]
    v_mfma_f32_32x32x16_bf16 v[112:127], a[200:203], v[196:199], v[112:127]
    s_waitcnt vmcnt(25)
    v_mfma_f32_32x32x16_bf16 v[64:79], a[204:207], v[200:203], v[64:79]
    s_waitcnt vmcnt(24)
    v_mfma_f32_32x32x16_bf16 v[80:95], a[204:207], v[204:207], v[80:95]
    v_mfma_f32_32x32x16_bf16 v[96:111], a[208:211], v[200:203], v[96:111]
    v_mfma_f32_32x32x16_bf16 v[112:127], a[208:211], v[204:207], v[112:127]
    s_waitcnt vmcnt(23)
    v_mfma_f32_32x32x16_bf16 v[64:79], a[212:215], v[208:211], v[64:79]
    s_waitcnt vmcnt(22)
    v_mfma_f32_32x32x16_bf16 v[80:95], a[212:215], v[212:215], v[80:95]
    v_mfma_f32_32x32x16_bf16 v[96:111], a[216:219], v[208:211], v[96:111]
    v_mfma_f32_32x32x16_bf16 v[112:127], a[216:219], v[212:215], v[112:127]
    s_waitcnt vmcnt(21)
    v_mfma_f32_32x32x16_bf16 v[64:79], a[220:223], v[216:219], v[64:79]
    s_waitcnt vmcnt(20)
    v_mfma_f32_32x32x16_bf16 v[80:95], a[220:223], v[220:223], v[80:95]
    v_mfma_f32_32x32x16_bf16 v[96:111], a[224:227], v[216:219], v[96:111]
    v_mfma_f32_32x32x16_bf16 v[112:127], a[224:227], v[220:223], v[112:127]
    s_waitcnt vmcnt(19)
    v_mfma_f32_32x32x16_bf16 v[64:79], a[228:231], v[224:227], v[64:79]
    s_waitcnt vmcnt(18)
    v_mfma_f32_32x32x16_bf16 v[80:95], a[228:231], v[228:231], v[80:95]
    v_mfma_f32_32x32x16_bf16 v[96:111], a[232:235], v[224:227], v[96:111]
    v_mfma_f32_32x32x16_bf16 v[112:127], a[232:235], v[228:231], v[112:127]
    s_waitcnt vmcnt(17)
    v_mfma_f32_32x32x16_bf16 v[64:79], a[236:239], v[232:235], v[64:79]
    s_waitcnt vmcnt(16)
    v_mfma_f32_32x32x16_bf16 v[80:95], a[236:239], v[236:239], v[80:95]
    v_mfma_f32_32x32x16_bf16 v[96:111], a[240:243], v[232:235], v[96:111]
    v_mfma_f32_32x32x16_bf16 v[112:127], a[240:243], v[236:239], v[112:127]
    s_waitcnt vmcnt(15)
    v_mfma_f32_32x32x16_bf16 v[64:79], a[244:247], a[56:59], v[64:79]
    s_waitcnt vmcnt(14)
    v_mfma_f32_32x32x16_bf16 v[80:95], a[244:247], a[60:63], v[80:95]
    v_mfma_f32_32x32x16_bf16 v[96:111], a[248:251], a[56:59], v[96:111]
    v_mfma_f32_32x32x16_bf16 v[112:127], a[248:251], a[60:63], v[112:127]
    s_waitcnt vmcnt(13)
    v_mfma_f32_32x32x16_bf16 v[64:79], a[0:3], a[64:67], v[64:79]
    s_waitcnt vmcnt(12)
    v_mfma_f32_32x32x16_bf16 v[80:95], a[0:3], a[68:71], v[80:95]
    v_mfma_f32_32x32x16_bf16 v[96:111], a[4:7], a[64:67], v[96:111]
    v_mfma_f32_32x32x16_bf16 v[112:127], a[4:7], a[68:71], v[112:127]
    s_waitcnt vmcnt(11)
    v_mfma_f32_32x32x16_bf16 v[64:79], a[8:11], a[72:75], v[64:79]
    s_waitcnt vmcnt(10)
    v_mfma_f32_32x32x16_bf16 v[80:95], a[8:11], a[76:79], v[80:95]
    v_mfma_f32_32x32x16_bf16 v[96:111], a[12:15], a[72:75], v[96:111]
    v_mfma_f32_32x32x16_bf16 v[112:127], a[12:15], a[76:79], v[112:127]
    s_waitcnt vmcnt(9)
    v_mfma_f32_32x32x16_bf16 v[64:79], a[16:19], a[80:83], v[64:79]
    s_waitcnt vmcnt(8)
    v_mfma_f32_32x32x16_bf16 v[80:95], a[16:19], a[84:87], v[80:95]
    v_mfma_f32_32x32x16_bf16 v[96:111], a[20:23], a[80:83], v[96:111]
    v_mfma_f32_32x32x16_bf16 v[112:127], a[20:23], a[84:87], v[112:127]
    s_waitcnt vmcnt(7)
    v_mfma_f32_32x32x16_bf16 v[64:79], a[24:27], a[88:91], v[64:79]
    s_waitcnt vmcnt(6)
    v_mfma_f32_32x32x16_bf16 v[80:95], a[24:27], a[92:95], v[80:95]
    v_mfma_f32_32x32x16_bf16 v[96:111], a[28:31], a[88:91], v[96:111]
    v_mfma_f32_32x32x16_bf16 v[112:127], a[28:31], a[92:95], v[112:127]
    s_waitcnt vmcnt(5)
    v_mfma_f32_32x32x16_bf16 v[64:79], a[32:35], a[96:99], v[64:79]
    s_waitcnt vmcnt(4)
    v_mfma_f32_32x32x16_bf16 v[80:95], a[32:35], a[100:103], v[80:95]
    v_mfma_f32_32x32x16_bf16 v[96:111], a[36:39], a[96:99], v[96:111]
    v_mfma_f32_32x32x16_bf16 v[112:127], a[36:39], a[100:103], v[112:127]
    s_waitcnt vmcnt(3)
    v_mfma_f32_32x32x16_bf16 v[64:79], a[40:43], a[104:107], v[64:79]
    s_waitcnt vmcnt(2)
    v_mfma_f32_32x32x16_bf16 v[80:95], a[40:43], a[108:111], v[80:95]
    v_mfma_f32_32x32x16_bf16 v[96:111], a[44:47], a[104:107], v[96:111]
    v_mfma_f32_32x32x16_bf16 v[112:127], a[44:47], a[108:111], v[112:127]
    s_waitcnt vmcnt(1)
    v_mfma_f32_32x32x16_bf16 v[64:79], a[48:51], a[112:115], v[64:79]
    s_waitcnt vmcnt(0)
    v_mfma_f32_32x32x16_bf16 v[80:95], a[48:51], a[116:119], v[80:95]
    v_mfma_f32_32x32x16_bf16 v[96:111], a[52:55], a[112:115], v[96:111]
    v_mfma_f32_32x32x16_bf16 v[112:127], a[52:55], a[116:119], v[112:127]
    v_add_u32 v48, s35, v4
    s_nop 8
    ds_write_b128 v48, v[80:83] offset:4096
    ds_write_b128 v48, v[84:87] offset:5120
    ds_write_b128 v48, v[88:91] offset:6144
    ds_write_b128 v48, v[92:95] offset:7168
    ds_write_b128 v48, v[96:99] offset:8192
    ds_write_b128 v48, v[100:103] offset:9216
    ds_write_b128 v48, v[104:107] offset:10240
    ds_write_b128 v48, v[108:111] offset:11264
    ds_write_b128 v48, v[112:115] offset:12288
    ds_write_b128 v48, v[116:119] offset:13312
    ds_write_b128 v48, v[120:123] offset:14336
    ds_write_b128 v48, v[124:127] offset:15360
    s_xor_b32 s47, s32, 1
    s_lshl_b32 s47, s47, 14
    v_add_u32 v49, s47, v4
    s_xor_b32 s47, s32, 2
    s_lshl_b32 s47, s47, 14
    v_add_u32 v50, s47, v4
    s_xor_b32 s47, s32, 3
    s_lshl_b32 s47, s47, 14
    v_add_u32 v51, s47, v4
    s_waitcnt lgkmcnt(0)
    s_barrier
    ds_read_b128 v[80:83], v49 offset:4096
    ds_read_b128 v[84:87], v49 offset:5120
    ds_read_b128 v[88:91], v49 offset:6144
    ds_read_b128 v[92:95], v49 offset:7168
    ds_read_b128 v[96:99], v50 offset:8192
    ds_read_b128 v[100:103], v50 offset:9216
    ds_read_b128 v[104:107], v50 offset:10240
    ds_read_b128 v[108:111], v50 offset:11264
    ds_read_b128 v[112:115], v51 offset:12288
    ds_read_b128 v[116:119], v51 offset:13312
    ds_read_b128 v[120:123], v51 offset:14336
    ds_read_b128 v[124:127], v51 offset:15360
    s_waitcnt lgkmcnt(11)
    v_pk_add_f32 v[64:65], v[64:65], v[80:81]
    s_waitcnt lgkmcnt(3)
    v_pk_add_f32 v[96:97], v[96:97], v[112:113]
    v_pk_add_f32 v[66:67], v[66:67], v[82:83]
    v_pk_add_f32 v[98:99], v[98:99], v[114:115]
    v_pk_add_f32 v[68:69], v[68:69], v[84:85]
    s_waitcnt lgkmcnt(2)
    v_pk_add_f32 v[100:101], v[100:101], v[116:117]
    v_pk_add_f32 v[70:71], v[70:71], v[86:87]
    v_pk_add_f32 v[102:103], v[102:103], v[118:119]
    v_pk_add_f32 v[72:73], v[72:73], v[88:89]
    s_waitcnt lgkmcnt(1)
    v_pk_add_f32 v[104:105], v[104:105], v[120:121]
    v_pk_add_f32 v[74:75], v[74:75], v[90:91]
    v_pk_add_f32 v[106:107], v[106:107], v[122:123]
    v_pk_add_f32 v[76:77], v[76:77], v[92:93]
    s_waitcnt lgkmcnt(0)
    v_pk_add_f32 v[108:109], v[108:109], v[124:125]
    v_pk_add_f32 v[78:79], v[78:79], v[94:95]
    v_pk_add_f32 v[110:111], v[110:111], v[126:127]
    v_pk_add_f32 v[64:65], v[64:65], v[96:97]
    v_pk_add_f32 v[66:67], v[66:67], v[98:99]
    v_pk_add_f32 v[68:69], v[68:69], v[100:101]
    v_pk_add_f32 v[70:71], v[70:71], v[102:103]
    v_pk_add_f32 v[72:73], v[72:73], v[104:105]
    v_pk_add_f32 v[74:75], v[74:75], v[106:107]
    v_pk_add_f32 v[76:77], v[76:77], v[108:109]
    v_pk_add_f32 v[78:79], v[78:79], v[110:111]
    v_lshlrev_b32 v80, 16, v8
    v_and_b32 v81, 0xffff0000, v8
    v_lshlrev_b32 v82, 16, v9
    v_and_b32 v83, 0xffff0000, v9
    v_lshlrev_b32 v84, 16, v10
    v_and_b32 v85, 0xffff0000, v10
    v_lshlrev_b32 v86, 16, v11
    v_and_b32 v87, 0xffff0000, v11
    v_lshlrev_b32 v88, 16, v12
    v_and_b32 v89, 0xffff0000, v12
    v_lshlrev_b32 v90, 16, v13
    v_and_b32 v91, 0xffff0000, v13
    v_lshlrev_b32 v92, 16, v14
    v_and_b32 v93, 0xffff0000, v14
    v_lshlrev_b32 v94, 16, v15
    v_and_b32 v95, 0xffff0000, v15
    v_pk_fma_f32 v[64:65], v[64:65], v[16:17], v[80:81]
    v_pk_fma_f32 v[66:67], v[66:67], v[18:19], v[82:83]
    v_pk_fma_f32 v[68:69], v[68:69], v[20:21], v[84:85]
    v_pk_fma_f32 v[70:71], v[70:71], v[22:23], v[86:87]
    v_pk_fma_f32 v[72:73], v[72:73], v[24:25], v[88:89]
    v_pk_fma_f32 v[74:75], v[74:75], v[26:27], v[90:91]
    v_pk_fma_f32 v[76:77], v[76:77], v[28:29], v[92:93]
    v_pk_fma_f32 v[78:79], v[78:79], v[30:31], v[94:95]
    v_cvt_pk_bf16_f32 v96, v64, v65
    v_cvt_pk_bf16_f32 v97, v66, v67
    v_cvt_pk_bf16_f32 v98, v68, v69
    v_cvt_pk_bf16_f32 v99, v70, v71
    v_cvt_pk_bf16_f32 v100, v72, v73
    v_cvt_pk_bf16_f32 v101, v74, v75
    v_cvt_pk_bf16_f32 v102, v76, v77
    v_cvt_pk_bf16_f32 v103, v78, v79
    buffer_store_dwordx4 v[96:99], v7, s[24:27], s70 offen offset:0
    buffer_store_dwordx4 v[100:103], v7, s[24:27], s70 offen offset:32
    s_waitcnt vmcnt(0)
L_k6_end:
    s_endpgm
L_k6_nomm:
    s_mul_i32 s46, s34, 176128
    s_add_u32 s46, s46, 0x2400000
    s_add_u32 s76, s50, s46
    s_addc_u32 s77, s51, 0
    s_mov_b32 s78, 0x2b000
    s_mov_b32 s79, 0x00020000
    s_mul_i32 s75, s32, 45056
    s_add_u32 s28, s50, 0x1400000
    s_addc_u32 s29, s51, 0
    s_mov_b32 s30, 0x200000
    s_mov_b32 s31, 0x00020000
    s_add_u32 s20, s50, 0x2800
    s_addc_u32 s21, s51, 0
    s_mov_b32 s22, 0x800
    s_mov_b32 s23, 0x00020000
    s_lshr_b32 s47, s32, 1
    s_lshl_b32 s47, s47, 10
    v_add_u32 v18, s47, v4
    s_xor_b32 s47, s47, 1024
    v_add_u32 v19, s47, v4
    s_add_u32 s73, s75, 0
    buffer_load_dwordx4 a[132:135], v18, s[76:79], s73 offen offset:0
    buffer_load_dwordx4 a[136:139], v19, s[76:79], s73 offen offset:0
    buffer_load_dwordx4 a[140:143], v18, s[76:79], s73 offen offset:2048
    buffer_load_dwordx4 a[144:147], v19, s[76:79], s73 offen offset:2048
    s_add_u32 s73, s75, 4096
    buffer_load_dwordx4 a[148:151], v18, s[76:79], s73 offen offset:0
    buffer_load_dwordx4 a[152:155], v19, s[76:79], s73 offen offset:0
    buffer_load_dwordx4 a[156:159], v18, s[76:79], s73 offen offset:2048
    buffer_load_dwordx4 a[160:163], v19, s[76:79], s73 offen offset:2048
    s_add_u32 s73, s75, 8192
    buffer_load_dwordx4 a[164:167], v18, s[76:79], s73 offen offset:0
    buffer_load_dwordx4 a[168:171], v19, s[76:79], s73 offen offset:0
    buffer_load_dwordx4 a[172:175], v18, s[76:79], s73 offen offset:2048
    buffer_load_dwordx4 a[176:179], v19, s[76:79], s73 offen offset:2048
    s_add_u32 s73, s75, 12288
    buffer_load_dwordx4 a[180:183], v18, s[76:79], s73 offen offset:0
    buffer_load_dwordx4 a[184:187], v19, s[76:79], s73 offen offset:0
    buffer_load_dwordx4 a[188:191], v18, s[76:79], s73 offen offset:2048
    buffer_load_dwordx4 a[192:195], v19, s[76:79], s73 offen offset:2048
    s_add_u32 s73, s75, 16384
    buffer_load_dwordx4 a[196:199], v18, s[76:79], s73 offen offset:0
    buffer_load_dwordx4 a[200:203], v19, s[76:79], s73 offen offset:0
    buffer_load_dwordx4 a[204:207], v18, s[76:79], s73 offen offset:2048
    buffer_load_dwordx4 a[208:211], v19, s[76:79], s73 offen offset:2048
    s_add_u32 s73, s75, 20480
    buffer_load_dwordx4 a[212:215], v18, s[76:79], s73 offen offset:0
    buffer_load_dwordx4 a[216:219], v19, s[76:79], s73 offen offset:0
    buffer_load_dwordx4 a[220:223], v18, s[76:79], s73 offen offset:2048
    buffer_load_dwordx4 a[224:227], v19, s[76:79], s73 offen offset:2048
    s_add_u32 s73, s75, 24576
    buffer_load_dwordx4 a[228:231], v18, s[76:79], s73 offen offset:0
    buffer_load_dwordx4 a[232:235], v19, s[76:79], s73 offen offset:0
    buffer_load_dwordx4 a[236:239], v18, s[76:79], s73 offen offset:2048
    buffer_load_dwordx4 a[240:243], v19, s[76:79], s73 offen offset:2048
    s_add_u32 s73, s75, 28672
    buffer_load_dwordx4 a[244:247], v18, s[76:79], s73 offen offset:0
    buffer_load_dwordx4 a[248:251], v19, s[76:79], s73 offen offset:0
    s_add_u32 s74, s75, 28672
    buffer_load_dwordx4 a[0:3], v18, s[76:79], s74 offen offset:2048
    buffer_load_dwordx4 a[4:7], v19, s[76:79], s74 offen offset:2048
    s_add_u32 s74, s75, 32768
    buffer_load_dwordx4 a[8:11], v18, s[76:79], s74 offen offset:0
    buffer_load_dwordx4 a[12:15], v19, s[76:79], s74 offen offset:0
    buffer_load_dwordx4 a[16:19], v18, s[76:79], s74 offen offset:2048
    buffer_load_dwordx4 a[20:23], v19, s[76:79], s74 offen offset:2048
    s_add_u32 s74, s75, 36864
    buffer_load_dwordx4 a[24:27], v18, s[76:79], s74 offen offset:0
    buffer_load_dwordx4 a[28:31], v19, s[76:79], s74 offen offset:0
    buffer_load_dwordx4 a[32:35], v18, s[76:79], s74 offen offset:2048
    buffer_load_dwordx4 a[36:39], v19, s[76:79], s74 offen offset:2048
    s_add_u32 s74, s75, 40960
    buffer_load_dwordx4 a[40:43], v18, s[76:79], s74 offen offset:0
    buffer_load_dwordx4 a[44:47], v19, s[76:79], s74 offen offset:0
    buffer_load_dwordx4 a[48:51], v18, s[76:79], s74 offen offset:2048
    buffer_load_dwordx4 a[52:55], v19, s[76:79], s74 offen offset:2048
    buffer_load_dwordx4 v[8:11], v4, s[28:31], s39 offen offset:0 sc1
    buffer_load_dwordx4 v[12:15], v4, s[28:31], s39 offen offset:1024 sc1
    buffer_load_dwordx4 v[16:19], v5, s[20:23], s71 offen offset:0
    buffer_load_dwordx4 v[20:23], v5, s[20:23], s71 offen offset:16
    buffer_load_dwordx4 v[24:27], v5, s[20:23], s71 offen offset:64
    buffer_load_dwordx4 v[28:31], v5, s[20:23], s71 offen offset:80
    s_branch L_k6_noep
L_text_end:
.section .rodata,"a"
.p2align 6
.amdhsa_kernel ada_attn_kernel
  .amdhsa_next_free_vgpr 512
  .amdhsa_next_free_sgpr 102
  .amdhsa_accum_offset 256
  .amdhsa_group_segment_fixed_size 0
  .amdhsa_kernarg_size 112
  .amdhsa_user_sgpr_count 2
  .amdhsa_user_sgpr_kernarg_segment_ptr 1
  .amdhsa_system_sgpr_workgroup_id_x 1
.end_amdhsa_kernel
.section .rodata,"a"
.p2align 6
.amdhsa_kernel ada_tail_kernel
  .amdhsa_next_free_vgpr 512
  .amdhsa_next_free_sgpr 102
  .amdhsa_accum_offset 256
  .amdhsa_group_segment_fixed_size 0
  .amdhsa_kernarg_size 112
  .amdhsa_user_sgpr_count 2
  .amdhsa_user_sgpr_kernarg_segment_ptr 1
  .amdhsa_system_sgpr_workgroup_id_x 1
.end_amdhsa_kernel
```
